```python
import torch

def _softmax(x, axis=-1):
    return torch.softmax(x, dim=axis)
def _gelu(x):
    return torch.nn.functional.gelu(x, approximate="tanh")
def _silu(x):
    return torch.nn.functional.silu(x)
def _sigmoid(x):
    return torch.sigmoid(x)
def _layernorm(x, axis=-1, eps=1e-5):
    m = x.mean(dim=axis, keepdim=True)
    v = x.var(dim=axis, keepdim=True, unbiased=False)
    return (x - m) / torch.sqrt(v + eps)
def _scatter_add(tgt, idx, src, axis=0):
    return tgt.clone().index_add_(axis, idx, src)
def _segment_sum(src, seg, n):
    out = torch.zeros((n,) + src.shape[1:], dtype=src.dtype)
    return out.index_add_(0, seg, src)
def _pad(x, pw):
    flat = tuple(v for pair in reversed(pw) for v in pair)
    return torch.nn.functional.pad(x, flat)

kernel_name = 'concat_heads__spectral_fnet__ssm_conv_h3__prompt'

def setup_inputs():

    _w = (lambda a: (lambda t: t.to(torch.bfloat16) if t.is_floating_point() else t)(torch.as_tensor(a)))
    def _A_setup():
        B, S, D = 1, 2048, 640
        ns = torch.arange(S)[:, None] * torch.arange(S)[None, :]
        nd = torch.arange(D)[:, None] * torch.arange(D)[None, :]
        Ws_re = torch.cos(-2.0 * torch.pi * ns / S).to(float)
        Ws_im = torch.sin(-2.0 * torch.pi * ns / S).to(float)
        Wd_re = torch.cos(-2.0 * torch.pi * nd / D).to(float)
        Wd_im = torch.sin(-2.0 * torch.pi * nd / D).to(float)
        return {
            "x": _w((lambda *s: torch.randn(*s, dtype=torch.bfloat16) * 0.05)(B, S, D)),
            "dft_seq_re": _w(Ws_re),
            "dft_seq_im": _w(Ws_im),
            "dft_hid_re": _w(Wd_re),
            "dft_hid_im": _w(Wd_im),
        }
    _A_in = _A_setup()

    def _B_setup():
        B, S, D = 1, 2048, 640
        ks = 4
        return {
            "q": _w((lambda *s: torch.randn(*s, dtype=torch.bfloat16) * 0.05)(B, S, D)),
            "k": _w((lambda *s: torch.randn(*s, dtype=torch.bfloat16) * 3.2)(B, S, D)),
            "v": _w((lambda *s: torch.randn(*s, dtype=torch.bfloat16) * 3.2)(B, S, D)),
            "shift_k": _w((lambda *s: torch.randn(*s, dtype=torch.bfloat16) * 3.2)(D, ks) * 0.5),
            "ssm_k": _w((lambda *s: torch.randn(*s, dtype=torch.bfloat16) * 3.2)(D, S) * (1.0 / S ** 0.5)),
            "ssm_D": _w((lambda *s: torch.randn(*s, dtype=torch.bfloat16) * 3.2)(D)),
        }
    _B_in = _B_setup()

    return {
        "A_x": _A_in["x"],
        "A_dft_seq_re": _A_in["dft_seq_re"],
        "A_dft_seq_im": _A_in["dft_seq_im"],
        "A_dft_hid_re": _A_in["dft_hid_re"],
        "A_dft_hid_im": _A_in["dft_hid_im"],
        "B_q": _B_in["q"],
        "B_k": _B_in["k"],
        "B_v": _B_in["v"],
        "B_shift_k": _B_in["shift_k"],
        "B_ssm_k": _B_in["ssm_k"],
        "B_ssm_D": _B_in["ssm_D"],
    }

def reference(A_x, A_dft_seq_re, A_dft_seq_im, A_dft_hid_re, A_dft_hid_im, B_q, B_k, B_v, B_shift_k, B_ssm_k, B_ssm_D):
    def _A_ref(x, dft_seq_re, dft_seq_im, dft_hid_re, dft_hid_im):
        a = torch.einsum("bsd,ed->bse", x, dft_hid_re)
        b = torch.einsum("bsd,ed->bse", x, dft_hid_im)
        y = torch.einsum("ts,bse->bte", dft_seq_re, a) - torch.einsum("ts,bse->bte", dft_seq_im, b)
        return y

    def _B_ref(q, k, v, shift_k, ssm_k, ssm_D):
        B, S, D = q.shape
        ks = shift_k.shape[-1]
        k_pad = _pad(k, ((0, 0), (ks - 1, 0), (0, 0)))
        k_shift = torch.zeros_like(k)
        for t in range(ks):
            k_shift = k_shift + k_pad[:, t:t + S, :] * shift_k[:, ks - 1 - t][None, None, :]
        kv = k_shift * v
        L = 2 * S
        kv_pad = _pad(kv, ((0, 0), (0, S), (0, 0)))
        kf_pad = _pad(ssm_k, ((0, 0), (0, S)))
        kv_f = (lambda x, axes=(-2,-1): torch.fft.rfft2(x.float(), dim=axes))(kv_pad[:, None, :, :], axes=(1, 2))
        kf_f = (lambda x, axes=(-2,-1): torch.fft.rfft2(x.float(), dim=axes))(kf_pad[:, None, :], axes=(1, 2))
        kf_f = (lambda x, *d: x.permute(*d))(kf_f, 1, 2, 0)
        y_f = kv_f * kf_f[None, :, :, :]
        y = (lambda x, s, axes=(-2,-1): torch.fft.irfft2(x, s=s, dim=axes).to(torch.bfloat16))(y_f, (1, L), axes=(1, 2))[:, 0, :S, :]
        y = y + kv * ssm_D[None, None, :]
        return q * y

    a = _A_ref(A_x, A_dft_seq_re, A_dft_seq_im, A_dft_hid_re, A_dft_hid_im)
    b = _B_ref(B_q, B_k, B_v, B_shift_k, B_ssm_k, B_ssm_D)
    return torch.concatenate([a, b], axis=-1)
```

```asm
; @launch grid=(256,1,1) block=(512,1,1) lds=137216
.amdgcn_target "amdgcn-amd-amdhsa--gfx950"
.text
.globl concat_heads__spectral_fnet__ssm_conv_h3__prompt_kernel
.p2align 8
.type concat_heads__spectral_fnet__ssm_conv_h3__prompt_kernel,@function
concat_heads__spectral_fnet__ssm_conv_h3__prompt_kernel:
  s_getpc_b64 s[4:5]
  s_load_dwordx2 s[96:97], s[0:1], 0
  s_load_dwordx2 s[64:65], s[0:1], 48
  s_load_dwordx2 s[68:69], s[0:1], 56
  s_load_dwordx2 s[72:73], s[0:1], 64
  s_load_dwordx2 s[14:15], s[0:1], 96
  s_memrealtime s[100:101]
  s_cmp_ge_u32 s2, 256
  s_cbranch_scc1 K_END
  v_lshrrev_b32 v2, 6, v0
  v_and_b32 v1, 63, v0
  v_readfirstlane_b32 s3, v2
  s_and_b32 s13, s2, 7
  s_bitcmp1_b32 s2, 0
  s_mov_b32 s16, 0x7f2b08
  s_cselect_b32 s16, 0xf9aa44, s16
  s_lshr_b32 s22, s2, 5
  s_mul_i32 s22, s22, 3
  s_lshr_b32 s9, s16, s22
  s_bfe_u32 s19, s2, 0x20003
  s_and_b32 s8, s9, 3
  s_lshl2_add_u32 s8, s8, s19
  v_lshlrev_b32 v3, 4, v1
  v_lshrrev_b32 v4, 3, v1
  v_and_b32 v5, 7, v1
  v_and_b32 v9, 2, v4
  v_xor_b32 v5, v5, v9
  s_bitcmp1_b32 s9, 2
  s_cbranch_scc0 R_A
  s_cmp_ge_u32 s3, 5
  s_cbranch_scc1 R_PF
  s_lshr_b32 s44, s8, 1
  s_lshl3_add_u32 s44, s13, s44
  s_and_b32 s45, s8, 1
  s_mul_i32 s45, s45, 5
  s_add_u32 s45, s45, s3
  s_mul_i32 s46, s44, 40960
  s_lshl_b32 s47, s45, 7
  s_add_u32 s46, s46, s47
  v_mul_u32_u24 v6, 1280, v4
  v_lshl_add_u32 v6, v5, 4, v6
  v_xor_b32 v7, 64, v6
  s_mul_i32 s48, s3, 9216
  s_add_u32 s59, s46, 10240
  s_add_u32 s60, s46, 20480
  s_add_u32 s61, s46, 30720
  s_sub_u32 s50, s46, 10240
  v_add_u32 v8, s50, v6
  s_mov_b32 s66, 0x280000
  s_mov_b32 s67, 0x20000
  s_mov_b32 s70, 0x280000
  s_mov_b32 s71, 0x20000
  s_mov_b32 s74, 0x1400
  s_mov_b32 s75, 0x20000
  s_add_u32 m0, s48, 1024
  s_waitcnt lgkmcnt(0)
  buffer_load_dwordx4 v7, s[64:67], s46 offen nt lds
  s_add_u32 m0, s48, 2048
  s_nop 0
  buffer_load_dwordx4 v6, s[64:67], s59 offen nt lds
  s_add_u32 m0, s48, 3072
  s_nop 0
  buffer_load_dwordx4 v7, s[64:67], s60 offen nt lds
  s_add_u32 m0, s48, 4096
  s_nop 0
  buffer_load_dwordx4 v6, s[64:67], s61 offen nt lds
  s_add_u32 m0, s48, 0
  s_mov_b32 exec_lo, 0
  buffer_load_dwordx4 v8, s[64:67], 0 offen nt lds
  s_mov_b32 exec_lo, -1
  v_lshlrev_b32 v9, 3, v1
  s_lshl_b32 s50, s45, 9
  buffer_load_dwordx2 v[64:65], v9, s[72:75], s50 offen
  s_add_u32 m0, s48, 5120
  s_nop 0
  buffer_load_dwordx4 v6, s[68:71], s46 offen nt lds
  s_add_u32 m0, s48, 6144
  s_nop 0
  buffer_load_dwordx4 v7, s[68:71], s59 offen nt lds
  s_add_u32 m0, s48, 7168
  s_nop 0
  buffer_load_dwordx4 v6, s[68:71], s60 offen nt lds
  s_add_u32 m0, s48, 8192
  s_nop 0
  buffer_load_dwordx4 v7, s[68:71], s61 offen nt lds
  s_branch R_B2
R_A:
  s_add_u32 s92, s4, TBL1-concat_heads__spectral_fnet__ssm_conv_h3__prompt_kernel-4
  s_addc_u32 s93, s5, 0
  s_mov_b32 s94, 0x4400
  s_mov_b32 s95, 0x20000
  s_lshl_b32 s44, s3, 10
  s_mov_b32 m0, s44
  s_add_u32 s45, s44, 8192
  buffer_load_dwordx4 v3, s[92:95], s44 offen lds
  s_cmp_lg_u32 s3, 7
  s_cbranch_scc1 A_T2
  s_movk_i32 s46, 16384
  s_mov_b32 m0, 16384
  s_nop 0
  buffer_load_dwordx4 v3, s[92:95], s46 offen lds
A_T2:
  s_mov_b32 m0, s45
  s_lshr_b32 s56, s8, 1
  buffer_load_dwordx4 v3, s[92:95], s45 offen lds
  s_lshl3_add_u32 s56, s56, s13
  s_sub_u32 s57, 128, s56
  s_cmp_eq_u32 s56, 0
  s_cselect_b32 s57, 64, s57
  s_and_b32 s59, s3, 3
  s_lshr_b32 s60, s3, 2
  v_mul_u32_u24 v6, 163840, v4
  v_lshl_add_u32 v6, v5, 4, v6
  s_cmp_ge_u32 s59, 2
  s_cselect_b32 s46, s57, s56
  s_and_b32 s47, s59, 1
  s_lshl_b32 s47, s47, 10
  s_add_u32 s46, s46, s47
  s_lshl1_add_u32 s46, s46, s60
  s_mul_i32 s46, s46, 640
  s_mul_i32 s47, s59, 10304
  s_mul_i32 s61, s60, 5120
  s_add_u32 s47, s47, s61
  s_mov_b32 s98, 0x280000
  s_mov_b32 s99, 0x20000
  s_waitcnt lgkmcnt(0)
  s_lshl3_add_u32 s48, s2, s3
  s_cmp_lg_u32 s48, 0
  s_cbranch_scc1 A_NT
  v_mov_b32 v7, 0
  v_or_b32 v8, s100, 1
  v_mov_b32 v9, s101
  s_mov_b64 exec, 1
  global_store_dwordx2 v7, v[8:9], s[14:15] sc1
  s_mov_b64 exec, -1
A_NT:
  s_add_u32 m0, s47, 17408
  s_nop 0
  buffer_load_dwordx4 v6, s[96:99], s46 offen offset:0 nt lds
  s_add_u32 m0, s47, 18304
  s_nop 0
  buffer_load_dwordx4 v6, s[96:99], s46 offen offset:128 nt lds
  s_add_u32 m0, s47, 19200
  s_nop 0
  buffer_load_dwordx4 v6, s[96:99], s46 offen offset:256 nt lds
  s_add_u32 m0, s47, 20096
  s_nop 0
  buffer_load_dwordx4 v6, s[96:99], s46 offen offset:384 nt lds
  s_add_u32 m0, s47, 20992
  s_nop 0
  buffer_load_dwordx4 v6, s[96:99], s46 offen offset:512 nt lds
  s_load_dwordx2 s[28:29], s[0:1], 104
  s_load_dwordx2 s[24:25], s[0:1], 72
  s_load_dwordx2 s[32:33], s[0:1], 80
  s_load_dwordx2 s[40:41], s[0:1], 88
  s_load_dwordx2 s[36:37], s[0:1], 40
  s_lshr_b32 s16, s2, 5
  s_mul_i32 s22, s13, 15
  s_add_u32 s22, s22, 1
  s_lshr_b32 s22, s22, 1
  s_add_u32 s22, s22, s16
  s_and_b32 s23, s13, 1
  s_add_u32 s23, s23, s16
  s_cmp_ge_u32 s23, 8
  s_cselect_b32 s22, 0, s22
  s_cselect_b32 s23, 3, 0
  s_mul_i32 s17, s22, 43
  s_lshr_b32 s17, s17, 7
  s_mul_i32 s18, s17, 3
  s_sub_u32 s18, s22, s18
  s_add_u32 s18, s18, s23
  s_lshl2_add_u32 s17, s17, s19
  s_lshl3_add_u32 s20, s17, s3
  s_lshl_b32 s21, s20, 12
  s_add_u32 s12, s21, 0x280000
  s_mul_i32 s52, s3, 4128
  s_add_u32 s52, s52, 104224
  s_mul_i32 s53, s3, 4352
  s_add_u32 s53, s53, 17664
  s_mov_b32 s26, 0x280000
  s_mov_b32 s27, 0x20000
  s_mov_b32 s30, 0x51a000
  s_mov_b32 s31, 0x20000
  s_mov_b32 s34, 0x500
  s_mov_b32 s35, 0x20000
  s_mov_b32 s38, 0x280000
  s_mov_b32 s39, 0x20000
  s_mov_b32 s42, 0x500000
  s_mov_b32 s43, 0x20000
  s_and_b32 s58, s8, 1
  v_and_b32 v4, 15, v1
  v_lshrrev_b32 v5, 4, v1
  v_cmp_gt_u32 vcc, 2, v5
  v_mov_b32 v6, s57
  v_mov_b32 v7, s56
  v_cndmask_b32 v6, v6, v7, vcc
  v_and_b32 v7, 1, v5
  v_lshl_add_u32 v6, v7, 10, v6
  v_mul_u32_u24 v6, v6, v4
  s_cmp_lg_u32 s56, 0
  s_cselect_b32 s44, s58, 0
  s_mul_i32 s45, s44, 512
  s_mul_i32 s46, s44, 1536
  v_mov_b32 v7, s46
  v_mov_b32 v16, s45
  v_cndmask_b32 v7, v7, v16, vcc
  v_add_u32 v6, v6, v7
  v_cvt_f32_u32 v6, v6
  v_mul_f32 v6, 0x3a000000, v6
  v_cvt_f32_u32 v7, v4
  v_mul_f32 v7, 0x3d800000, v7
  v_cos_f32 v16, v6
  v_sin_f32 v24, -v6
  v_add_f32 v6, v6, v7
  v_cos_f32 v17, v6
  v_sin_f32 v25, -v6
  v_add_f32 v6, v6, v7
  v_cos_f32 v18, v6
  v_sin_f32 v26, -v6
  v_add_f32 v6, v6, v7
  v_cos_f32 v19, v6
  v_sin_f32 v27, -v6
  v_add_f32 v6, v6, v7
  v_cos_f32 v20, v6
  v_sin_f32 v28, -v6
  v_add_f32 v6, v6, v7
  v_cos_f32 v21, v6
  v_sin_f32 v29, -v6
  v_add_f32 v6, v6, v7
  v_cos_f32 v22, v6
  v_sin_f32 v30, -v6
  v_add_f32 v6, v6, v7
  v_cos_f32 v23, v6
  v_sin_f32 v31, -v6
  v_cvt_pk_bf16_f32 v8, v16, v17
  v_cvt_pk_bf16_f32 v9, v18, v19
  v_cvt_pk_bf16_f32 v10, v20, v21
  v_cvt_pk_bf16_f32 v11, v22, v23
  v_cvt_pk_bf16_f32 v12, v24, v25
  v_cvt_pk_bf16_f32 v13, v26, v27
  v_cvt_pk_bf16_f32 v14, v28, v29
  v_cvt_pk_bf16_f32 v15, v30, v31
  s_cmp_lg_u32 s56, 0
  s_cbranch_scc1 A_NM
  s_cmp_eq_u32 s58, 0
  s_cselect_b32 s45, -1, 0
  s_cselect_b32 s46, 0, -1
  v_mov_b32 v16, s46
  v_mov_b32 v17, s45
  v_cndmask_b32 v32, v16, v17, vcc
  v_and_b32 v8, v32, v8
  v_and_b32 v9, v32, v9
  v_and_b32 v10, v32, v10
  v_and_b32 v11, v32, v11
  v_and_b32 v12, v32, v12
  v_and_b32 v13, v32, v13
  v_and_b32 v14, v32, v14
  v_and_b32 v15, v32, v15
A_NM:
  v_lshrrev_b32 v16, 4, v1
  v_bfe_u32 v17, v1, 2, 2
  v_and_b32 v18, 3, v1
  v_bfe_u32 v20, v1, 3, 1
  v_xor_b32 v21, s59, v20
  v_mul_u32_u24 v252, 10304, v16
  v_lshl_add_u32 v252, v17, 7, v252
  v_lshl_add_u32 v252, v21, 5, v252
  v_lshl_add_u32 v252, v18, 3, v252
  v_add_u32 v252, s61, v252
  v_mul_u32_u24 v253, 2568, v4
  v_lshl_add_u32 v253, v16, 3, v253
  s_lshl_b32 s44, s59, 5
  s_mul_i32 s45, s60, 640
  s_add_u32 s44, s44, s45
  v_add_u32 v253, s44, v253
  v_lshrrev_b32 v21, 1, v16
  v_mul_u32_u24 v254, 1280, v21
  v_and_b32 v21, 1, v16
  v_lshl_add_u32 v21, v21, 3, v17
  v_mul_u32_u24 v21, 80, v21
  s_mul_i32 s44, s3, 5136
  v_add3_u32 v254, v254, v21, s44
  v_and_b32 v21, 1, v18
  v_lshl_add_u32 v255, v21, 3, v254
  v_lshl_add_u32 v254, v18, 3, v254
  v_lshlrev_b32 v40, 7, v17
  v_lshl_add_u32 v40, v16, 5, v40
  v_lshl_add_u32 v40, v18, 3, v40
  v_lshl_add_u32 v41, v20, 30, v40
  s_lshl_b32 s45, s58, 6
  s_add_u32 s45, s45, s56
  s_lshl_b32 s49, s3, 7
  s_add_u32 s49, s49, s45
  s_mul_i32 s50, s49, 2560
  s_lshl_b32 s49, s49, 6
  s_add_u32 s49, s49, 0x50a000
  s_waitcnt vmcnt(5)
  s_barrier
  ds_read_b128 v[48:51], v3 offset:0
  ds_read_b128 v[52:55], v3 offset:1024
  ds_read_b128 v[56:59], v3 offset:2048
  ds_read_b128 v[60:63], v3 offset:3072
  ds_read_b128 v[64:67], v3 offset:4096
  ds_read_b128 v[68:71], v3 offset:5120
  ds_read_b128 v[72:75], v3 offset:6144
  ds_read_b128 v[76:79], v3 offset:7168
  ds_read_b128 v[80:83], v3 offset:8192
  ds_read_b128 v[84:87], v3 offset:9216
  ds_read_b128 v[88:91], v3 offset:10240
  ds_read_b128 v[92:95], v3 offset:11264
  ds_read_b128 v[96:99], v3 offset:12288
  ds_read_b128 v[100:103], v3 offset:13312
  ds_read_b128 v[104:107], v3 offset:14336
  ds_read_b128 v[108:111], v3 offset:15360
  ds_read_b128 v[112:115], v3 offset:16384
  v_add_u32 v4, v17, v18
  v_lshl_add_u32 v4, v16, 3, v4
  s_sub_u32 s23, s52, 24
  v_lshl_add_u32 v4, v4, 3, s23
  v_lshlrev_b32 v5, 2, v18
  v_sub_u32 v5, v5, v17
  v_lshlrev_b32 v19, 3, v16
  v_sub_u32 v5, v5, v19
  s_sub_u32 s23, s53, 8
  v_lshl_add_u32 v5, v5, 3, s23
  s_mul_i32 s23, s3, 1600
  v_lshl_add_u32 v6, v1, 3, s23
  v_mov_b32 v23, 0
  global_load_dwordx2 v[248:249], v23, s[14:15] sc1
  s_lshl_b32 s23, s20, 1
  s_waitcnt lgkmcnt(0)
  buffer_load_ushort v250, off, s[32:35], s23
  s_mov_b32 m0, s52
  s_nop 0
  buffer_load_dwordx4 v3, s[24:27], s21 offen offset:0 lds
  buffer_load_dwordx4 v3, s[24:27], s21 offen offset:1024 lds
  buffer_load_dwordx4 v3, s[24:27], s21 offen offset:2048 lds
  buffer_load_dwordx4 v3, s[24:27], s21 offen offset:3072 lds
  s_waitcnt vmcnt(6)
  s_barrier
  ds_read_b64_tr_b16 v[116:117], v252 offset:17408
  ds_read_b64_tr_b16 v[118:119], v252 offset:17920
  ds_read_b64_tr_b16 v[120:121], v252 offset:18432
  ds_read_b64_tr_b16 v[122:123], v252 offset:18944
  ds_read_b64_tr_b16 v[124:125], v252 offset:19456
  ds_read_b64_tr_b16 v[126:127], v252 offset:19968
  ds_read_b64_tr_b16 v[128:129], v252 offset:20480
  ds_read_b64_tr_b16 v[130:131], v252 offset:20992
  ds_read_b64_tr_b16 v[132:133], v252 offset:21504
  ds_read_b64_tr_b16 v[134:135], v252 offset:22016
  v_and_b32 v19, 1, v18
  v_lshl_add_u32 v19, v19, 2, v17
  v_mul_u32_u24 v7, 1600, v19
  v_lshrrev_b32 v19, 1, v18
  v_lshl_add_u32 v19, v16, 1, v19
  v_lshl_add_u32 v19, v2, 3, v19
  v_lshl_add_u32 v7, v19, 3, v7
  v_lshrrev_b32 v20, 3, v1
  v_lshrrev_b32 v46, 2, v1
  v_min_u32 v46, 12, v46
  s_mul_i32 s23, s3, 13
  v_add_u32 v46, s23, v46
  s_lshl_b32 s23, s18, 3
  s_lshr_b32 s23, 0x3f27373f, s23
  s_and_b32 s23, s23, 63
  v_min_u32 v46, s23, v46
  v_lshlrev_b32 v46, 6, v46
  v_lshl_add_u32 v19, v2, 3, v20
  v_lshl_add_u32 v19, v18, 6, v19
  v_mul_u32_u24 v19, 1280, v19
  v_and_b32 v21, 4, v1
  s_waitcnt lgkmcnt(8)
  v_mfma_f32_16x16x32_bf16 v[136:139], v[116:119], v[8:11], 0
  v_mfma_f32_16x16x32_bf16 v[140:143], v[116:119], v[12:15], 0
  s_waitcnt lgkmcnt(6)
  v_mfma_f32_16x16x32_bf16 v[144:147], v[120:123], v[8:11], 0
  v_mfma_f32_16x16x32_bf16 v[148:151], v[120:123], v[12:15], 0
  s_waitcnt lgkmcnt(4)
  v_mfma_f32_16x16x32_bf16 v[152:155], v[124:127], v[8:11], 0
  v_mfma_f32_16x16x32_bf16 v[156:159], v[124:127], v[12:15], 0
  s_nop 0
  v_cvt_pk_bf16_f32 v176, v136, v137
  v_cvt_pk_bf16_f32 v177, v138, v139
  ds_write_b64 v253, v[176:177] offset:58624
  v_cvt_pk_bf16_f32 v178, v140, v141
  v_cvt_pk_bf16_f32 v179, v142, v143
  ds_write_b64 v253, v[178:179] offset:59904
  s_waitcnt lgkmcnt(4)
  v_mfma_f32_16x16x32_bf16 v[160:163], v[128:131], v[8:11], 0
  v_mfma_f32_16x16x32_bf16 v[164:167], v[128:131], v[12:15], 0
  v_cvt_pk_bf16_f32 v180, v144, v145
  v_cvt_pk_bf16_f32 v181, v146, v147
  ds_write_b64 v253, v[180:181] offset:58752
  v_cvt_pk_bf16_f32 v182, v148, v149
  v_cvt_pk_bf16_f32 v183, v150, v151
  ds_write_b64 v253, v[182:183] offset:60032
  s_waitcnt lgkmcnt(4)
  v_mfma_f32_16x16x32_bf16 v[168:171], v[132:135], v[8:11], 0
  v_mfma_f32_16x16x32_bf16 v[172:175], v[132:135], v[12:15], 0
  v_cvt_pk_bf16_f32 v184, v152, v153
  v_cvt_pk_bf16_f32 v185, v154, v155
  ds_write_b64 v253, v[184:185] offset:58880
  v_cvt_pk_bf16_f32 v186, v156, v157
  v_cvt_pk_bf16_f32 v187, v158, v159
  ds_write_b64 v253, v[186:187] offset:60160
  v_cvt_pk_bf16_f32 v188, v160, v161
  v_cvt_pk_bf16_f32 v189, v162, v163
  ds_write_b64 v253, v[188:189] offset:59008
  v_cvt_pk_bf16_f32 v190, v164, v165
  v_cvt_pk_bf16_f32 v191, v166, v167
  ds_write_b64 v253, v[190:191] offset:60288
  v_cvt_pk_bf16_f32 v192, v168, v169
  v_cvt_pk_bf16_f32 v193, v170, v171
  ds_write_b64 v253, v[192:193] offset:59136
  v_cvt_pk_bf16_f32 v194, v172, v173
  v_cvt_pk_bf16_f32 v195, v174, v175
  ds_write_b64 v253, v[194:195] offset:60416
  s_waitcnt lgkmcnt(0)
  s_barrier
  ds_read_b64_tr_b16 v[116:117], v254 offset:58624
  ds_read_b64_tr_b16 v[118:119], v254 offset:58944
  ds_read_b64_tr_b16 v[120:121], v254 offset:58656
  ds_read_b64_tr_b16 v[122:123], v254 offset:58976
  ds_read_b64_tr_b16 v[124:125], v255 offset:58688
  ds_read_b64_tr_b16 v[126:127], v255 offset:59008
  ds_read_b64_tr_b16 v[128:129], v254 offset:61192
  ds_read_b64_tr_b16 v[130:131], v254 offset:61512
  ds_read_b64_tr_b16 v[132:133], v254 offset:61224
  ds_read_b64_tr_b16 v[134:135], v254 offset:61544
  ds_read_b64_tr_b16 v[136:137], v255 offset:61256
  ds_read_b64_tr_b16 v[138:139], v255 offset:61576
  v_lshl_add_u32 v45, v21, 27, v19
  v_lshlrev_b32 v44, 1, v45
  v_and_b32 v19, 7, v1
  v_lshl_add_u32 v19, v20, 8, v19
  s_cmp_eq_u32 s18, 0
  s_cselect_b32 s62, 640, 0
  s_cselect_b32 s63, 0, 512
  v_and_b32 v21, 2, v20
  v_mad_u32_u24 v19, v21, s62, v19
  v_mul_u32_u24 v19, 1280, v19
  s_cmp_eq_u32 s18, 1
  s_cselect_b32 s63, 1280, s63
  s_cselect_b32 s23, 15, 23
  v_cmp_lt_u32 vcc, s23, v1
  s_nop 1
  v_cndmask_b32 v47, v19, -1, vcc
  s_lshl3_add_u32 s62, s19, s3
  s_lshl3_add_u32 s62, s62, s63
  s_mul_i32 s62, s62, 1280
  s_lshr_b32 s63, s17, 2
  s_lshl_b32 s63, s63, 6
  s_add_u32 s62, s62, s63
  s_and_b32 s47, s17, 120
  s_lshl_b32 s47, s47, 9
  s_add_u32 s47, s47, 0x500000
  s_lshl_b32 s54, s17, 4
  s_mov_b32 s55, 0xffff0000
  v_mov_b32 v21, 0
  s_sub_u32 s23, s52, 32
  v_and_b32 v19, 7, v1
  v_lshl_add_u32 v19, v19, 2, s23
  ds_write_b32 v19, v21
  s_waitcnt lgkmcnt(11)
  v_mfma_f32_16x16x32_bf16 v[140:143], v[116:119], v[48:51], 0
  v_mfma_f32_16x16x32_bf16 v[144:147], v[116:119], v[52:55], 0
  s_waitcnt lgkmcnt(9)
  v_mfma_f32_16x16x32_bf16 v[148:151], v[120:123], v[48:51], 0
  v_mfma_f32_16x16x32_bf16 v[152:155], v[120:123], v[52:55], 0
  s_waitcnt lgkmcnt(7)
  v_mfma_f32_16x16x32_bf16 v[156:159], v[124:127], v[48:51], 0
  v_mfma_f32_16x16x32_bf16 v[160:163], v[124:127], v[52:55], 0
  s_waitcnt lgkmcnt(5)
  v_mfma_f32_16x16x32_bf16 v[164:167], v[128:131], v[48:51], 0
  v_mfma_f32_16x16x32_bf16 v[168:171], v[128:131], v[52:55], 0
  v_mul_f32 v8, v140, v56
  v_mul_f32 v9, v141, v57
  v_mul_f32 v10, v142, v58
  s_waitcnt lgkmcnt(3)
  v_mfma_f32_16x16x32_bf16 v[172:175], v[132:135], v[48:51], 0
  v_mul_f32 v11, v143, v59
  v_mul_f32 v12, v144, v56
  v_mul_f32 v13, v145, v57
  v_mul_f32 v14, v146, v58
  v_mul_f32 v15, v147, v59
  v_mfma_f32_16x16x32_bf16 v[176:179], v[132:135], v[52:55], 0
  v_fmac_f32 v8, v144, v60
  v_fmac_f32 v9, v145, v61
  v_fmac_f32 v10, v146, v62
  v_fmac_f32 v11, v147, v63
  v_fma_f32 v12, -v140, v60, v12
  s_waitcnt lgkmcnt(1)
  v_mfma_f32_16x16x32_bf16 v[180:183], v[136:139], v[48:51], 0
  v_fma_f32 v13, -v141, v61, v13
  v_fma_f32 v14, -v142, v62, v14
  v_fma_f32 v15, -v143, v63, v15
  v_cvt_pk_bf16_f32 v188, v8, v9
  v_cvt_pk_bf16_f32 v189, v10, v11
  v_mfma_f32_16x16x32_bf16 v[184:187], v[136:139], v[52:55], 0
  v_cvt_pk_bf16_f32 v190, v12, v13
  v_cvt_pk_bf16_f32 v191, v14, v15
  v_mul_f32 v16, v148, v64
  v_mul_f32 v17, v149, v65
  v_mul_f32 v18, v150, v66
  v_mfma_f32_16x16x32_bf16 v[212:215], v[188:191], v[80:83], 0
  v_mul_f32 v19, v151, v67
  v_mul_f32 v20, v152, v64
  v_mul_f32 v21, v153, v65
  v_mul_f32 v22, v154, v66
  v_mul_f32 v23, v155, v67
  v_fmac_f32 v16, v152, v68
  v_fmac_f32 v17, v153, v69
  v_mfma_f32_16x16x32_bf16 v[216:219], v[188:191], v[84:87], 0
  v_fmac_f32 v18, v154, v70
  v_fmac_f32 v19, v155, v71
  v_fma_f32 v20, -v148, v68, v20
  v_fma_f32 v21, -v149, v69, v21
  v_fma_f32 v22, -v150, v70, v22
  v_fma_f32 v23, -v151, v71, v23
  v_cvt_pk_bf16_f32 v192, v16, v17
  v_mfma_f32_16x16x32_bf16 v[220:223], v[188:191], v[88:91], 0
  v_cvt_pk_bf16_f32 v193, v18, v19
  v_cvt_pk_bf16_f32 v194, v20, v21
  v_cvt_pk_bf16_f32 v195, v22, v23
  v_mul_f32 v24, v156, v72
  v_mul_f32 v25, v157, v73
  v_mul_f32 v26, v158, v74
  v_mfma_f32_16x16x32_bf16 v[212:215], v[192:195], v[92:95], v[212:215]
  v_mul_f32 v27, v159, v75
  v_mul_f32 v28, v160, v72
  v_mul_f32 v29, v161, v73
  v_mul_f32 v30, v162, v74
  v_mul_f32 v31, v163, v75
  v_fmac_f32 v24, v160, v76
  v_fmac_f32 v25, v161, v77
  v_mfma_f32_16x16x32_bf16 v[216:219], v[192:195], v[96:99], v[216:219]
  v_fmac_f32 v26, v162, v78
  v_fmac_f32 v27, v163, v79
  v_fma_f32 v28, -v156, v76, v28
  v_fma_f32 v29, -v157, v77, v29
  v_fma_f32 v30, -v158, v78, v30
  v_fma_f32 v31, -v159, v79, v31
  v_cvt_pk_bf16_f32 v196, v24, v25
  v_mfma_f32_16x16x32_bf16 v[220:223], v[192:195], v[100:103], v[220:223]
  v_cvt_pk_bf16_f32 v197, v26, v27
  v_cvt_pk_bf16_f32 v198, v28, v29
  v_cvt_pk_bf16_f32 v199, v30, v31
  v_mul_f32 v32, v164, v56
  v_mul_f32 v33, v165, v57
  v_mul_f32 v34, v166, v58
  v_mfma_f32_16x16x32_bf16 v[212:215], v[196:199], v[104:107], v[212:215]
  v_mul_f32 v35, v167, v59
  v_mul_f32 v36, v168, v56
  v_mul_f32 v37, v169, v57
  v_mul_f32 v38, v170, v58
  v_mul_f32 v39, v171, v59
  v_fmac_f32 v32, v168, v60
  v_fmac_f32 v33, v169, v61
  v_mfma_f32_16x16x32_bf16 v[216:219], v[196:199], v[108:111], v[216:219]
  v_fmac_f32 v34, v170, v62
  v_fmac_f32 v35, v171, v63
  v_fma_f32 v36, -v164, v60, v36
  v_fma_f32 v37, -v165, v61, v37
  v_fma_f32 v38, -v166, v62, v38
  v_fma_f32 v39, -v167, v63, v39
  v_cvt_pk_bf16_f32 v200, v32, v33
  v_mfma_f32_16x16x32_bf16 v[220:223], v[196:199], v[112:115], v[220:223]
  v_cvt_pk_bf16_f32 v201, v34, v35
  v_cvt_pk_bf16_f32 v202, v36, v37
  v_cvt_pk_bf16_f32 v203, v38, v39
  v_mul_f32 v8, v172, v64
  v_mul_f32 v9, v173, v65
  v_mul_f32 v10, v174, v66
  v_mfma_f32_16x16x32_bf16 v[224:227], v[200:203], v[80:83], 0
  v_mul_f32 v11, v175, v67
  v_mul_f32 v12, v176, v64
  v_mul_f32 v13, v177, v65
  v_mul_f32 v14, v178, v66
  v_mul_f32 v15, v179, v67
  v_fmac_f32 v8, v176, v68
  v_fmac_f32 v9, v177, v69
  v_mfma_f32_16x16x32_bf16 v[228:231], v[200:203], v[84:87], 0
  v_fmac_f32 v10, v178, v70
  v_fmac_f32 v11, v179, v71
  v_fma_f32 v12, -v172, v68, v12
  v_fma_f32 v13, -v173, v69, v13
  v_fma_f32 v14, -v174, v70, v14
  v_fma_f32 v15, -v175, v71, v15
  v_cvt_pk_bf16_f32 v204, v8, v9
  v_mfma_f32_16x16x32_bf16 v[232:235], v[200:203], v[88:91], 0
  v_cvt_pk_bf16_f32 v205, v10, v11
  v_cvt_pk_bf16_f32 v206, v12, v13
  v_cvt_pk_bf16_f32 v207, v14, v15
  v_cvt_pk_bf16_f32 v236, v212, v213
  v_cvt_pk_bf16_f32 v237, v214, v215
  buffer_store_dwordx2 v[236:237], v40, s[28:31], s50 offen offset:0 sc1
  v_cvt_pk_bf16_f32 v238, v216, v217
  v_cvt_pk_bf16_f32 v239, v218, v219
  v_mfma_f32_16x16x32_bf16 v[224:227], v[204:207], v[92:95], v[224:227]
  buffer_store_dwordx2 v[238:239], v40, s[28:31], s50 offen offset:512 sc1
  v_cvt_pk_bf16_f32 v240, v220, v221
  v_cvt_pk_bf16_f32 v241, v222, v223
  buffer_store_dwordx2 v[240:241], v41, s[28:31], s50 offen offset:1024 sc1
  v_mul_f32 v16, v180, v72
  v_mul_f32 v17, v181, v73
  v_mul_f32 v18, v182, v74
  v_mul_f32 v19, v183, v75
  v_mul_f32 v20, v184, v72
  v_mul_f32 v21, v185, v73
  v_mfma_f32_16x16x32_bf16 v[228:231], v[204:207], v[96:99], v[228:231]
  v_mul_f32 v22, v186, v74
  v_mul_f32 v23, v187, v75
  v_fmac_f32 v16, v184, v76
  v_fmac_f32 v17, v185, v77
  v_fmac_f32 v18, v186, v78
  v_fmac_f32 v19, v187, v79
  v_fma_f32 v20, -v180, v76, v20
  v_fma_f32 v21, -v181, v77, v21
  v_fma_f32 v22, -v182, v78, v22
  v_mfma_f32_16x16x32_bf16 v[232:235], v[204:207], v[100:103], v[232:235]
  v_fma_f32 v23, -v183, v79, v23
  v_cvt_pk_bf16_f32 v208, v16, v17
  v_cvt_pk_bf16_f32 v209, v18, v19
  v_cvt_pk_bf16_f32 v210, v20, v21
  v_cvt_pk_bf16_f32 v211, v22, v23
  s_cmp_ge_u32 s3, 5
  s_cbranch_scc1 A_NP
  buffer_load_dwordx2 v[42:43], v46, s[28:31], s47 offen sc1
A_NP:
  v_mfma_f32_16x16x32_bf16 v[224:227], v[208:211], v[104:107], v[224:227]
  v_mfma_f32_16x16x32_bf16 v[228:231], v[208:211], v[108:111], v[228:231]
  v_mfma_f32_16x16x32_bf16 v[232:235], v[208:211], v[112:115], v[232:235]
  s_nop 5
  v_cvt_pk_bf16_f32 v242, v224, v225
  v_cvt_pk_bf16_f32 v243, v226, v227
  buffer_store_dwordx2 v[242:243], v40, s[28:31], s50 offen offset:1280 sc1
  v_cvt_pk_bf16_f32 v244, v228, v229
  v_cvt_pk_bf16_f32 v245, v230, v231
  buffer_store_dwordx2 v[244:245], v40, s[28:31], s50 offen offset:1792 sc1
  v_cvt_pk_bf16_f32 v246, v232, v233
  v_cvt_pk_bf16_f32 v247, v234, v235
  buffer_store_dwordx2 v[246:247], v41, s[28:31], s50 offen offset:2304 sc1
  s_waitcnt vmcnt(11)
  v_readfirstlane_b32 s10, v248
  v_readfirstlane_b32 s11, v249
  s_sub_u32 s22, s10, s100
  s_cmp_eq_u32 s10, 0
  s_cselect_b32 s22, 0x80000000, s22
  s_cmp_gt_i32 s22, -400
  s_cbranch_scc1 A_TOKOK
  s_mov_b32 s23, 0
  v_mov_b32 v16, 0
A_TOKL:
  global_load_dwordx2 v[248:249], v16, s[14:15] sc1
  s_waitcnt vmcnt(0)
  v_readfirstlane_b32 s10, v248
  v_readfirstlane_b32 s11, v249
  s_sub_u32 s22, s10, s100
  s_cmp_eq_u32 s10, 0
  s_cselect_b32 s22, 0x80000000, s22
  s_cmp_gt_i32 s22, -400
  s_cbranch_scc1 A_TOKOK
  s_cmp_eq_u32 s10, 0
  s_cselect_b32 s22, 1, 64
  s_add_u32 s23, s23, s22
  s_cmp_lt_u32 s23, 4000
  s_cbranch_scc1 A_TOKL
A_TOKOK:
  s_nop 3
  s_waitcnt vmcnt(6)
  s_branch PH2
R_B2:
  s_load_dwordx2 s[28:29], s[0:1], 104
  s_load_dwordx2 s[24:25], s[0:1], 72
  s_load_dwordx2 s[32:33], s[0:1], 80
  s_load_dwordx2 s[40:41], s[0:1], 88
  s_load_dwordx2 s[36:37], s[0:1], 40
  s_mov_b32 s30, 0x51a000
  s_mov_b32 s31, 0x20000
  v_lshrrev_b32 v16, 4, v1
  v_bfe_u32 v17, v1, 2, 2
  v_and_b32 v18, 3, v1
  v_lshl_add_u32 v19, v16, 3, v17
  v_lshlrev_b32 v19, 7, v19
  v_lshl_add_u32 v19, v18, 3, v19
  v_bfe_u32 v20, v1, 3, 2
  v_lshl_add_u32 v19, v20, 5, v19
  v_add_u32 v28, s48, v19
  v_xor_b32 v29, 32, v28
  v_xor_b32 v30, 64, v28
  v_xor_b32 v31, 96, v28
  v_bfe_u32 v20, v1, 1, 2
  v_xor_b32 v20, v20, v16
  v_lshlrev_b32 v20, 4, v20
  v_and_b32 v24, 15, v1
  v_lshl_add_u32 v20, v24, 6, v20
  v_add_u32 v20, s48, v20
  v_bfe_u32 v21, v1, 3, 2
  v_xor_b32 v21, v21, v18
  v_lshlrev_b32 v21, 4, v21
  v_lshrrev_b32 v22, 2, v1
  v_lshl_add_u32 v21, v22, 6, v21
  v_add_u32 v21, s48, v21
  v_lshlrev_b32 v22, 12, v22
  v_lshl_add_u32 v22, v18, 4, v22
  v_add_u32 v9, s48, v9
  v_lshl_add_u32 v19, v24, 3, s48
  s_lshl_b32 s59, s45, 18
  s_lshl_b32 s47, s44, 6
  s_add_u32 s59, s59, s47
  s_add_u32 s59, s59, 0x280000
  s_add_u32 s60, s59, 65536
  s_add_u32 s61, s60, 65536
  s_add_u32 s62, s61, 65536
  s_lshl_b32 s50, s45, 6
  s_add_u32 s50, s50, s44
  s_lshl_b32 s50, s50, 6
  s_add_u32 s50, s50, 0x500000
  s_mov_b32 s58, 0xffff0000
  s_lshr_b32 s16, s2, 5
  s_mul_i32 s22, s13, 15
  s_add_u32 s22, s22, 1
  s_lshr_b32 s22, s22, 1
  s_add_u32 s22, s22, s16
  s_and_b32 s23, s13, 1
  s_add_u32 s23, s23, s16
  s_cmp_ge_u32 s23, 8
  s_cselect_b32 s22, 0, s22
  s_cselect_b32 s23, 3, 0
  s_mul_i32 s17, s22, 43
  s_lshr_b32 s17, s17, 7
  s_mul_i32 s18, s17, 3
  s_sub_u32 s18, s22, s18
  s_add_u32 s18, s18, s23
  s_lshl2_add_u32 s17, s17, s19
  s_lshl3_add_u32 s20, s17, s3
  s_lshl_b32 s21, s20, 12
  s_add_u32 s12, s21, 0x280000
  s_mul_i32 s52, s3, 4128
  s_add_u32 s52, s52, 104224
  s_mul_i32 s53, s3, 4352
  s_add_u32 s53, s53, 17664
  s_mov_b32 s26, 0x280000
  s_mov_b32 s27, 0x20000
  s_mov_b32 s30, 0x51a000
  s_mov_b32 s31, 0x20000
  s_mov_b32 s34, 0x500
  s_mov_b32 s35, 0x20000
  s_mov_b32 s38, 0x280000
  s_mov_b32 s39, 0x20000
  s_mov_b32 s42, 0x500000
  s_mov_b32 s43, 0x20000
  s_waitcnt vmcnt(4)
  v_alignbit_b32 v64, v64, v64, 16
  v_alignbit_b32 v65, v65, v65, 16
  ds_write_b64 v9, v[64:65]
  ds_read_b64 v[216:217], v19 offset:0
  ds_read_b64 v[218:219], v19 offset:128
  ds_read_b64 v[220:221], v19 offset:256
  ds_read_b64 v[222:223], v19 offset:384
  ds_read_b64_tr_b16 v[72:73], v28 offset:512
  ds_read_b64_tr_b16 v[74:75], v30 offset:1024
  ds_read_b64_tr_b16 v[76:77], v30 offset:1536
  ds_read_b64_tr_b16 v[78:79], v29 offset:512
  ds_read_b64_tr_b16 v[80:81], v31 offset:1024
  ds_read_b64_tr_b16 v[82:83], v31 offset:1536
  ds_read_b64_tr_b16 v[84:85], v30 offset:512
  ds_read_b64_tr_b16 v[86:87], v28 offset:1024
  ds_read_b64_tr_b16 v[88:89], v28 offset:1536
  ds_read_b64_tr_b16 v[90:91], v31 offset:512
  ds_read_b64_tr_b16 v[92:93], v29 offset:1024
  ds_read_b64_tr_b16 v[94:95], v29 offset:1536
  v_mov_b32 v23, 0
  global_load_dwordx2 v[248:249], v23, s[14:15] sc1
  s_lshl_b32 s23, s20, 1
  s_waitcnt lgkmcnt(0)
  buffer_load_ushort v250, off, s[32:35], s23
  v_alignbit_b32 v112, v73, v72, 16
  v_alignbit_b32 v113, v74, v73, 16
  v_alignbit_b32 v114, v75, v74, 16
  v_alignbit_b32 v115, v76, v75, 16
  v_alignbit_b32 v116, v77, v76, 16
  v_dot2_f32_bf16 v136, v112, v217, 0
  v_dot2_f32_bf16 v137, v73, v217, 0
  v_dot2_f32_bf16 v138, v113, v217, 0
  v_dot2_f32_bf16 v139, v74, v217, 0
  v_dot2_f32_bf16 v140, v114, v217, 0
  v_dot2_f32_bf16 v141, v75, v217, 0
  v_dot2_f32_bf16 v142, v115, v217, 0
  v_dot2_f32_bf16 v143, v76, v217, 0
  v_dot2_f32_bf16 v136, v113, v216, v136
  v_dot2_f32_bf16 v137, v74, v216, v137
  v_dot2_f32_bf16 v138, v114, v216, v138
  v_dot2_f32_bf16 v139, v75, v216, v139
  v_dot2_f32_bf16 v140, v115, v216, v140
  v_dot2_f32_bf16 v141, v76, v216, v141
  v_dot2_f32_bf16 v142, v116, v216, v142
  v_dot2_f32_bf16 v143, v77, v216, v143
  v_alignbit_b32 v118, v79, v78, 16
  v_alignbit_b32 v119, v80, v79, 16
  v_alignbit_b32 v120, v81, v80, 16
  v_alignbit_b32 v121, v82, v81, 16
  v_alignbit_b32 v122, v83, v82, 16
  v_dot2_f32_bf16 v144, v118, v219, 0
  v_dot2_f32_bf16 v145, v79, v219, 0
  v_dot2_f32_bf16 v146, v119, v219, 0
  v_dot2_f32_bf16 v147, v80, v219, 0
  v_dot2_f32_bf16 v148, v120, v219, 0
  v_dot2_f32_bf16 v149, v81, v219, 0
  v_dot2_f32_bf16 v150, v121, v219, 0
  v_dot2_f32_bf16 v151, v82, v219, 0
  v_dot2_f32_bf16 v144, v119, v218, v144
  v_dot2_f32_bf16 v145, v80, v218, v145
  v_dot2_f32_bf16 v146, v120, v218, v146
  v_dot2_f32_bf16 v147, v81, v218, v147
  v_dot2_f32_bf16 v148, v121, v218, v148
  v_dot2_f32_bf16 v149, v82, v218, v149
  v_dot2_f32_bf16 v150, v122, v218, v150
  v_dot2_f32_bf16 v151, v83, v218, v151
  v_alignbit_b32 v124, v85, v84, 16
  v_alignbit_b32 v125, v86, v85, 16
  v_alignbit_b32 v126, v87, v86, 16
  v_alignbit_b32 v127, v88, v87, 16
  v_alignbit_b32 v128, v89, v88, 16
  v_dot2_f32_bf16 v152, v124, v221, 0
  v_dot2_f32_bf16 v153, v85, v221, 0
  v_dot2_f32_bf16 v154, v125, v221, 0
  v_dot2_f32_bf16 v155, v86, v221, 0
  v_dot2_f32_bf16 v156, v126, v221, 0
  v_dot2_f32_bf16 v157, v87, v221, 0
  v_dot2_f32_bf16 v158, v127, v221, 0
  v_dot2_f32_bf16 v159, v88, v221, 0
  v_dot2_f32_bf16 v152, v125, v220, v152
  v_dot2_f32_bf16 v153, v86, v220, v153
  v_dot2_f32_bf16 v154, v126, v220, v154
  v_dot2_f32_bf16 v155, v87, v220, v155
  v_dot2_f32_bf16 v156, v127, v220, v156
  v_dot2_f32_bf16 v157, v88, v220, v157
  v_dot2_f32_bf16 v158, v128, v220, v158
  v_dot2_f32_bf16 v159, v89, v220, v159
  s_waitcnt vmcnt(2)
  ds_read_b64_tr_b16 v[96:97], v28 offset:5120
  ds_read_b64_tr_b16 v[98:99], v28 offset:5632
  ds_read_b64_tr_b16 v[100:101], v29 offset:5120
  ds_read_b64_tr_b16 v[102:103], v29 offset:5632
  ds_read_b64_tr_b16 v[104:105], v30 offset:5120
  ds_read_b64_tr_b16 v[106:107], v30 offset:5632
  ds_read_b64_tr_b16 v[108:109], v31 offset:5120
  ds_read_b64_tr_b16 v[110:111], v31 offset:5632
  v_alignbit_b32 v130, v91, v90, 16
  v_alignbit_b32 v131, v92, v91, 16
  v_alignbit_b32 v132, v93, v92, 16
  v_alignbit_b32 v133, v94, v93, 16
  v_alignbit_b32 v134, v95, v94, 16
  v_dot2_f32_bf16 v160, v130, v223, 0
  v_dot2_f32_bf16 v161, v91, v223, 0
  v_dot2_f32_bf16 v162, v131, v223, 0
  v_dot2_f32_bf16 v163, v92, v223, 0
  v_dot2_f32_bf16 v164, v132, v223, 0
  v_dot2_f32_bf16 v165, v93, v223, 0
  v_dot2_f32_bf16 v166, v133, v223, 0
  v_dot2_f32_bf16 v167, v94, v223, 0
  v_dot2_f32_bf16 v160, v131, v222, v160
  v_dot2_f32_bf16 v161, v92, v222, v161
  v_dot2_f32_bf16 v162, v132, v222, v162
  v_dot2_f32_bf16 v163, v93, v222, v163
  v_dot2_f32_bf16 v164, v133, v222, v164
  v_dot2_f32_bf16 v165, v94, v222, v165
  v_dot2_f32_bf16 v166, v134, v222, v166
  v_dot2_f32_bf16 v167, v95, v222, v167
  s_waitcnt lgkmcnt(7)
  v_lshlrev_b32 v168, 16, v96
  v_and_b32 v169, s58, v96
  v_lshlrev_b32 v170, 16, v97
  v_and_b32 v171, s58, v97
  s_waitcnt lgkmcnt(6)
  v_lshlrev_b32 v172, 16, v98
  v_and_b32 v173, s58, v98
  v_lshlrev_b32 v174, 16, v99
  v_and_b32 v175, s58, v99
  v_pk_mul_f32 v[136:137], v[136:137], v[168:169]
  v_pk_mul_f32 v[138:139], v[138:139], v[170:171]
  v_pk_mul_f32 v[140:141], v[140:141], v[172:173]
  v_pk_mul_f32 v[142:143], v[142:143], v[174:175]
  v_cvt_pk_bf16_f32 v200, v136, v137
  v_cvt_pk_bf16_f32 v201, v138, v139
  v_cvt_pk_bf16_f32 v202, v140, v141
  v_cvt_pk_bf16_f32 v203, v142, v143
  ds_write_b128 v20, v[200:203] offset:0
  ds_read_b128 v[72:75], v21 offset:0
  s_waitcnt lgkmcnt(7)
  v_lshlrev_b32 v176, 16, v100
  v_and_b32 v177, s58, v100
  v_lshlrev_b32 v178, 16, v101
  v_and_b32 v179, s58, v101
  s_waitcnt lgkmcnt(6)
  v_lshlrev_b32 v180, 16, v102
  v_and_b32 v181, s58, v102
  v_lshlrev_b32 v182, 16, v103
  v_and_b32 v183, s58, v103
  v_pk_mul_f32 v[144:145], v[144:145], v[176:177]
  v_pk_mul_f32 v[146:147], v[146:147], v[178:179]
  v_pk_mul_f32 v[148:149], v[148:149], v[180:181]
  v_pk_mul_f32 v[150:151], v[150:151], v[182:183]
  v_cvt_pk_bf16_f32 v204, v144, v145
  v_cvt_pk_bf16_f32 v205, v146, v147
  v_cvt_pk_bf16_f32 v206, v148, v149
  v_cvt_pk_bf16_f32 v207, v150, v151
  ds_write_b128 v20, v[204:207] offset:1024
  ds_read_b128 v[76:79], v21 offset:1024
  s_waitcnt lgkmcnt(2)
  buffer_store_dwordx4 v[72:75], v22, s[28:31], s59 offen sc1
  v_lshlrev_b32 v184, 16, v104
  v_and_b32 v185, s58, v104
  v_lshlrev_b32 v186, 16, v105
  v_and_b32 v187, s58, v105
  v_lshlrev_b32 v188, 16, v106
  v_and_b32 v189, s58, v106
  v_lshlrev_b32 v190, 16, v107
  v_and_b32 v191, s58, v107
  v_pk_mul_f32 v[152:153], v[152:153], v[184:185]
  v_pk_mul_f32 v[154:155], v[154:155], v[186:187]
  v_pk_mul_f32 v[156:157], v[156:157], v[188:189]
  v_pk_mul_f32 v[158:159], v[158:159], v[190:191]
  v_cvt_pk_bf16_f32 v208, v152, v153
  v_cvt_pk_bf16_f32 v209, v154, v155
  v_cvt_pk_bf16_f32 v210, v156, v157
  v_cvt_pk_bf16_f32 v211, v158, v159
  ds_write_b128 v20, v[208:211] offset:2048
  ds_read_b128 v[80:83], v21 offset:2048
  s_waitcnt lgkmcnt(2)
  buffer_store_dwordx4 v[76:79], v22, s[28:31], s60 offen sc1
  v_lshlrev_b32 v192, 16, v108
  v_and_b32 v193, s58, v108
  v_lshlrev_b32 v194, 16, v109
  v_and_b32 v195, s58, v109
  v_lshlrev_b32 v196, 16, v110
  v_and_b32 v197, s58, v110
  v_lshlrev_b32 v198, 16, v111
  v_and_b32 v199, s58, v111
  v_pk_mul_f32 v[160:161], v[160:161], v[192:193]
  v_pk_mul_f32 v[162:163], v[162:163], v[194:195]
  v_pk_mul_f32 v[164:165], v[164:165], v[196:197]
  v_pk_mul_f32 v[166:167], v[166:167], v[198:199]
  v_cvt_pk_bf16_f32 v212, v160, v161
  v_cvt_pk_bf16_f32 v213, v162, v163
  v_cvt_pk_bf16_f32 v214, v164, v165
  v_cvt_pk_bf16_f32 v215, v166, v167
  ds_write_b128 v20, v[212:215] offset:3072
  ds_read_b128 v[84:87], v21 offset:3072
  s_waitcnt lgkmcnt(2)
  buffer_store_dwordx4 v[80:83], v22, s[28:31], s61 offen sc1
  s_waitcnt lgkmcnt(0)
  buffer_store_dwordx4 v[84:87], v22, s[28:31], s62 offen sc1
  s_waitcnt vmcnt(5)
  v_readfirstlane_b32 s10, v248
  v_readfirstlane_b32 s11, v249
  s_sub_u32 s22, s10, s100
  s_cmp_eq_u32 s10, 0
  s_cselect_b32 s22, 0x80000000, s22
  s_cmp_gt_i32 s22, -400
  s_cbranch_scc1 B_TOKOK
  s_mov_b32 s23, 0
  v_mov_b32 v23, 0
B_TOKL:
  global_load_dwordx2 v[248:249], v23, s[14:15] sc1
  s_waitcnt vmcnt(0)
  v_readfirstlane_b32 s10, v248
  v_readfirstlane_b32 s11, v249
  s_sub_u32 s22, s10, s100
  s_cmp_eq_u32 s10, 0
  s_cselect_b32 s22, 0x80000000, s22
  s_cmp_gt_i32 s22, -400
  s_cbranch_scc1 B_TOKOK
  s_cmp_eq_u32 s10, 0
  s_cselect_b32 s22, 1, 64
  s_add_u32 s23, s23, s22
  s_cmp_lt_u32 s23, 4000
  s_cbranch_scc1 B_TOKL
B_TOKOK:
  s_nop 3
  v_add_u32 v4, v17, v18
  v_lshl_add_u32 v4, v16, 3, v4
  s_sub_u32 s23, s52, 24
  v_lshl_add_u32 v4, v4, 3, s23
  v_lshlrev_b32 v5, 2, v18
  v_sub_u32 v5, v5, v17
  v_lshlrev_b32 v19, 3, v16
  v_sub_u32 v5, v5, v19
  s_sub_u32 s23, s53, 8
  v_lshl_add_u32 v5, v5, 3, s23
  s_mul_i32 s23, s3, 1600
  v_lshl_add_u32 v6, v1, 3, s23
  v_and_b32 v19, 1, v18
  v_lshl_add_u32 v19, v19, 2, v17
  v_mul_u32_u24 v7, 1600, v19
  v_lshrrev_b32 v19, 1, v18
  v_lshl_add_u32 v19, v16, 1, v19
  v_lshl_add_u32 v19, v2, 3, v19
  v_lshl_add_u32 v7, v19, 3, v7
  v_lshrrev_b32 v20, 3, v1
  v_lshrrev_b32 v46, 2, v1
  v_min_u32 v46, 12, v46
  s_mul_i32 s23, s3, 13
  v_add_u32 v46, s23, v46
  s_lshl_b32 s23, s18, 3
  s_lshr_b32 s23, 0x3f27373f, s23
  s_and_b32 s23, s23, 63
  v_min_u32 v46, s23, v46
  v_lshlrev_b32 v46, 6, v46
  v_lshl_add_u32 v19, v2, 3, v20
  v_lshl_add_u32 v19, v18, 6, v19
  v_mul_u32_u24 v19, 1280, v19
  v_and_b32 v21, 4, v1
  v_lshl_add_u32 v45, v21, 27, v19
  v_lshlrev_b32 v44, 1, v45
  v_and_b32 v19, 7, v1
  v_lshl_add_u32 v19, v20, 8, v19
  s_cmp_eq_u32 s18, 0
  s_cselect_b32 s62, 640, 0
  s_cselect_b32 s63, 0, 512
  v_and_b32 v21, 2, v20
  v_mad_u32_u24 v19, v21, s62, v19
  v_mul_u32_u24 v19, 1280, v19
  s_cmp_eq_u32 s18, 1
  s_cselect_b32 s63, 1280, s63
  s_cselect_b32 s23, 15, 23
  v_cmp_lt_u32 vcc, s23, v1
  s_nop 1
  v_cndmask_b32 v47, v19, -1, vcc
  s_lshl3_add_u32 s62, s19, s3
  s_lshl3_add_u32 s62, s62, s63
  s_mul_i32 s62, s62, 1280
  s_lshr_b32 s63, s17, 2
  s_lshl_b32 s63, s63, 6
  s_add_u32 s62, s62, s63
  s_and_b32 s47, s17, 120
  s_lshl_b32 s47, s47, 9
  s_add_u32 s47, s47, 0x500000
  s_lshl_b32 s54, s17, 4
  s_mov_b32 s55, 0xffff0000
  v_mov_b32 v21, 0
  s_sub_u32 s23, s52, 32
  v_and_b32 v19, 7, v1
  v_lshl_add_u32 v19, v19, 2, s23
  ds_write_b32 v19, v21
  s_waitcnt vmcnt(0)
  s_mov_b64 exec, 1
  buffer_store_dwordx2 v[248:249], off, s[28:31], s50 sc1
  s_mov_b64 exec, -1
  s_barrier
  s_add_u32 s68, s4, TBL2-concat_heads__spectral_fnet__ssm_conv_h3__prompt_kernel-4
  s_addc_u32 s69, s5, 0
  s_mov_b32 s70, 0x8000
  s_mov_b32 s71, 0x20000
  s_mul_i32 s50, s3, 7168
  s_min_u32 s50, s50, 25600
  s_add_u32 m0, s50, 71424
  s_nop 0
  buffer_load_dwordx4 v3, s[68:71], s50 offen offset:0 lds
  buffer_load_dwordx4 v3, s[68:71], s50 offen offset:1024 lds
  buffer_load_dwordx4 v3, s[68:71], s50 offen offset:2048 lds
  buffer_load_dwordx4 v3, s[68:71], s50 offen offset:3072 lds
  s_add_u32 s50, s50, 4096
  s_add_u32 m0, s50, 71424
  s_nop 0
  buffer_load_dwordx4 v3, s[68:71], s50 offen offset:0 lds
  buffer_load_dwordx4 v3, s[68:71], s50 offen offset:1024 lds
  buffer_load_dwordx4 v3, s[68:71], s50 offen offset:2048 lds
  s_branch R_BJ
R_PF:
  s_load_dwordx2 s[28:29], s[0:1], 104
  s_load_dwordx2 s[24:25], s[0:1], 72
  s_load_dwordx2 s[32:33], s[0:1], 80
  s_load_dwordx2 s[40:41], s[0:1], 88
  s_load_dwordx2 s[36:37], s[0:1], 40
  s_sub_u32 s44, s3, 5
  s_mul_i32 s45, s8, 3
  s_add_u32 s45, s45, s44
  s_lshl_b32 s46, s45, 10
  s_mov_b32 s6, PF_END-concat_heads__spectral_fnet__ssm_conv_h3__prompt_kernel-4
  s_mov_b32 s7, 0x20000
  buffer_load_dwordx4 v[240:243], v3, s[4:7], s46 offen
  s_add_u32 s46, s46, 49152
  buffer_load_dwordx4 v[240:243], v3, s[4:7], s46 offen
  s_lshr_b32 s16, s2, 5
  s_mul_i32 s22, s13, 15
  s_add_u32 s22, s22, 1
  s_lshr_b32 s22, s22, 1
  s_add_u32 s22, s22, s16
  s_and_b32 s23, s13, 1
  s_add_u32 s23, s23, s16
  s_cmp_ge_u32 s23, 8
  s_cselect_b32 s22, 0, s22
  s_cselect_b32 s23, 3, 0
  s_mul_i32 s17, s22, 43
  s_lshr_b32 s17, s17, 7
  s_mul_i32 s18, s17, 3
  s_sub_u32 s18, s22, s18
  s_add_u32 s18, s18, s23
  s_lshl2_add_u32 s17, s17, s19
  s_lshl3_add_u32 s20, s17, s3
  s_lshl_b32 s21, s20, 12
  s_add_u32 s12, s21, 0x280000
  s_mul_i32 s52, s3, 4128
  s_add_u32 s52, s52, 104224
  s_mul_i32 s53, s3, 4352
  s_add_u32 s53, s53, 17664
  s_mov_b32 s26, 0x280000
  s_mov_b32 s27, 0x20000
  s_mov_b32 s30, 0x51a000
  s_mov_b32 s31, 0x20000
  s_mov_b32 s34, 0x500
  s_mov_b32 s35, 0x20000
  s_mov_b32 s38, 0x280000
  s_mov_b32 s39, 0x20000
  s_mov_b32 s42, 0x500000
  s_mov_b32 s43, 0x20000
  v_lshrrev_b32 v16, 4, v1
  v_bfe_u32 v17, v1, 2, 2
  v_and_b32 v18, 3, v1
  v_add_u32 v4, v17, v18
  v_lshl_add_u32 v4, v16, 3, v4
  s_sub_u32 s23, s52, 24
  v_lshl_add_u32 v4, v4, 3, s23
  v_lshlrev_b32 v5, 2, v18
  v_sub_u32 v5, v5, v17
  v_lshlrev_b32 v19, 3, v16
  v_sub_u32 v5, v5, v19
  s_sub_u32 s23, s53, 8
  v_lshl_add_u32 v5, v5, 3, s23
  s_mul_i32 s23, s3, 1600
  v_lshl_add_u32 v6, v1, 3, s23
  v_and_b32 v19, 1, v18
  v_lshl_add_u32 v19, v19, 2, v17
  v_mul_u32_u24 v7, 1600, v19
  v_lshrrev_b32 v19, 1, v18
  v_lshl_add_u32 v19, v16, 1, v19
  v_lshl_add_u32 v19, v2, 3, v19
  v_lshl_add_u32 v7, v19, 3, v7
  v_lshrrev_b32 v20, 3, v1
  v_lshrrev_b32 v46, 2, v1
  v_min_u32 v46, 12, v46
  s_mul_i32 s23, s3, 13
  v_add_u32 v46, s23, v46
  s_lshl_b32 s23, s18, 3
  s_lshr_b32 s23, 0x3f27373f, s23
  s_and_b32 s23, s23, 63
  v_min_u32 v46, s23, v46
  v_lshlrev_b32 v46, 6, v46
  v_lshl_add_u32 v19, v2, 3, v20
  v_lshl_add_u32 v19, v18, 6, v19
  v_mul_u32_u24 v19, 1280, v19
  v_and_b32 v21, 4, v1
  v_lshl_add_u32 v45, v21, 27, v19
  v_lshlrev_b32 v44, 1, v45
  v_and_b32 v19, 7, v1
  v_lshl_add_u32 v19, v20, 8, v19
  s_cmp_eq_u32 s18, 0
  s_cselect_b32 s62, 640, 0
  s_cselect_b32 s63, 0, 512
  v_and_b32 v21, 2, v20
  v_mad_u32_u24 v19, v21, s62, v19
  v_mul_u32_u24 v19, 1280, v19
  s_cmp_eq_u32 s18, 1
  s_cselect_b32 s63, 1280, s63
  s_cselect_b32 s23, 15, 23
  v_cmp_lt_u32 vcc, s23, v1
  s_nop 1
  v_cndmask_b32 v47, v19, -1, vcc
  s_lshl3_add_u32 s62, s19, s3
  s_lshl3_add_u32 s62, s62, s63
  s_mul_i32 s62, s62, 1280
  s_lshr_b32 s63, s17, 2
  s_lshl_b32 s63, s63, 6
  s_add_u32 s62, s62, s63
  s_and_b32 s47, s17, 120
  s_lshl_b32 s47, s47, 9
  s_add_u32 s47, s47, 0x500000
  s_lshl_b32 s54, s17, 4
  s_mov_b32 s55, 0xffff0000
  v_mov_b32 v21, 0
  s_sub_u32 s23, s52, 32
  v_and_b32 v19, 7, v1
  v_lshl_add_u32 v19, v19, 2, s23
  ds_write_b32 v19, v21
  s_mul_i32 s46, s44, 3
  s_add_u32 s48, s46, 0
  s_min_u32 s48, s48, 7
  s_lshl3_add_u32 s56, s17, s48
  s_lshl_b32 s56, s56, 12
  s_mul_i32 s59, s48, 4128
  s_add_u32 s59, s59, 104224
  s_add_u32 s48, s46, 1
  s_min_u32 s48, s48, 7
  s_lshl3_add_u32 s57, s17, s48
  s_lshl_b32 s57, s57, 12
  s_mul_i32 s60, s48, 4128
  s_add_u32 s60, s60, 104224
  s_add_u32 s48, s46, 2
  s_min_u32 s48, s48, 7
  s_lshl3_add_u32 s58, s17, s48
  s_lshl_b32 s58, s58, 12
  s_mul_i32 s61, s48, 4128
  s_add_u32 s61, s61, 104224
  s_waitcnt vmcnt(0)
  s_lshl_b32 s23, s20, 1
  s_waitcnt lgkmcnt(0)
  buffer_load_ushort v250, off, s[32:35], s23
  v_mov_b32 v23, 0
  global_load_dwordx2 v[248:249], v23, s[14:15] sc1
  s_waitcnt vmcnt(0)
  v_readfirstlane_b32 s10, v248
  v_readfirstlane_b32 s11, v249
  s_sub_u32 s22, s10, s100
  s_cmp_eq_u32 s10, 0
  s_cselect_b32 s22, 0x80000000, s22
  s_cmp_gt_i32 s22, -400
  s_cbranch_scc1 PF_TOKOK
  s_mov_b32 s23, 0
  v_mov_b32 v23, 0
PF_TOKL:
  global_load_dwordx2 v[248:249], v23, s[14:15] sc1
  s_waitcnt vmcnt(0)
  v_readfirstlane_b32 s10, v248
  v_readfirstlane_b32 s11, v249
  s_sub_u32 s22, s10, s100
  s_cmp_eq_u32 s10, 0
  s_cselect_b32 s22, 0x80000000, s22
  s_cmp_gt_i32 s22, -400
  s_cbranch_scc1 PF_TOKOK
  s_cmp_eq_u32 s10, 0
  s_cselect_b32 s22, 1, 64
  s_add_u32 s23, s23, s22
  s_cmp_lt_u32 s23, 4000
  s_cbranch_scc1 PF_TOKL
PF_TOKOK:
  s_nop 3
  s_barrier
  s_cmp_eq_u32 s18, 3
  s_cbranch_scc1 PF_H3
  s_mov_b32 m0, s59
  s_nop 0
  buffer_load_dwordx4 v3, s[24:27], s56 offen offset:0 lds
  s_mov_b32 m0, s60
  s_nop 0
  buffer_load_dwordx4 v3, s[24:27], s57 offen offset:0 lds
  s_mov_b32 m0, s61
  s_nop 0
  buffer_load_dwordx4 v3, s[24:27], s58 offen offset:0 lds
  s_mov_b32 m0, s59
  s_nop 0
  buffer_load_dwordx4 v3, s[24:27], s56 offen offset:1024 lds
  s_mov_b32 m0, s60
  s_nop 0
  buffer_load_dwordx4 v3, s[24:27], s57 offen offset:1024 lds
  s_mov_b32 m0, s61
  s_nop 0
  buffer_load_dwordx4 v3, s[24:27], s58 offen offset:1024 lds
  s_cmp_eq_u32 s18, 2
  s_cselect_b32 exec_hi, 0, -1
  s_mov_b32 m0, s59
  s_nop 0
  buffer_load_dwordx4 v3, s[24:27], s56 offen offset:2048 lds
  s_mov_b32 m0, s60
  s_nop 0
  buffer_load_dwordx4 v3, s[24:27], s57 offen offset:2048 lds
  s_mov_b32 m0, s61
  s_nop 0
  buffer_load_dwordx4 v3, s[24:27], s58 offen offset:2048 lds
  s_cbranch_scc1 PF_H3
  s_mov_b32 m0, s59
  s_nop 0
  buffer_load_dwordx4 v3, s[24:27], s56 offen offset:3072 lds
  s_mov_b32 m0, s60
  s_nop 0
  buffer_load_dwordx4 v3, s[24:27], s57 offen offset:3072 lds
  s_mov_b32 m0, s61
  s_nop 0
  buffer_load_dwordx4 v3, s[24:27], s58 offen offset:3072 lds
PF_H3:
  s_mov_b32 exec_hi, -1
R_BJ:
  s_nop 1
  s_mov_b32 s49, 0x7ff00000
  v_mov_b32 v42, 0
  s_lshr_b32 s45, s13, 1
  s_lshl2_add_u32 s45, s45, s19
  s_bfe_u32 s46, s9, 0x10001
  s_add_u32 s46, s46, 8
  s_cmp_eq_u32 s18, 3
  s_cselect_b32 s46, 5, s46
  s_mul_i32 s22, s17, 205
  s_lshr_b32 s22, s22, 10
  s_mul_i32 s23, s22, 5
  s_sub_u32 s23, s17, s23
  s_cmp_eq_u32 s18, 2
  s_cselect_b32 s45, s22, s45
  s_cselect_b32 s46, s23, s46
  v_lshrrev_b32 v60, 3, v1
  v_and_b32 v61, 7, v1
  v_and_b32 v62, 2, v60
  v_xor_b32 v61, v61, v62
  v_mul_u32_u24 v62, 2560, v60
  v_lshl_add_u32 v62, v61, 4, v62
  v_xor_b32 v63, 64, v62
  s_lshr_b32 s60, s45, 1
  s_lshl3_add_u32 s60, s60, s3
  s_lshl_b32 s60, s60, 5
  s_and_b32 s61, s45, 1
  s_add_u32 s60, s60, s61
  s_mul_i32 s60, s60, 1280
  s_lshl_b32 s61, s46, 7
  s_add_u32 s60, s60, s61
  s_add_u32 s61, s60, 20480
  s_lshl_b32 s44, s3, 11
  v_lshrrev_b32 v61, 2, v1
  v_lshlrev_b32 v61, 6, v61
  s_lshr_b32 s59, s45, 1
  s_lshl3_add_u32 s59, s59, s3
  s_lshl_b32 s59, s59, 10
  s_add_u32 s59, s59, 0x50a000
  v_lshrrev_b32 v52, 4, v1
  v_lshl_add_u32 v0, v2, 2, v52
  v_mul_u32_u24 v0, 163840, v0
  v_and_b32 v53, 15, v1
  v_lshl_add_u32 v0, v53, 3, v0
  v_bfe_u32 v53, v1, 2, 2
  v_and_b32 v54, 3, v1
  v_bfe_u32 v55, v1, 3, 2
  v_lshlrev_b32 v60, 10, v52
  v_lshl_add_u32 v60, v53, 7, v60
  v_lshl_add_u32 v60, v54, 3, v60
  v_lshl_add_u32 v60, v55, 5, v60
  s_mul_i32 s64, s45, 2560
  s_lshl_b32 s65, s46, 7
  s_add_u32 s64, s64, s65
  s_add_u32 s65, s64, 40960
  s_add_u32 s66, s65, 40960
  s_add_u32 s67, s66, 40960
PH2:
  s_nop 1
  s_cmp_eq_u32 s18, 1
  s_cbranch_scc1 P_1
  s_cmp_eq_u32 s18, 0
  s_cbranch_scc1 P_0
  s_cmp_eq_u32 s18, 3
  s_cbranch_scc1 P_3
  s_cmp_ge_u32 s3, 5
  s_cbranch_scc1 PU2_OK
  v_cmp_ne_u64 vcc, s[10:11], v[42:43]
  s_nop 0
  s_cbranch_vccz PU2_OK
  s_mov_b32 s23, 0
PU2_L:
  buffer_load_dwordx2 v[42:43], v46, s[28:31], s47 offen sc1
  s_add_u32 s23, s23, 1
  s_waitcnt vmcnt(0)
  v_cmp_ne_u64 vcc, s[10:11], v[42:43]
  s_cmp_ge_u32 s23, 4000
  s_cbranch_scc1 PU2_OK
  s_cbranch_vccnz PU2_L
PU2_OK:
  s_barrier
  s_mov_b32 m0, s53
  s_nop 0
  buffer_load_dwordx4 v3, s[28:31], s12 offen offset:1024 sc1 lds
  buffer_load_dwordx4 v3, s[28:31], s12 offen offset:0 sc1 lds
  s_mov_b32 exec_hi, 0
  buffer_load_dwordx4 v3, s[28:31], s12 offen offset:2048 sc1 lds
  s_mov_b32 exec_hi, -1
  v_mov_b32 v16, 0
  s_sub_u32 s22, s53, 256
  v_lshl_add_u32 v17, v1, 2, s22
  ds_write_b32 v17, v16
  s_waitcnt vmcnt(3)
  s_barrier
  v_mov_b32 v52, s52
  ds_read_u16 v251, v52
  ds_read_b64_tr_b16 v[68:69], v4 offset:256
  ds_read_b64_tr_b16 v[70:71], v4 offset:288
  ds_read_b64_tr_b16 v[72:73], v4 offset:512
  ds_read_b64_tr_b16 v[74:75], v4 offset:544
  ds_read_b64_tr_b16 v[76:77], v4 offset:768
  ds_read_b64_tr_b16 v[78:79], v4 offset:800
  v_lshlrev_b32 v250, 16, v250
  s_waitcnt lgkmcnt(6)
  v_lshlrev_b32 v251, 16, v251
  v_add_f32 v250, v250, v251
  v_cvt_pk_bf16_f32 v250, v250, v250
  ds_write_b16 v52, v250
  ds_read_b64_tr_b16 v[64:65], v4 offset:0
  ds_read_b64_tr_b16 v[66:67], v4 offset:32
  buffer_load_dword v43, v47, s[36:39], s62 offen
  s_cmp_lt_u32 s3, 4
  s_cbranch_scc1 PRIO2
  s_setprio 1
PRIO2:
  s_waitcnt vmcnt(3)
  ds_read_b64_tr_b16 v[172:173], v5 offset:1440
  ds_read_b64_tr_b16 v[174:175], v5 offset:1408
  ds_read_b64_tr_b16 v[168:169], v5 offset:1312
  ds_read_b64_tr_b16 v[170:171], v5 offset:1280
  s_waitcnt vmcnt(2)
  ds_read_b64_tr_b16 v[164:165], v5 offset:1184
  ds_read_b64_tr_b16 v[166:167], v5 offset:1152
  ds_read_b64_tr_b16 v[160:161], v5 offset:1056
  ds_read_b64_tr_b16 v[162:163], v5 offset:1024
  ds_read_b64_tr_b16 v[156:157], v5 offset:928
  ds_read_b64_tr_b16 v[158:159], v5 offset:896
  s_waitcnt lgkmcnt(8)
  v_mfma_f32_16x16x32_bf16 v[56:59], v[172:175], v[64:67], 0
  ds_read_b64_tr_b16 v[152:153], v5 offset:800
  ds_read_b64_tr_b16 v[154:155], v5 offset:768
  s_waitcnt lgkmcnt(8)
  v_mfma_f32_16x16x32_bf16 v[20:23], v[168:171], v[64:67], 0
  v_lshl_add_u32 v220, v2, 12, v3
  v_add_u32 v220, 71424, v220
  ds_read_b64_tr_b16 v[148:149], v5 offset:672
  ds_read_b64_tr_b16 v[150:151], v5 offset:640
  s_waitcnt lgkmcnt(8)
  v_mfma_f32_16x16x32_bf16 v[16:19], v[164:167], v[64:67], 0
  ds_read_b128 v[232:235], v220 offset:0
  s_waitcnt lgkmcnt(7)
  v_mfma_f32_16x16x32_bf16 v[12:15], v[160:163], v[64:67], 0
  ds_read_b128 v[236:239], v220 offset:1024
  s_waitcnt lgkmcnt(6)
  v_mfma_f32_16x16x32_bf16 v[8:11], v[156:159], v[64:67], 0
  ds_read_b128 v[240:243], v220 offset:2048
  v_mfma_f32_16x16x32_bf16 v[56:59], v[164:167], v[68:71], v[56:59]
  ds_read_b128 v[244:247], v220 offset:3072
  ds_read_b64_tr_b16 v[144:145], v5 offset:544
  ds_read_b64_tr_b16 v[146:147], v5 offset:512
  v_mfma_f32_16x16x32_bf16 v[20:23], v[160:163], v[68:71], v[20:23]
  v_xor_b32 v248, 0, v60
  ds_read_b64_tr_b16 v[140:141], v5 offset:416
  ds_read_b64_tr_b16 v[142:143], v5 offset:384
  v_mfma_f32_16x16x32_bf16 v[16:19], v[156:159], v[68:71], v[16:19]
  v_xor_b32 v249, 32, v60
  s_waitcnt lgkmcnt(10)
  v_mfma_f32_16x16x32_bf16 v[12:15], v[152:155], v[68:71], v[12:15]
  v_xor_b32 v250, 64, v60
  s_waitcnt lgkmcnt(8)
  v_mfma_f32_16x16x32_bf16 v[8:11], v[148:151], v[68:71], v[8:11]
  v_xor_b32 v251, 96, v60
  v_mfma_f32_16x16x32_bf16 v[56:59], v[156:159], v[72:75], v[56:59]
  ds_read_b64_tr_b16 v[136:137], v5 offset:288
  ds_read_b64_tr_b16 v[138:139], v5 offset:256
  v_mfma_f32_16x16x32_bf16 v[20:23], v[152:155], v[72:75], v[20:23]
  ds_read_b64_tr_b16 v[132:133], v5 offset:160
  ds_read_b64_tr_b16 v[134:135], v5 offset:128
  v_mfma_f32_16x16x32_bf16 v[16:19], v[148:151], v[72:75], v[16:19]
  ds_read_b64_tr_b16 v[80:81], v4 offset:1024
  ds_read_b64_tr_b16 v[82:83], v4 offset:1056
  s_waitcnt lgkmcnt(8)
  v_mfma_f32_16x16x32_bf16 v[12:15], v[144:147], v[72:75], v[12:15]
  s_waitcnt lgkmcnt(6)
  v_mfma_f32_16x16x32_bf16 v[8:11], v[140:143], v[72:75], v[8:11]
  v_mfma_f32_16x16x32_bf16 v[56:59], v[148:151], v[76:79], v[56:59]
  ds_read_b64_tr_b16 v[128:129], v5 offset:32
  ds_read_b64_tr_b16 v[130:131], v5 offset:0
  v_mfma_f32_16x16x32_bf16 v[20:23], v[144:147], v[76:79], v[20:23]
  ds_read_b64_tr_b16 v[84:85], v4 offset:1280
  ds_read_b64_tr_b16 v[86:87], v4 offset:1312
  v_mfma_f32_16x16x32_bf16 v[16:19], v[140:143], v[76:79], v[16:19]
  s_add_u32 s56, s54, 0xa0000
  buffer_load_dwordx4 v[24:27], v45, s[36:39], s56 offen
  s_add_u32 s56, s54, 0x140500
  s_waitcnt lgkmcnt(8)
  v_mfma_f32_16x16x32_bf16 v[12:15], v[136:139], v[76:79], v[12:15]
  ds_read_b64_tr_b16 v[176:177], v5 offset:1568
  ds_read_b64_tr_b16 v[178:179], v5 offset:1536
  s_waitcnt lgkmcnt(8)
  v_mfma_f32_16x16x32_bf16 v[8:11], v[132:135], v[76:79], v[8:11]
  s_waitcnt lgkmcnt(6)
  v_mfma_f32_16x16x32_bf16 v[56:59], v[140:143], v[80:83], v[56:59]
  v_mfma_f32_16x16x32_bf16 v[20:23], v[136:139], v[80:83], v[20:23]
  v_mfma_f32_16x16x32_bf16 v[16:19], v[132:135], v[80:83], v[16:19]
  s_add_u32 s57, s54, 0xf0000
  buffer_load_dwordx4 v[28:31], v45, s[36:39], s57 offen
  s_add_u32 s57, s54, 0x1e0500
  s_waitcnt lgkmcnt(4)
  v_mfma_f32_16x16x32_bf16 v[12:15], v[128:131], v[80:83], v[12:15]
  s_waitcnt lgkmcnt(2)
  v_mfma_f32_16x16x32_bf16 v[56:59], v[132:135], v[84:87], v[56:59]
  ds_read_b64_tr_b16 v[88:89], v4 offset:1536
  ds_read_b64_tr_b16 v[90:91], v4 offset:1568
  v_mfma_f32_16x16x32_bf16 v[20:23], v[128:131], v[84:87], v[20:23]
  ds_read_b64_tr_b16 v[180:181], v5 offset:1696
  ds_read_b64_tr_b16 v[182:183], v5 offset:1664
  s_waitcnt lgkmcnt(4)
  v_mfma_f32_16x16x32_bf16 v[124:127], v[176:179], v[64:67], 0
  v_mfma_f32_16x16x32_bf16 v[124:127], v[168:171], v[68:71], v[124:127]
  s_add_u32 s58, s54, 0x140000
  buffer_load_dwordx4 v[32:35], v45, s[36:39], s58 offen
  s_add_u32 s58, s54, 0x280500
  v_mfma_f32_16x16x32_bf16 v[124:127], v[160:163], v[72:75], v[124:127]
  v_add_f32_dpp v49, v11, v14 wave_ror:1 row_mask:0xf bank_mask:0xf
  v_add_f32_dpp v50, v15, v18 wave_ror:1 row_mask:0xf bank_mask:0xf
  v_add_f32_dpp v51, v19, v22 wave_ror:1 row_mask:0xf bank_mask:0xf
  v_mfma_f32_16x16x32_bf16 v[124:127], v[152:155], v[76:79], v[124:127]
  v_add_f32_dpp v52, v23, v58 wave_ror:1 row_mask:0xf bank_mask:0xf
  v_add_f32_dpp v48, v11, v10 wave_shr:1 row_mask:0xf bank_mask:0xf bound_ctrl:0
  v_add_f32_dpp v49, v15, v14 wave_shr:1 row_mask:0xf bank_mask:0xf
  v_mfma_f32_16x16x32_bf16 v[124:127], v[144:147], v[80:83], v[124:127]
  v_add_f32_dpp v50, v19, v18 wave_shr:1 row_mask:0xf bank_mask:0xf
  v_add_f32_dpp v51, v23, v22 wave_shr:1 row_mask:0xf bank_mask:0xf
  v_add_f32_dpp v52, v59, v58 wave_shr:1 row_mask:0xf bank_mask:0xf
  v_mfma_f32_16x16x32_bf16 v[124:127], v[136:139], v[84:87], v[124:127]
  v_add_f32_dpp v14, v48, v13 wave_ror:1 row_mask:0xf bank_mask:0xf
  v_add_f32_dpp v18, v49, v17 wave_ror:1 row_mask:0xf bank_mask:0xf
  v_add_f32_dpp v22, v50, v21 wave_ror:1 row_mask:0xf bank_mask:0xf
  s_waitcnt lgkmcnt(2)
  v_mfma_f32_16x16x32_bf16 v[124:127], v[128:131], v[88:91], v[124:127]
  v_add_f32_dpp v58, v51, v57 wave_ror:1 row_mask:0xf bank_mask:0xf
  v_add_f32_dpp v10, v48, v9 wave_shr:1 row_mask:0xf bank_mask:0xf bound_ctrl:0
  v_add_f32_dpp v14, v49, v13 wave_shr:1 row_mask:0xf bank_mask:0xf
  ds_read_b64_tr_b16 v[184:185], v5 offset:1824
  ds_read_b64_tr_b16 v[186:187], v5 offset:1792
  s_waitcnt lgkmcnt(2)
  v_mfma_f32_16x16x32_bf16 v[104:107], v[180:183], v[64:67], 0
  v_add_f32_dpp v18, v50, v17 wave_shr:1 row_mask:0xf bank_mask:0xf
  v_add_f32_dpp v22, v51, v21 wave_shr:1 row_mask:0xf bank_mask:0xf
  v_add_f32_dpp v58, v52, v57 wave_shr:1 row_mask:0xf bank_mask:0xf
  v_mfma_f32_16x16x32_bf16 v[104:107], v[172:175], v[68:71], v[104:107]
  v_add_f32_dpp v13, v10, v12 wave_ror:1 row_mask:0xf bank_mask:0xf
  v_add_f32_dpp v17, v14, v16 wave_ror:1 row_mask:0xf bank_mask:0xf
  v_add_f32_dpp v21, v18, v20 wave_ror:1 row_mask:0xf bank_mask:0xf
  v_mfma_f32_16x16x32_bf16 v[104:107], v[164:167], v[72:75], v[104:107]
  v_add_f32_dpp v57, v22, v56 wave_ror:1 row_mask:0xf bank_mask:0xf
  v_add_f32_dpp v13, v14, v12 wave_shr:1 row_mask:0xf bank_mask:0xf
  v_add_f32_dpp v17, v18, v16 wave_shr:1 row_mask:0xf bank_mask:0xf
  v_mfma_f32_16x16x32_bf16 v[104:107], v[156:159], v[76:79], v[104:107]
  v_add_f32_dpp v21, v22, v20 wave_shr:1 row_mask:0xf bank_mask:0xf
  v_add_f32_dpp v57, v58, v56 wave_shr:1 row_mask:0xf bank_mask:0xf
  v_cvt_pk_bf16_f32 v54, v13, v17
  v_mfma_f32_16x16x32_bf16 v[104:107], v[148:151], v[80:83], v[104:107]
  v_cvt_pk_bf16_f32 v55, v21, v57
  ds_write_b64 v6, v[54:55] offset:58624
  v_add_f32_dpp v53, v59, v126 wave_ror:1 row_mask:0xf bank_mask:0xf
  s_andn2_b32 s16, 4, s9
  s_cbranch_scc1 HF2_0E
  buffer_load_dwordx2 v[216:217], v61, s[28:31], s59 offen sc1
HF2_0E:
  v_mfma_f32_16x16x32_bf16 v[104:107], v[140:143], v[84:87], v[104:107]
  v_add_f32_dpp v38, v52, v125 wave_ror:1 row_mask:0xf bank_mask:0xf
  v_add_f32_dpp v56, v58, v124 wave_ror:1 row_mask:0xf bank_mask:0xf
  v_add_f32_dpp v53, v127, v126 wave_shr:1 row_mask:0xf bank_mask:0xf
  v_mfma_f32_16x16x32_bf16 v[104:107], v[132:135], v[88:91], v[104:107]
  ds_read_b64_tr_b16 v[92:93], v4 offset:1792
  ds_read_b64_tr_b16 v[94:95], v4 offset:1824
  s_waitcnt lgkmcnt(3)
  v_mfma_f32_16x16x32_bf16 v[108:111], v[184:187], v[64:67], 0
  v_add_f32_dpp v38, v53, v125 wave_shr:1 row_mask:0xf bank_mask:0xf
  ds_read_b64_tr_b16 v[188:189], v5 offset:1952
  ds_read_b64_tr_b16 v[190:191], v5 offset:1920
  v_mfma_f32_16x16x32_bf16 v[108:111], v[176:179], v[68:71], v[108:111]
  v_add_f32_dpp v56, v38, v124 wave_shr:1 row_mask:0xf bank_mask:0xf
  v_mfma_f32_16x16x32_bf16 v[108:111], v[168:171], v[72:75], v[108:111]
  v_add_f32_dpp v46, v127, v106 wave_ror:1 row_mask:0xf bank_mask:0xf
  v_add_f32_dpp v39, v53, v105 wave_ror:1 row_mask:0xf bank_mask:0xf
  v_add_f32_dpp v124, v38, v104 wave_ror:1 row_mask:0xf bank_mask:0xf
  v_mfma_f32_16x16x32_bf16 v[108:111], v[160:163], v[76:79], v[108:111]
  v_add_f32_dpp v46, v107, v106 wave_shr:1 row_mask:0xf bank_mask:0xf
  v_mfma_f32_16x16x32_bf16 v[108:111], v[152:155], v[80:83], v[108:111]
  s_nop 0
  v_add_f32_dpp v39, v46, v105 wave_shr:1 row_mask:0xf bank_mask:0xf
  v_mfma_f32_16x16x32_bf16 v[108:111], v[144:147], v[84:87], v[108:111]
  s_nop 0
  v_add_f32_dpp v124, v39, v104 wave_shr:1 row_mask:0xf bank_mask:0xf
  v_mfma_f32_16x16x32_bf16 v[108:111], v[136:139], v[88:91], v[108:111]
  s_waitcnt lgkmcnt(2)
  v_mfma_f32_16x16x32_bf16 v[108:111], v[128:131], v[92:95], v[108:111]
  s_waitcnt lgkmcnt(0)
  v_mfma_f32_16x16x32_bf16 v[112:115], v[188:191], v[64:67], 0
  s_waitcnt vmcnt(4)
  ds_read_b64_tr_b16 v[192:193], v5 offset:2080
  ds_read_b64_tr_b16 v[194:195], v5 offset:2048
  v_mfma_f32_16x16x32_bf16 v[112:115], v[180:183], v[68:71], v[112:115]
  v_mfma_f32_16x16x32_bf16 v[112:115], v[172:175], v[72:75], v[112:115]
  s_nop 0
  v_add_f32_dpp v47, v107, v110 wave_ror:1 row_mask:0xf bank_mask:0xf
  v_add_f32_dpp v38, v46, v109 wave_ror:1 row_mask:0xf bank_mask:0xf
  v_add_f32_dpp v104, v39, v108 wave_ror:1 row_mask:0xf bank_mask:0xf
  v_mfma_f32_16x16x32_bf16 v[112:115], v[164:167], v[76:79], v[112:115]
  v_add_f32_dpp v47, v111, v110 wave_shr:1 row_mask:0xf bank_mask:0xf
  v_mfma_f32_16x16x32_bf16 v[112:115], v[156:159], v[80:83], v[112:115]
  s_nop 0
  v_add_f32_dpp v38, v47, v109 wave_shr:1 row_mask:0xf bank_mask:0xf
  v_mfma_f32_16x16x32_bf16 v[112:115], v[148:151], v[84:87], v[112:115]
  s_nop 0
  v_add_f32_dpp v104, v38, v108 wave_shr:1 row_mask:0xf bank_mask:0xf
  v_mfma_f32_16x16x32_bf16 v[112:115], v[140:143], v[88:91], v[112:115]
  v_mfma_f32_16x16x32_bf16 v[112:115], v[132:135], v[92:95], v[112:115]
  s_waitcnt lgkmcnt(0)
  v_mfma_f32_16x16x32_bf16 v[116:119], v[192:195], v[64:67], 0
  ds_read_b64_tr_b16 v[96:97], v4 offset:2048
  ds_read_b64_tr_b16 v[98:99], v4 offset:2080
  v_mfma_f32_16x16x32_bf16 v[116:119], v[184:187], v[68:71], v[116:119]
  s_cmp_ge_u32 s16, 2
  s_cbranch_scc1 HC2_0_E
  s_waitcnt vmcnt(0)
  s_cmp_eq_u32 s16, 1
  s_cbranch_scc1 HC2_0_I
  v_cmp_ne_u64 vcc, s[10:11], v[216:217]
  s_nop 0
  s_cbranch_vccz HC2_0_OK
  buffer_load_dwordx2 v[216:217], v61, s[28:31], s59 offen sc1
  s_branch HC2_0_E
HC2_0_OK:
  s_add_u32 m0, s44, 0
  s_nop 0
  buffer_load_dwordx4 v62, s[28:31], s60 offen offset:0 sc1 lds
  s_add_u32 m0, s44, 1024
  s_nop 0
  buffer_load_dwordx4 v63, s[28:31], s61 offen offset:0 sc1 lds
HC2_0_I:
  s_add_u32 s16, s16, 1
HC2_0_E:
  ds_read_b64_tr_b16 v[196:197], v5 offset:2208
  ds_read_b64_tr_b16 v[198:199], v5 offset:2176
  v_mfma_f32_16x16x32_bf16 v[116:119], v[176:179], v[72:75], v[116:119]
  v_add_f32_dpp v48, v111, v114 wave_ror:1 row_mask:0xf bank_mask:0xf
  v_add_f32_dpp v39, v47, v113 wave_ror:1 row_mask:0xf bank_mask:0xf
  v_add_f32_dpp v108, v38, v112 wave_ror:1 row_mask:0xf bank_mask:0xf
  v_mfma_f32_16x16x32_bf16 v[116:119], v[168:171], v[76:79], v[116:119]
  v_add_f32_dpp v48, v115, v114 wave_shr:1 row_mask:0xf bank_mask:0xf
  v_mfma_f32_16x16x32_bf16 v[116:119], v[160:163], v[80:83], v[116:119]
  s_nop 0
  v_add_f32_dpp v39, v48, v113 wave_shr:1 row_mask:0xf bank_mask:0xf
  v_mfma_f32_16x16x32_bf16 v[116:119], v[152:155], v[84:87], v[116:119]
  s_nop 0
  v_add_f32_dpp v108, v39, v112 wave_shr:1 row_mask:0xf bank_mask:0xf
  v_cvt_pk_bf16_f32 v54, v56, v124
  v_cvt_pk_bf16_f32 v55, v104, v108
  v_mfma_f32_16x16x32_bf16 v[116:119], v[144:147], v[88:91], v[116:119]
  ds_write_b64 v6, v[54:55] offset:59136
  s_waitcnt lgkmcnt(0)
  s_barrier
  ds_read_b64_tr_b16 v[36:37], v7 offset:58624
  v_mfma_f32_16x16x32_bf16 v[116:119], v[136:139], v[92:95], v[116:119]
  s_waitcnt vmcnt(2)
  v_mov_b32_dpp v24, v26 row_shr:4 row_mask:0xf bank_mask:0xa
  v_mov_b32_dpp v25, v27 row_shr:4 row_mask:0xf bank_mask:0xa
  v_and_b32 v27, s55, v25
  v_mfma_f32_16x16x32_bf16 v[116:119], v[128:131], v[96:99], v[116:119]
  v_lshlrev_b32 v26, 16, v25
  v_and_b32 v25, s55, v24
  v_lshlrev_b32 v24, 16, v24
  v_mfma_f32_16x16x32_bf16 v[120:123], v[196:199], v[64:67], 0
  v_mfma_f32_16x16x32_bf16 v[120:123], v[188:191], v[68:71], v[120:123]
  s_waitcnt lgkmcnt(0)
  v_lshlrev_b32 v40, 16, v36
  v_and_b32 v41, s55, v36
  v_lshlrev_b32 v42, 16, v37
  ds_read_b64_tr_b16 v[200:201], v5 offset:2336
  ds_read_b64_tr_b16 v[202:203], v5 offset:2304
  v_mfma_f32_16x16x32_bf16 v[120:123], v[180:183], v[72:75], v[120:123]
  v_and_b32 v43, s55, v37
  v_mul_f32 v40, v40, v24
  v_mul_f32 v41, v41, v25
  v_mfma_f32_16x16x32_bf16 v[120:123], v[172:175], v[76:79], v[120:123]
  v_mul_f32 v42, v42, v26
  v_mul_f32 v43, v43, v27
  v_cvt_pk_bf16_f32 v24, v40, v41
  v_mfma_f32_16x16x32_bf16 v[120:123], v[164:167], v[80:83], v[120:123]
  v_cvt_pk_bf16_f32 v25, v42, v43
  v_mov_b32_dpp v26, v24 row_shl:4 row_mask:0xf bank_mask:0xf
  s_nop 0
  v_mov_b32_dpp v27, v25 row_shl:4 row_mask:0xf bank_mask:0xf
  v_mfma_f32_16x16x32_bf16 v[120:123], v[156:159], v[84:87], v[120:123]
  buffer_store_dwordx4 v[24:27], v44, s[40:43], s56 offen
  ds_read_b64_tr_b16 v[36:37], v7 offset:59136
  s_waitcnt vmcnt(2)
  v_mov_b32_dpp v28, v30 row_shr:4 row_mask:0xf bank_mask:0xa
  v_mfma_f32_16x16x32_bf16 v[120:123], v[148:151], v[88:91], v[120:123]
  v_mov_b32_dpp v29, v31 row_shr:4 row_mask:0xf bank_mask:0xa
  v_and_b32 v31, s55, v29
  v_lshlrev_b32 v30, 16, v29
  v_mfma_f32_16x16x32_bf16 v[120:123], v[140:143], v[92:95], v[120:123]
  v_and_b32 v29, s55, v28
  v_lshlrev_b32 v28, 16, v28
  v_add_f32_dpp v49, v115, v118 wave_ror:1 row_mask:0xf bank_mask:0xf
  v_mfma_f32_16x16x32_bf16 v[120:123], v[132:135], v[96:99], v[120:123]
  v_add_f32_dpp v38, v48, v117 wave_ror:1 row_mask:0xf bank_mask:0xf
  v_add_f32_dpp v112, v39, v116 wave_ror:1 row_mask:0xf bank_mask:0xf
  v_add_f32_dpp v49, v119, v118 wave_shr:1 row_mask:0xf bank_mask:0xf
  s_waitcnt lgkmcnt(1)
  v_mfma_f32_16x16x32_bf16 v[208:211], v[200:203], v[64:67], 0
  v_mfma_f32_16x16x32_bf16 v[208:211], v[192:195], v[68:71], v[208:211]
  v_add_f32_dpp v38, v49, v117 wave_shr:1 row_mask:0xf bank_mask:0xf
  ds_read_b64_tr_b16 v[100:101], v4 offset:2304
  ds_read_b64_tr_b16 v[102:103], v4 offset:2336
  v_mfma_f32_16x16x32_bf16 v[208:211], v[184:187], v[72:75], v[208:211]
  v_add_f32_dpp v112, v38, v116 wave_shr:1 row_mask:0xf bank_mask:0xf
  s_waitcnt lgkmcnt(2)
  v_lshlrev_b32 v40, 16, v36
  v_and_b32 v41, s55, v36
  ds_read_b64_tr_b16 v[204:205], v5 offset:2464
  ds_read_b64_tr_b16 v[206:207], v5 offset:2432
  v_mfma_f32_16x16x32_bf16 v[208:211], v[176:179], v[76:79], v[208:211]
  v_lshlrev_b32 v42, 16, v37
  v_and_b32 v43, s55, v37
  v_mul_f32 v40, v40, v28
  v_mfma_f32_16x16x32_bf16 v[208:211], v[168:171], v[80:83], v[208:211]
  v_mul_f32 v41, v41, v29
  v_mul_f32 v42, v42, v30
  v_mul_f32 v43, v43, v31
  v_mfma_f32_16x16x32_bf16 v[208:211], v[160:163], v[84:87], v[208:211]
  v_cvt_pk_bf16_f32 v28, v40, v41
  v_cvt_pk_bf16_f32 v29, v42, v43
  s_nop 0
  v_mov_b32_dpp v30, v28 row_shl:4 row_mask:0xf bank_mask:0xf
  v_mfma_f32_16x16x32_bf16 v[208:211], v[152:155], v[88:91], v[208:211]
  v_mov_b32_dpp v31, v29 row_shl:4 row_mask:0xf bank_mask:0xf
  buffer_store_dwordx4 v[28:31], v44, s[40:43], s57 offen
  s_waitcnt vmcnt(2)
  v_mov_b32_dpp v32, v34 row_shr:4 row_mask:0xf bank_mask:0xa
  v_mfma_f32_16x16x32_bf16 v[208:211], v[144:147], v[92:95], v[208:211]
  v_mov_b32_dpp v33, v35 row_shr:4 row_mask:0xf bank_mask:0xa
  v_and_b32 v35, s55, v33
  v_lshlrev_b32 v34, 16, v33
  v_mfma_f32_16x16x32_bf16 v[208:211], v[136:139], v[96:99], v[208:211]
  v_and_b32 v33, s55, v32
  v_lshlrev_b32 v32, 16, v32
  v_add_f32_dpp v50, v119, v122 wave_ror:1 row_mask:0xf bank_mask:0xf
  s_waitcnt lgkmcnt(2)
  v_mfma_f32_16x16x32_bf16 v[208:211], v[128:131], v[100:103], v[208:211]
  v_add_f32_dpp v39, v49, v121 wave_ror:1 row_mask:0xf bank_mask:0xf
  v_add_f32_dpp v116, v38, v120 wave_ror:1 row_mask:0xf bank_mask:0xf
  v_add_f32_dpp v50, v123, v122 wave_shr:1 row_mask:0xf bank_mask:0xf
  s_cmp_ge_u32 s16, 2
  s_cbranch_scc1 HC2_1_E
  s_waitcnt vmcnt(2)
  s_cmp_eq_u32 s16, 1
  s_cbranch_scc1 HC2_1_I
  v_cmp_ne_u64 vcc, s[10:11], v[216:217]
  s_nop 0
  s_cbranch_vccz HC2_1_OK
  s_mov_b32 s23, 0
HC2_1_L:
  buffer_load_dwordx2 v[216:217], v61, s[28:31], s59 offen sc1
  s_add_u32 s23, s23, 1
  s_waitcnt vmcnt(0)
  v_cmp_ne_u64 vcc, s[10:11], v[216:217]
  s_cmp_ge_u32 s23, 4000
  s_cbranch_scc1 HC2_1_OK
  s_cbranch_vccnz HC2_1_L
HC2_1_OK:
  s_add_u32 m0, s44, 0
  s_nop 0
  buffer_load_dwordx4 v62, s[28:31], s60 offen offset:0 sc1 lds
  s_add_u32 m0, s44, 1024
  s_nop 0
  buffer_load_dwordx4 v63, s[28:31], s61 offen offset:0 sc1 lds
  s_waitcnt vmcnt(0)
HC2_1_I:
  s_add_u32 s16, s16, 1
HC2_1_E:
  s_barrier
  ds_read_b64_tr_b16 v[8:9], v248 offset:0
  ds_read_b64_tr_b16 v[10:11], v248 offset:512
  ds_read_b64_tr_b16 v[12:13], v249 offset:0
  ds_read_b64_tr_b16 v[14:15], v249 offset:512
  ds_read_b64_tr_b16 v[16:17], v250 offset:0
  ds_read_b64_tr_b16 v[18:19], v250 offset:512
  ds_read_b64_tr_b16 v[20:21], v251 offset:0
  ds_read_b64_tr_b16 v[22:23], v251 offset:512
  ds_read_b64_tr_b16 v[56:57], v248 offset:4096
  ds_read_b64_tr_b16 v[58:59], v248 offset:4608
  ds_read_b64_tr_b16 v[124:125], v249 offset:4096
  ds_read_b64_tr_b16 v[126:127], v249 offset:4608
  s_waitcnt lgkmcnt(12)
  v_mfma_f32_16x16x32_bf16 v[212:215], v[204:207], v[64:67], 0
  v_mfma_f32_16x16x32_bf16 v[212:215], v[196:199], v[68:71], v[212:215]
  v_add_f32_dpp v39, v50, v121 wave_shr:1 row_mask:0xf bank_mask:0xf
  v_mfma_f32_16x16x32_bf16 v[212:215], v[188:191], v[72:75], v[212:215]
  s_nop 0
  v_add_f32_dpp v116, v39, v120 wave_shr:1 row_mask:0xf bank_mask:0xf
  v_add_f32_dpp v51, v123, v210 wave_ror:1 row_mask:0xf bank_mask:0xf
  v_add_f32_dpp v38, v50, v209 wave_ror:1 row_mask:0xf bank_mask:0xf
  ds_read_b64_tr_b16 v[200:201], v250 offset:4096
  ds_read_b64_tr_b16 v[202:203], v250 offset:4608
  s_waitcnt lgkmcnt(12)
  v_mfma_f32_16x16x32_bf16 v[216:219], v[232:235], v[8:11], 0
  v_add_f32_dpp v120, v39, v208 wave_ror:1 row_mask:0xf bank_mask:0xf
  v_add_f32_dpp v51, v211, v210 wave_shr:1 row_mask:0xf bank_mask:0xf
  ds_read_b64_tr_b16 v[192:193], v251 offset:4096
  ds_read_b64_tr_b16 v[194:195], v251 offset:4608
  s_waitcnt lgkmcnt(12)
  v_mfma_f32_16x16x32_bf16 v[220:223], v[232:235], v[12:15], 0
  v_add_f32_dpp v38, v51, v209 wave_shr:1 row_mask:0xf bank_mask:0xf
  ds_read_b64_tr_b16 v[184:185], v248 offset:8192
  ds_read_b64_tr_b16 v[186:187], v248 offset:8704
  s_waitcnt lgkmcnt(12)
  v_mfma_f32_16x16x32_bf16 v[224:227], v[232:235], v[16:19], 0
  v_add_f32_dpp v120, v38, v208 wave_shr:1 row_mask:0xf bank_mask:0xf
  ds_read_b64_tr_b16 v[176:177], v249 offset:8192
  ds_read_b64_tr_b16 v[178:179], v249 offset:8704
  s_waitcnt lgkmcnt(12)
  v_mfma_f32_16x16x32_bf16 v[228:231], v[232:235], v[20:23], 0
  ds_read_b64_tr_b16 v[168:169], v250 offset:8192
  ds_read_b64_tr_b16 v[170:171], v250 offset:8704
  s_waitcnt lgkmcnt(12)
  v_mfma_f32_16x16x32_bf16 v[216:219], v[236:239], v[56:59], v[216:219]
  ds_read_b64_tr_b16 v[160:161], v251 offset:8192
  ds_read_b64_tr_b16 v[162:163], v251 offset:8704
  s_waitcnt lgkmcnt(12)
  v_mfma_f32_16x16x32_bf16 v[220:223], v[236:239], v[124:127], v[220:223]
  ds_read_b64_tr_b16 v[152:153], v248 offset:12288
  ds_read_b64_tr_b16 v[154:155], v248 offset:12800
  s_waitcnt lgkmcnt(12)
  v_mfma_f32_16x16x32_bf16 v[224:227], v[236:239], v[200:203], v[224:227]
  ds_read_b64_tr_b16 v[144:145], v249 offset:12288
  ds_read_b64_tr_b16 v[146:147], v249 offset:12800
  s_waitcnt lgkmcnt(12)
  v_mfma_f32_16x16x32_bf16 v[228:231], v[236:239], v[192:195], v[228:231]
  ds_read_b64_tr_b16 v[136:137], v250 offset:12288
  ds_read_b64_tr_b16 v[138:139], v250 offset:12800
  s_waitcnt lgkmcnt(12)
  v_mfma_f32_16x16x32_bf16 v[216:219], v[240:243], v[184:187], v[216:219]
  ds_read_b64_tr_b16 v[128:129], v251 offset:12288
  ds_read_b64_tr_b16 v[130:131], v251 offset:12800
  s_waitcnt lgkmcnt(12)
  v_mfma_f32_16x16x32_bf16 v[220:223], v[240:243], v[176:179], v[220:223]
  s_waitcnt lgkmcnt(10)
  v_mfma_f32_16x16x32_bf16 v[224:227], v[240:243], v[168:171], v[224:227]
  s_waitcnt lgkmcnt(8)
  v_mfma_f32_16x16x32_bf16 v[228:231], v[240:243], v[160:163], v[228:231]
  s_waitcnt lgkmcnt(6)
  v_mfma_f32_16x16x32_bf16 v[216:219], v[244:247], v[152:155], v[216:219]
  s_waitcnt lgkmcnt(4)
  v_mfma_f32_16x16x32_bf16 v[220:223], v[244:247], v[144:147], v[220:223]
  s_waitcnt lgkmcnt(2)
  v_mfma_f32_16x16x32_bf16 v[224:227], v[244:247], v[136:139], v[224:227]
  s_waitcnt lgkmcnt(0)
  v_mfma_f32_16x16x32_bf16 v[228:231], v[244:247], v[128:131], v[228:231]
  v_mfma_f32_16x16x32_bf16 v[212:215], v[180:183], v[76:79], v[212:215]
  v_mfma_f32_16x16x32_bf16 v[212:215], v[172:175], v[80:83], v[212:215]
  s_nop 1
  v_cvt_pk_bf16_f32 v104, v216, v220
  s_nop 2
  v_cvt_pk_bf16_f32 v105, v224, v228
  buffer_store_dwordx2 v[104:105], v0, s[40:43], s64 offen offset:0 sc1
  v_cvt_pk_bf16_f32 v106, v217, v221
  v_mfma_f32_16x16x32_bf16 v[212:215], v[164:167], v[84:87], v[212:215]
  v_cvt_pk_bf16_f32 v107, v225, v229
  buffer_store_dwordx2 v[106:107], v0, s[40:43], s65 offen offset:0 sc1
  v_cvt_pk_bf16_f32 v108, v218, v222
  v_cvt_pk_bf16_f32 v109, v226, v230
  v_mfma_f32_16x16x32_bf16 v[212:215], v[156:159], v[88:91], v[212:215]
  buffer_store_dwordx2 v[108:109], v0, s[40:43], s66 offen offset:0 sc1
  v_cvt_pk_bf16_f32 v110, v219, v223
  v_cvt_pk_bf16_f32 v111, v227, v231
  buffer_store_dwordx2 v[110:111], v0, s[40:43], s67 offen offset:0 sc1
  v_mfma_f32_16x16x32_bf16 v[212:215], v[148:151], v[92:95], v[212:215]
  v_mfma_f32_16x16x32_bf16 v[212:215], v[140:143], v[96:99], v[212:215]
  v_mfma_f32_16x16x32_bf16 v[212:215], v[132:135], v[100:103], v[212:215]
  s_nop 7
  v_add_f32_dpp v52, v211, v214 wave_ror:1 row_mask:0xf bank_mask:0xf
  v_add_f32_dpp v39, v51, v213 wave_ror:1 row_mask:0xf bank_mask:0xf
  v_add_f32_dpp v208, v38, v212 wave_ror:1 row_mask:0xf bank_mask:0xf
  v_add_f32_dpp v52, v215, v214 wave_shr:1 row_mask:0xf bank_mask:0xf
  s_nop 1
  v_add_f32_dpp v39, v52, v213 wave_shr:1 row_mask:0xf bank_mask:0xf
  s_nop 1
  v_add_f32_dpp v208, v39, v212 wave_shr:1 row_mask:0xf bank_mask:0xf
  v_cvt_pk_bf16_f32 v54, v112, v116
  v_cvt_pk_bf16_f32 v55, v120, v208
  ds_write_b64 v6, v[54:55] offset:59648
  s_waitcnt lgkmcnt(0)
  s_barrier
  ds_read_b64_tr_b16 v[36:37], v7 offset:59648
  s_waitcnt lgkmcnt(0)
  v_lshlrev_b32 v40, 16, v36
  v_and_b32 v41, s55, v36
  v_lshlrev_b32 v42, 16, v37
  v_and_b32 v43, s55, v37
  v_mul_f32 v40, v40, v32
  v_mul_f32 v41, v41, v33
  v_mul_f32 v42, v42, v34
  v_mul_f32 v43, v43, v35
  v_cvt_pk_bf16_f32 v32, v40, v41
  v_cvt_pk_bf16_f32 v33, v42, v43
  s_nop 0
  v_mov_b32_dpp v34, v32 row_shl:4 row_mask:0xf bank_mask:0xf
  v_mov_b32_dpp v35, v33 row_shl:4 row_mask:0xf bank_mask:0xf
  buffer_store_dwordx4 v[32:35], v44, s[40:43], s58 offen
  s_endpgm
.p2align 6
P_1:
  v_mov_b32 v52, s52
  ds_read_u16 v251, v52
  ds_read_b64_tr_b16 v[68:69], v4 offset:256
  ds_read_b64_tr_b16 v[70:71], v4 offset:288
  ds_read_b64_tr_b16 v[72:73], v4 offset:512
  ds_read_b64_tr_b16 v[74:75], v4 offset:544
  ds_read_b64_tr_b16 v[76:77], v4 offset:768
  ds_read_b64_tr_b16 v[78:79], v4 offset:800
  v_lshlrev_b32 v250, 16, v250
  s_waitcnt lgkmcnt(6)
  v_lshlrev_b32 v251, 16, v251
  v_add_f32 v250, v250, v251
  v_cvt_pk_bf16_f32 v250, v250, v250
  ds_write_b16 v52, v250
  v_mov_b32 v16, 0
  s_sub_u32 s22, s53, 256
  v_lshl_add_u32 v17, v1, 2, s22
  ds_write_b32 v17, v16
  ds_read_b64_tr_b16 v[64:65], v4 offset:0
  ds_read_b64_tr_b16 v[66:67], v4 offset:32
  ds_read_b64_tr_b16 v[80:81], v4 offset:1024
  ds_read_b64_tr_b16 v[82:83], v4 offset:1056
  ds_read_b64_tr_b16 v[84:85], v4 offset:1280
  ds_read_b64_tr_b16 v[86:87], v4 offset:1312
  ds_read_b64_tr_b16 v[88:89], v4 offset:1536
  ds_read_b64_tr_b16 v[90:91], v4 offset:1568
  ds_read_b64_tr_b16 v[92:93], v4 offset:1792
  ds_read_b64_tr_b16 v[94:95], v4 offset:1824
  ds_read_b64_tr_b16 v[96:97], v4 offset:2048
  ds_read_b64_tr_b16 v[98:99], v4 offset:2080
  ds_read_b64_tr_b16 v[100:101], v4 offset:2304
  ds_read_b64_tr_b16 v[102:103], v4 offset:2336
  ds_read_b64_tr_b16 v[104:105], v4 offset:2560
  ds_read_b64_tr_b16 v[106:107], v4 offset:2592
  ds_read_b64_tr_b16 v[108:109], v4 offset:2816
  ds_read_b64_tr_b16 v[110:111], v4 offset:2848
  ds_read_b64_tr_b16 v[112:113], v4 offset:3072
  ds_read_b64_tr_b16 v[114:115], v4 offset:3104
  ds_read_b64_tr_b16 v[116:117], v4 offset:3328
  ds_read_b64_tr_b16 v[118:119], v4 offset:3360
  s_waitcnt vmcnt(0)
  s_mov_b64 exec, 1
  buffer_store_dwordx2 v[248:249], off, s[28:31], s49 sc1
  s_mov_b64 exec, -1
HFE1:
  s_cmp_ge_u32 s3, 5
  s_cbranch_scc1 PU1_OK
  v_cmp_ne_u64 vcc, s[10:11], v[42:43]
  s_nop 0
  s_cbranch_vccz PU1_OK
  s_mov_b32 s23, 0
PU1_L:
  buffer_load_dwordx2 v[42:43], v46, s[28:31], s47 offen sc1
  s_add_u32 s23, s23, 1
  s_waitcnt vmcnt(0)
  v_cmp_ne_u64 vcc, s[10:11], v[42:43]
  s_cmp_ge_u32 s23, 4000
  s_cbranch_scc1 PU1_OK
  s_cbranch_vccnz PU1_L
PU1_OK:
  s_barrier
  s_mov_b32 m0, s53
  s_nop 0
  buffer_load_dwordx4 v3, s[28:31], s12 offen offset:2048 sc1 lds
  buffer_load_dwordx4 v3, s[28:31], s12 offen offset:1024 sc1 lds
  buffer_load_dwordx4 v3, s[28:31], s12 offen offset:0 sc1 lds
  s_mov_b32 exec_hi, 0
  buffer_load_dwordx4 v3, s[28:31], s12 offen offset:3072 sc1 lds
  s_mov_b32 exec_hi, -1
  s_cmp_lt_u32 s3, 4
  s_cbranch_scc1 PRIO1
  s_setprio 1
PRIO1:
  s_waitcnt vmcnt(3)
  ds_read_b64_tr_b16 v[220:221], v5 offset:2976
  ds_read_b64_tr_b16 v[222:223], v5 offset:2944
  ds_read_b64_tr_b16 v[216:217], v5 offset:2848
  ds_read_b64_tr_b16 v[218:219], v5 offset:2816
  ds_read_b64_tr_b16 v[212:213], v5 offset:2720
  ds_read_b64_tr_b16 v[214:215], v5 offset:2688
  ds_read_b64_tr_b16 v[208:209], v5 offset:2592
  ds_read_b64_tr_b16 v[210:211], v5 offset:2560
  ds_read_b64_tr_b16 v[204:205], v5 offset:2464
  ds_read_b64_tr_b16 v[206:207], v5 offset:2432
  s_waitcnt lgkmcnt(8)
  v_mfma_f32_16x16x32_bf16 v[56:59], v[220:223], v[64:67], 0
  buffer_load_dword v43, v47, s[36:39], s62 offen
  ds_read_b64_tr_b16 v[200:201], v5 offset:2336
  ds_read_b64_tr_b16 v[202:203], v5 offset:2304
  s_waitcnt lgkmcnt(8)
  v_mfma_f32_16x16x32_bf16 v[20:23], v[216:219], v[64:67], 0
  s_waitcnt vmcnt(3)
  ds_read_b64_tr_b16 v[196:197], v5 offset:2208
  ds_read_b64_tr_b16 v[198:199], v5 offset:2176
  s_waitcnt lgkmcnt(8)
  v_mfma_f32_16x16x32_bf16 v[16:19], v[212:215], v[64:67], 0
  s_waitcnt lgkmcnt(6)
  v_mfma_f32_16x16x32_bf16 v[12:15], v[208:211], v[64:67], 0
  s_waitcnt lgkmcnt(4)
  v_mfma_f32_16x16x32_bf16 v[8:11], v[204:207], v[64:67], 0
  v_mfma_f32_16x16x32_bf16 v[56:59], v[212:215], v[68:71], v[56:59]
  ds_read_b64_tr_b16 v[192:193], v5 offset:2080
  ds_read_b64_tr_b16 v[194:195], v5 offset:2048
  v_mfma_f32_16x16x32_bf16 v[20:23], v[208:211], v[68:71], v[20:23]
  ds_read_b64_tr_b16 v[188:189], v5 offset:1952
  ds_read_b64_tr_b16 v[190:191], v5 offset:1920
  v_mfma_f32_16x16x32_bf16 v[16:19], v[204:207], v[68:71], v[16:19]
  s_waitcnt lgkmcnt(6)
  v_mfma_f32_16x16x32_bf16 v[12:15], v[200:203], v[68:71], v[12:15]
  s_waitcnt lgkmcnt(4)
  v_mfma_f32_16x16x32_bf16 v[8:11], v[196:199], v[68:71], v[8:11]
  v_mfma_f32_16x16x32_bf16 v[56:59], v[204:207], v[72:75], v[56:59]
  ds_read_b64_tr_b16 v[184:185], v5 offset:1824
  ds_read_b64_tr_b16 v[186:187], v5 offset:1792
  v_mfma_f32_16x16x32_bf16 v[20:23], v[200:203], v[72:75], v[20:23]
  ds_read_b64_tr_b16 v[180:181], v5 offset:1696
  ds_read_b64_tr_b16 v[182:183], v5 offset:1664
  v_mfma_f32_16x16x32_bf16 v[16:19], v[196:199], v[72:75], v[16:19]
  s_waitcnt lgkmcnt(6)
  v_mfma_f32_16x16x32_bf16 v[12:15], v[192:195], v[72:75], v[12:15]
  s_waitcnt lgkmcnt(4)
  v_mfma_f32_16x16x32_bf16 v[8:11], v[188:191], v[72:75], v[8:11]
  v_mfma_f32_16x16x32_bf16 v[56:59], v[196:199], v[76:79], v[56:59]
  ds_read_b64_tr_b16 v[176:177], v5 offset:1568
  ds_read_b64_tr_b16 v[178:179], v5 offset:1536
  v_mfma_f32_16x16x32_bf16 v[20:23], v[192:195], v[76:79], v[20:23]
  ds_read_b64_tr_b16 v[172:173], v5 offset:1440
  ds_read_b64_tr_b16 v[174:175], v5 offset:1408
  v_mfma_f32_16x16x32_bf16 v[16:19], v[188:191], v[76:79], v[16:19]
  s_waitcnt lgkmcnt(6)
  v_mfma_f32_16x16x32_bf16 v[12:15], v[184:187], v[76:79], v[12:15]
  s_waitcnt lgkmcnt(4)
  v_mfma_f32_16x16x32_bf16 v[8:11], v[180:183], v[76:79], v[8:11]
  v_mfma_f32_16x16x32_bf16 v[56:59], v[188:191], v[80:83], v[56:59]
  ds_read_b64_tr_b16 v[168:169], v5 offset:1312
  ds_read_b64_tr_b16 v[170:171], v5 offset:1280
  v_mfma_f32_16x16x32_bf16 v[20:23], v[184:187], v[80:83], v[20:23]
  s_waitcnt vmcnt(2)
  ds_read_b64_tr_b16 v[164:165], v5 offset:1184
  ds_read_b64_tr_b16 v[166:167], v5 offset:1152
  v_mfma_f32_16x16x32_bf16 v[16:19], v[180:183], v[80:83], v[16:19]
  s_waitcnt lgkmcnt(6)
  v_mfma_f32_16x16x32_bf16 v[12:15], v[176:179], v[80:83], v[12:15]
  s_waitcnt lgkmcnt(4)
  v_mfma_f32_16x16x32_bf16 v[8:11], v[172:175], v[80:83], v[8:11]
  v_mfma_f32_16x16x32_bf16 v[56:59], v[180:183], v[84:87], v[56:59]
  ds_read_b64_tr_b16 v[160:161], v5 offset:1056
  ds_read_b64_tr_b16 v[162:163], v5 offset:1024
  v_mfma_f32_16x16x32_bf16 v[20:23], v[176:179], v[84:87], v[20:23]
  ds_read_b64_tr_b16 v[156:157], v5 offset:928
  ds_read_b64_tr_b16 v[158:159], v5 offset:896
  v_mfma_f32_16x16x32_bf16 v[16:19], v[172:175], v[84:87], v[16:19]
  s_waitcnt lgkmcnt(6)
  v_mfma_f32_16x16x32_bf16 v[12:15], v[168:171], v[84:87], v[12:15]
  s_waitcnt lgkmcnt(4)
  v_mfma_f32_16x16x32_bf16 v[8:11], v[164:167], v[84:87], v[8:11]
  s_add_u32 s56, s54, 0x190000
  buffer_load_dwordx4 v[24:27], v45, s[36:39], s56 offen
  s_add_u32 s56, s54, 0x320500
  v_mfma_f32_16x16x32_bf16 v[56:59], v[172:175], v[88:91], v[56:59]
  ds_read_b64_tr_b16 v[152:153], v5 offset:800
  ds_read_b64_tr_b16 v[154:155], v5 offset:768
  v_mfma_f32_16x16x32_bf16 v[20:23], v[168:171], v[88:91], v[20:23]
  ds_read_b64_tr_b16 v[148:149], v5 offset:672
  ds_read_b64_tr_b16 v[150:151], v5 offset:640
  v_mfma_f32_16x16x32_bf16 v[16:19], v[164:167], v[88:91], v[16:19]
  s_waitcnt lgkmcnt(6)
  v_mfma_f32_16x16x32_bf16 v[12:15], v[160:163], v[88:91], v[12:15]
  s_waitcnt lgkmcnt(4)
  v_mfma_f32_16x16x32_bf16 v[8:11], v[156:159], v[88:91], v[8:11]
  v_mfma_f32_16x16x32_bf16 v[56:59], v[164:167], v[92:95], v[56:59]
  ds_read_b64_tr_b16 v[144:145], v5 offset:544
  ds_read_b64_tr_b16 v[146:147], v5 offset:512
  v_mfma_f32_16x16x32_bf16 v[20:23], v[160:163], v[92:95], v[20:23]
  ds_read_b64_tr_b16 v[140:141], v5 offset:416
  ds_read_b64_tr_b16 v[142:143], v5 offset:384
  v_mfma_f32_16x16x32_bf16 v[16:19], v[156:159], v[92:95], v[16:19]
  s_waitcnt lgkmcnt(6)
  v_mfma_f32_16x16x32_bf16 v[12:15], v[152:155], v[92:95], v[12:15]
  s_waitcnt lgkmcnt(4)
  v_mfma_f32_16x16x32_bf16 v[8:11], v[148:151], v[92:95], v[8:11]
  s_add_u32 s57, s54, 0x1e0000
  buffer_load_dwordx4 v[28:31], v45, s[36:39], s57 offen
  s_add_u32 s57, s54, 0x3c0500
  v_mfma_f32_16x16x32_bf16 v[56:59], v[156:159], v[96:99], v[56:59]
  ds_read_b64_tr_b16 v[136:137], v5 offset:288
  ds_read_b64_tr_b16 v[138:139], v5 offset:256
  v_mfma_f32_16x16x32_bf16 v[20:23], v[152:155], v[96:99], v[20:23]
  ds_read_b64_tr_b16 v[132:133], v5 offset:160
  ds_read_b64_tr_b16 v[134:135], v5 offset:128
  v_mfma_f32_16x16x32_bf16 v[16:19], v[148:151], v[96:99], v[16:19]
  s_waitcnt lgkmcnt(6)
  v_mfma_f32_16x16x32_bf16 v[12:15], v[144:147], v[96:99], v[12:15]
  s_waitcnt lgkmcnt(4)
  v_mfma_f32_16x16x32_bf16 v[8:11], v[140:143], v[96:99], v[8:11]
  v_mfma_f32_16x16x32_bf16 v[56:59], v[148:151], v[100:103], v[56:59]
  ds_read_b64_tr_b16 v[128:129], v5 offset:32
  ds_read_b64_tr_b16 v[130:131], v5 offset:0
  v_mfma_f32_16x16x32_bf16 v[20:23], v[144:147], v[100:103], v[20:23]
  v_mfma_f32_16x16x32_bf16 v[16:19], v[140:143], v[100:103], v[16:19]
  s_waitcnt lgkmcnt(4)
  v_mfma_f32_16x16x32_bf16 v[12:15], v[136:139], v[100:103], v[12:15]
  s_waitcnt vmcnt(3)
  ds_read_b64_tr_b16 v[224:225], v5 offset:3104
  ds_read_b64_tr_b16 v[226:227], v5 offset:3072
  s_waitcnt lgkmcnt(4)
  v_mfma_f32_16x16x32_bf16 v[8:11], v[132:135], v[100:103], v[8:11]
  v_mfma_f32_16x16x32_bf16 v[56:59], v[140:143], v[104:107], v[56:59]
  v_mfma_f32_16x16x32_bf16 v[20:23], v[136:139], v[104:107], v[20:23]
  v_mfma_f32_16x16x32_bf16 v[16:19], v[132:135], v[104:107], v[16:19]
  s_waitcnt lgkmcnt(2)
  v_mfma_f32_16x16x32_bf16 v[12:15], v[128:131], v[104:107], v[12:15]
  v_mfma_f32_16x16x32_bf16 v[56:59], v[132:135], v[108:111], v[56:59]
  v_mfma_f32_16x16x32_bf16 v[20:23], v[128:131], v[108:111], v[20:23]
  s_waitcnt lgkmcnt(0)
  v_mfma_f32_16x16x32_bf16 v[60:63], v[224:227], v[64:67], 0
  v_mfma_f32_16x16x32_bf16 v[60:63], v[216:219], v[68:71], v[60:63]
  v_mfma_f32_16x16x32_bf16 v[60:63], v[208:211], v[72:75], v[60:63]
  s_nop 1
  v_add_f32_dpp v49, v11, v14 wave_ror:1 row_mask:0xf bank_mask:0xf
  v_add_f32_dpp v50, v15, v18 wave_ror:1 row_mask:0xf bank_mask:0xf
  v_add_f32_dpp v51, v19, v22 wave_ror:1 row_mask:0xf bank_mask:0xf
  v_mfma_f32_16x16x32_bf16 v[60:63], v[200:203], v[76:79], v[60:63]
  v_add_f32_dpp v52, v23, v58 wave_ror:1 row_mask:0xf bank_mask:0xf
  v_add_f32_dpp v48, v11, v10 wave_shr:1 row_mask:0xf bank_mask:0xf bound_ctrl:0
  v_add_f32_dpp v49, v15, v14 wave_shr:1 row_mask:0xf bank_mask:0xf
  v_mfma_f32_16x16x32_bf16 v[60:63], v[192:195], v[80:83], v[60:63]
  v_add_f32_dpp v50, v19, v18 wave_shr:1 row_mask:0xf bank_mask:0xf
  v_add_f32_dpp v51, v23, v22 wave_shr:1 row_mask:0xf bank_mask:0xf
  v_add_f32_dpp v52, v59, v58 wave_shr:1 row_mask:0xf bank_mask:0xf
  v_mfma_f32_16x16x32_bf16 v[60:63], v[184:187], v[84:87], v[60:63]
  v_add_f32_dpp v14, v48, v13 wave_ror:1 row_mask:0xf bank_mask:0xf
  v_add_f32_dpp v18, v49, v17 wave_ror:1 row_mask:0xf bank_mask:0xf
  v_add_f32_dpp v22, v50, v21 wave_ror:1 row_mask:0xf bank_mask:0xf
  ds_read_b64_tr_b16 v[228:229], v5 offset:3232
  ds_read_b64_tr_b16 v[230:231], v5 offset:3200
  v_mfma_f32_16x16x32_bf16 v[60:63], v[176:179], v[88:91], v[60:63]
  v_add_f32_dpp v58, v51, v57 wave_ror:1 row_mask:0xf bank_mask:0xf
  v_add_f32_dpp v10, v48, v9 wave_shr:1 row_mask:0xf bank_mask:0xf bound_ctrl:0
  v_add_f32_dpp v14, v49, v13 wave_shr:1 row_mask:0xf bank_mask:0xf
  v_mfma_f32_16x16x32_bf16 v[60:63], v[168:171], v[92:95], v[60:63]
  v_add_f32_dpp v18, v50, v17 wave_shr:1 row_mask:0xf bank_mask:0xf
  v_add_f32_dpp v22, v51, v21 wave_shr:1 row_mask:0xf bank_mask:0xf
  v_add_f32_dpp v58, v52, v57 wave_shr:1 row_mask:0xf bank_mask:0xf
  v_mfma_f32_16x16x32_bf16 v[60:63], v[160:163], v[96:99], v[60:63]
  v_add_f32_dpp v13, v10, v12 wave_ror:1 row_mask:0xf bank_mask:0xf
  v_add_f32_dpp v17, v14, v16 wave_ror:1 row_mask:0xf bank_mask:0xf
  v_add_f32_dpp v21, v18, v20 wave_ror:1 row_mask:0xf bank_mask:0xf
  v_mfma_f32_16x16x32_bf16 v[60:63], v[152:155], v[100:103], v[60:63]
  v_add_f32_dpp v57, v22, v56 wave_ror:1 row_mask:0xf bank_mask:0xf
  v_add_f32_dpp v13, v14, v12 wave_shr:1 row_mask:0xf bank_mask:0xf
  v_add_f32_dpp v17, v18, v16 wave_shr:1 row_mask:0xf bank_mask:0xf
  v_mfma_f32_16x16x32_bf16 v[60:63], v[144:147], v[104:107], v[60:63]
  v_add_f32_dpp v21, v22, v20 wave_shr:1 row_mask:0xf bank_mask:0xf
  v_add_f32_dpp v57, v58, v56 wave_shr:1 row_mask:0xf bank_mask:0xf
  v_cvt_pk_bf16_f32 v54, v13, v17
  v_mfma_f32_16x16x32_bf16 v[60:63], v[136:139], v[108:111], v[60:63]
  v_cvt_pk_bf16_f32 v55, v21, v57
  ds_write_b64 v6, v[54:55] offset:58624
  s_waitcnt lgkmcnt(0)
  s_barrier
  v_mfma_f32_16x16x32_bf16 v[60:63], v[128:131], v[112:115], v[60:63]
  ds_read_b64_tr_b16 v[36:37], v7 offset:58624
  s_waitcnt vmcnt(1)
  v_mov_b32_dpp v24, v26 row_shr:4 row_mask:0xf bank_mask:0xa
  v_mov_b32_dpp v25, v27 row_shr:4 row_mask:0xf bank_mask:0xa
  v_mfma_f32_16x16x32_bf16 v[240:243], v[228:231], v[64:67], 0
  v_and_b32 v27, s55, v25
  v_lshlrev_b32 v26, 16, v25
  v_and_b32 v25, s55, v24
  v_mfma_f32_16x16x32_bf16 v[240:243], v[220:223], v[68:71], v[240:243]
  v_lshlrev_b32 v24, 16, v24
  v_mfma_f32_16x16x32_bf16 v[240:243], v[212:215], v[72:75], v[240:243]
  v_mfma_f32_16x16x32_bf16 v[240:243], v[204:207], v[76:79], v[240:243]
  v_add_f32_dpp v53, v59, v62 wave_ror:1 row_mask:0xf bank_mask:0xf
  v_add_f32_dpp v38, v52, v61 wave_ror:1 row_mask:0xf bank_mask:0xf
  v_add_f32_dpp v56, v58, v60 wave_ror:1 row_mask:0xf bank_mask:0xf
  v_mfma_f32_16x16x32_bf16 v[240:243], v[196:199], v[80:83], v[240:243]
  v_add_f32_dpp v53, v63, v62 wave_shr:1 row_mask:0xf bank_mask:0xf
  v_mfma_f32_16x16x32_bf16 v[240:243], v[188:191], v[84:87], v[240:243]
  s_nop 0
  v_add_f32_dpp v38, v53, v61 wave_shr:1 row_mask:0xf bank_mask:0xf
  ds_read_b64_tr_b16 v[232:233], v5 offset:3360
  ds_read_b64_tr_b16 v[234:235], v5 offset:3328
  v_mfma_f32_16x16x32_bf16 v[240:243], v[180:183], v[88:91], v[240:243]
  v_add_f32_dpp v56, v38, v60 wave_shr:1 row_mask:0xf bank_mask:0xf
  s_waitcnt lgkmcnt(2)
  v_lshlrev_b32 v40, 16, v36
  v_and_b32 v41, s55, v36
  v_mfma_f32_16x16x32_bf16 v[240:243], v[172:175], v[92:95], v[240:243]
  v_lshlrev_b32 v42, 16, v37
  v_and_b32 v43, s55, v37
  v_mul_f32 v40, v40, v24
  v_mfma_f32_16x16x32_bf16 v[240:243], v[164:167], v[96:99], v[240:243]
  v_mul_f32 v41, v41, v25
  v_mul_f32 v42, v42, v26
  v_mul_f32 v43, v43, v27
  v_mfma_f32_16x16x32_bf16 v[240:243], v[156:159], v[100:103], v[240:243]
  v_cvt_pk_bf16_f32 v24, v40, v41
  v_cvt_pk_bf16_f32 v25, v42, v43
  s_nop 0
  v_mov_b32_dpp v26, v24 row_shl:4 row_mask:0xf bank_mask:0xf
  v_mfma_f32_16x16x32_bf16 v[240:243], v[148:151], v[104:107], v[240:243]
  v_mov_b32_dpp v27, v25 row_shl:4 row_mask:0xf bank_mask:0xf
  buffer_store_dwordx4 v[24:27], v44, s[40:43], s56 offen
  s_waitcnt vmcnt(1)
  v_mov_b32_dpp v28, v30 row_shr:4 row_mask:0xf bank_mask:0xa
  v_mfma_f32_16x16x32_bf16 v[240:243], v[140:143], v[108:111], v[240:243]
  v_mov_b32_dpp v29, v31 row_shr:4 row_mask:0xf bank_mask:0xa
  v_and_b32 v31, s55, v29
  v_lshlrev_b32 v30, 16, v29
  v_mfma_f32_16x16x32_bf16 v[240:243], v[132:135], v[112:115], v[240:243]
  v_and_b32 v29, s55, v28
  v_lshlrev_b32 v28, 16, v28
  s_waitcnt lgkmcnt(0)
  v_mfma_f32_16x16x32_bf16 v[244:247], v[232:235], v[64:67], 0
  v_mfma_f32_16x16x32_bf16 v[244:247], v[224:227], v[68:71], v[244:247]
  v_mfma_f32_16x16x32_bf16 v[244:247], v[216:219], v[72:75], v[244:247]
  s_nop 1
  v_add_f32_dpp v46, v63, v242 wave_ror:1 row_mask:0xf bank_mask:0xf
  v_add_f32_dpp v39, v53, v241 wave_ror:1 row_mask:0xf bank_mask:0xf
  v_add_f32_dpp v60, v38, v240 wave_ror:1 row_mask:0xf bank_mask:0xf
  v_mfma_f32_16x16x32_bf16 v[244:247], v[208:211], v[76:79], v[244:247]
  v_add_f32_dpp v46, v243, v242 wave_shr:1 row_mask:0xf bank_mask:0xf
  v_mfma_f32_16x16x32_bf16 v[244:247], v[200:203], v[80:83], v[244:247]
  s_nop 0
  v_add_f32_dpp v39, v46, v241 wave_shr:1 row_mask:0xf bank_mask:0xf
  v_mfma_f32_16x16x32_bf16 v[244:247], v[192:195], v[84:87], v[244:247]
  s_nop 0
  v_add_f32_dpp v60, v39, v240 wave_shr:1 row_mask:0xf bank_mask:0xf
  v_mfma_f32_16x16x32_bf16 v[244:247], v[184:187], v[88:91], v[244:247]
  ds_read_b64_tr_b16 v[236:237], v5 offset:3488
  ds_read_b64_tr_b16 v[238:239], v5 offset:3456
  v_mfma_f32_16x16x32_bf16 v[244:247], v[176:179], v[92:95], v[244:247]
  v_mfma_f32_16x16x32_bf16 v[244:247], v[168:171], v[96:99], v[244:247]
  v_mfma_f32_16x16x32_bf16 v[244:247], v[160:163], v[100:103], v[244:247]
  v_mfma_f32_16x16x32_bf16 v[244:247], v[152:155], v[104:107], v[244:247]
  v_mfma_f32_16x16x32_bf16 v[244:247], v[144:147], v[108:111], v[244:247]
  v_mfma_f32_16x16x32_bf16 v[244:247], v[136:139], v[112:115], v[244:247]
  v_mfma_f32_16x16x32_bf16 v[244:247], v[128:131], v[116:119], v[244:247]
  s_waitcnt lgkmcnt(0)
  v_mfma_f32_16x16x32_bf16 v[248:251], v[236:239], v[64:67], 0
  v_mfma_f32_16x16x32_bf16 v[248:251], v[228:231], v[68:71], v[248:251]
  v_mfma_f32_16x16x32_bf16 v[248:251], v[220:223], v[72:75], v[248:251]
  s_nop 3
  v_add_f32_dpp v47, v243, v246 wave_ror:1 row_mask:0xf bank_mask:0xf
  v_add_f32_dpp v38, v46, v245 wave_ror:1 row_mask:0xf bank_mask:0xf
  v_add_f32_dpp v240, v39, v244 wave_ror:1 row_mask:0xf bank_mask:0xf
  v_mfma_f32_16x16x32_bf16 v[248:251], v[212:215], v[76:79], v[248:251]
  v_add_f32_dpp v47, v247, v246 wave_shr:1 row_mask:0xf bank_mask:0xf
  v_mfma_f32_16x16x32_bf16 v[248:251], v[204:207], v[80:83], v[248:251]
  s_nop 0
  v_add_f32_dpp v38, v47, v245 wave_shr:1 row_mask:0xf bank_mask:0xf
  v_mfma_f32_16x16x32_bf16 v[248:251], v[196:199], v[84:87], v[248:251]
  s_nop 0
  v_add_f32_dpp v240, v38, v244 wave_shr:1 row_mask:0xf bank_mask:0xf
  v_mfma_f32_16x16x32_bf16 v[248:251], v[188:191], v[88:91], v[248:251]
  v_mfma_f32_16x16x32_bf16 v[248:251], v[180:183], v[92:95], v[248:251]
  v_mfma_f32_16x16x32_bf16 v[248:251], v[172:175], v[96:99], v[248:251]
  v_mfma_f32_16x16x32_bf16 v[248:251], v[164:167], v[100:103], v[248:251]
  v_mfma_f32_16x16x32_bf16 v[248:251], v[156:159], v[104:107], v[248:251]
  v_mfma_f32_16x16x32_bf16 v[248:251], v[148:151], v[108:111], v[248:251]
  v_mfma_f32_16x16x32_bf16 v[248:251], v[140:143], v[112:115], v[248:251]
  v_mfma_f32_16x16x32_bf16 v[248:251], v[132:135], v[116:119], v[248:251]
  s_nop 7
  v_add_f32_dpp v48, v247, v250 wave_ror:1 row_mask:0xf bank_mask:0xf
  v_add_f32_dpp v39, v47, v249 wave_ror:1 row_mask:0xf bank_mask:0xf
  v_add_f32_dpp v244, v38, v248 wave_ror:1 row_mask:0xf bank_mask:0xf
  v_add_f32_dpp v48, v251, v250 wave_shr:1 row_mask:0xf bank_mask:0xf
  s_nop 1
  v_add_f32_dpp v39, v48, v249 wave_shr:1 row_mask:0xf bank_mask:0xf
  s_nop 1
  v_add_f32_dpp v244, v39, v248 wave_shr:1 row_mask:0xf bank_mask:0xf
  v_cvt_pk_bf16_f32 v54, v56, v60
  v_cvt_pk_bf16_f32 v55, v240, v244
  ds_write_b64 v6, v[54:55] offset:59136
  s_waitcnt lgkmcnt(0)
  s_barrier
  ds_read_b64_tr_b16 v[36:37], v7 offset:59136
  s_waitcnt lgkmcnt(0)
  v_lshlrev_b32 v40, 16, v36
  v_and_b32 v41, s55, v36
  v_lshlrev_b32 v42, 16, v37
  v_and_b32 v43, s55, v37
  v_mul_f32 v40, v40, v28
  v_mul_f32 v41, v41, v29
  v_mul_f32 v42, v42, v30
  v_mul_f32 v43, v43, v31
  v_cvt_pk_bf16_f32 v28, v40, v41
  v_cvt_pk_bf16_f32 v29, v42, v43
  s_nop 0
  v_mov_b32_dpp v30, v28 row_shl:4 row_mask:0xf bank_mask:0xf
  v_mov_b32_dpp v31, v29 row_shl:4 row_mask:0xf bank_mask:0xf
  buffer_store_dwordx4 v[28:31], v44, s[40:43], s57 offen
  s_endpgm
.p2align 6
P_0:
  s_bitcmp1_b32 s9, 2
  s_cbranch_scc1 HFE0
  s_waitcnt vmcnt(0)
  s_mov_b64 exec, 1
  buffer_store_dwordx2 v[248:249], off, s[28:31], s49 sc1
  s_mov_b64 exec, -1
HFE0:
  s_cmp_ge_u32 s3, 5
  s_cbranch_scc1 PU0_OK
  v_cmp_ne_u64 vcc, s[10:11], v[42:43]
  s_nop 0
  s_cbranch_vccz PU0_OK
  s_mov_b32 s23, 0
PU0_L:
  buffer_load_dwordx2 v[42:43], v46, s[28:31], s47 offen sc1
  s_add_u32 s23, s23, 1
  s_waitcnt vmcnt(0)
  v_cmp_ne_u64 vcc, s[10:11], v[42:43]
  s_cmp_ge_u32 s23, 4000
  s_cbranch_scc1 PU0_OK
  s_cbranch_vccnz PU0_L
PU0_OK:
  s_barrier
  s_mov_b32 m0, s53
  s_nop 0
  buffer_load_dwordx4 v3, s[28:31], s12 offen offset:0 sc1 lds
  buffer_load_dwordx4 v3, s[28:31], s12 offen offset:3072 sc1 lds
  buffer_load_dwordx4 v3, s[28:31], s12 offen offset:2048 sc1 lds
  buffer_load_dwordx4 v3, s[28:31], s12 offen offset:1024 sc1 lds
  v_mov_b32 v16, 0
  s_sub_u32 s22, s53, 256
  v_lshl_add_u32 v17, v1, 2, s22
  ds_write_b32 v17, v16
  s_waitcnt vmcnt(4)
  s_barrier
  v_mov_b32 v52, s52
  ds_read_u16 v251, v52
  ds_read_b64_tr_b16 v[68:69], v4 offset:256
  ds_read_b64_tr_b16 v[70:71], v4 offset:288
  ds_read_b64_tr_b16 v[72:73], v4 offset:512
  ds_read_b64_tr_b16 v[74:75], v4 offset:544
  ds_read_b64_tr_b16 v[76:77], v4 offset:768
  ds_read_b64_tr_b16 v[78:79], v4 offset:800
  v_lshlrev_b32 v250, 16, v250
  s_waitcnt lgkmcnt(6)
  v_lshlrev_b32 v251, 16, v251
  v_add_f32 v250, v250, v251
  v_cvt_pk_bf16_f32 v250, v250, v250
  ds_write_b16 v52, v250
  ds_read_b64_tr_b16 v[64:65], v4 offset:0
  ds_read_b64_tr_b16 v[66:67], v4 offset:32
  buffer_load_dword v43, v47, s[36:39], s62 offen
  s_cmp_lt_u32 s3, 4
  s_cbranch_scc1 PRIO0
  s_setprio 1
PRIO0:
  s_waitcnt vmcnt(4)
  ds_read_b64_tr_b16 v[128:129], v5 offset:32
  ds_read_b64_tr_b16 v[130:131], v5 offset:0
  ds_read_b64_tr_b16 v[132:133], v5 offset:160
  ds_read_b64_tr_b16 v[134:135], v5 offset:128
  ds_read_b64_tr_b16 v[136:137], v5 offset:288
  ds_read_b64_tr_b16 v[138:139], v5 offset:256
  ds_read_b64_tr_b16 v[140:141], v5 offset:416
  ds_read_b64_tr_b16 v[142:143], v5 offset:384
  ds_read_b64_tr_b16 v[144:145], v5 offset:544
  ds_read_b64_tr_b16 v[146:147], v5 offset:512
  s_waitcnt lgkmcnt(8)
  v_mfma_f32_16x16x32_bf16 v[96:99], v[128:131], v[64:67], 0
  s_waitcnt lgkmcnt(6)
  v_mfma_f32_16x16x32_bf16 v[100:103], v[132:135], v[64:67], 0
  ds_read_b64_tr_b16 v[148:149], v5 offset:672
  ds_read_b64_tr_b16 v[150:151], v5 offset:640
  s_waitcnt lgkmcnt(6)
  v_mfma_f32_16x16x32_bf16 v[104:107], v[136:139], v[64:67], 0
  v_mfma_f32_16x16x32_bf16 v[104:107], v[128:131], v[68:71], v[104:107]
  s_waitcnt lgkmcnt(4)
  v_mfma_f32_16x16x32_bf16 v[108:111], v[140:143], v[64:67], 0
  ds_read_b64_tr_b16 v[152:153], v5 offset:800
  ds_read_b64_tr_b16 v[154:155], v5 offset:768
  v_mfma_f32_16x16x32_bf16 v[108:111], v[132:135], v[68:71], v[108:111]
  s_waitcnt lgkmcnt(4)
  v_mfma_f32_16x16x32_bf16 v[112:115], v[144:147], v[64:67], 0
  v_mfma_f32_16x16x32_bf16 v[112:115], v[136:139], v[68:71], v[112:115]
  v_mfma_f32_16x16x32_bf16 v[112:115], v[128:131], v[72:75], v[112:115]
  v_add_f32_dpp v49, v99, v102 wave_ror:1 row_mask:0xf bank_mask:0xf
  v_add_f32_dpp v50, v103, v106 wave_ror:1 row_mask:0xf bank_mask:0xf
  s_nop 1
  v_add_f32_dpp v51, v107, v110 wave_ror:1 row_mask:0xf bank_mask:0xf
  ds_read_b64_tr_b16 v[156:157], v5 offset:928
  ds_read_b64_tr_b16 v[158:159], v5 offset:896
  s_waitcnt lgkmcnt(4)
  v_mfma_f32_16x16x32_bf16 v[116:119], v[148:151], v[64:67], 0
  v_add_f32_dpp v48, v99, v98 wave_shr:1 row_mask:0xf bank_mask:0xf bound_ctrl:0
  v_add_f32_dpp v49, v103, v102 wave_shr:1 row_mask:0xf bank_mask:0xf
  v_add_f32_dpp v50, v107, v106 wave_shr:1 row_mask:0xf bank_mask:0xf
  v_mfma_f32_16x16x32_bf16 v[116:119], v[140:143], v[68:71], v[116:119]
  v_add_f32_dpp v51, v111, v110 wave_shr:1 row_mask:0xf bank_mask:0xf
  v_add_f32_dpp v102, v48, v101 wave_ror:1 row_mask:0xf bank_mask:0xf
  v_add_f32_dpp v106, v49, v105 wave_ror:1 row_mask:0xf bank_mask:0xf
  v_mfma_f32_16x16x32_bf16 v[116:119], v[132:135], v[72:75], v[116:119]
  v_add_f32_dpp v110, v50, v109 wave_ror:1 row_mask:0xf bank_mask:0xf
  v_add_f32_dpp v98, v48, v97 wave_shr:1 row_mask:0xf bank_mask:0xf bound_ctrl:0
  v_add_f32_dpp v102, v49, v101 wave_shr:1 row_mask:0xf bank_mask:0xf
  s_waitcnt lgkmcnt(2)
  v_mfma_f32_16x16x32_bf16 v[120:123], v[152:155], v[64:67], 0
  v_add_f32_dpp v106, v50, v105 wave_shr:1 row_mask:0xf bank_mask:0xf
  v_add_f32_dpp v110, v51, v109 wave_shr:1 row_mask:0xf bank_mask:0xf
  v_add_f32_dpp v101, v98, v100 wave_ror:1 row_mask:0xf bank_mask:0xf
  s_waitcnt vmcnt(3)
  ds_read_b64_tr_b16 v[252:253], v5 offset:4000
  ds_read_b64_tr_b16 v[254:255], v5 offset:3968
  v_mfma_f32_16x16x32_bf16 v[120:123], v[144:147], v[68:71], v[120:123]
  v_add_f32_dpp v105, v102, v104 wave_ror:1 row_mask:0xf bank_mask:0xf
  v_add_f32_dpp v109, v106, v108 wave_ror:1 row_mask:0xf bank_mask:0xf
  v_add_f32_dpp v97, v98, v96 wave_shr:1 row_mask:0xf bank_mask:0xf bound_ctrl:0
  ds_read_b64_tr_b16 v[248:249], v5 offset:3872
  ds_read_b64_tr_b16 v[250:251], v5 offset:3840
  v_mfma_f32_16x16x32_bf16 v[120:123], v[136:139], v[72:75], v[120:123]
  v_add_f32_dpp v101, v102, v100 wave_shr:1 row_mask:0xf bank_mask:0xf
  v_add_f32_dpp v105, v106, v104 wave_shr:1 row_mask:0xf bank_mask:0xf
  v_add_f32_dpp v109, v110, v108 wave_shr:1 row_mask:0xf bank_mask:0xf
  ds_read_b64_tr_b16 v[244:245], v5 offset:3744
  ds_read_b64_tr_b16 v[246:247], v5 offset:3712
  v_mfma_f32_16x16x32_bf16 v[120:123], v[128:131], v[76:79], v[120:123]
  v_cvt_pk_bf16_f32 v54, v97, v101
  v_cvt_pk_bf16_f32 v55, v105, v109
  ds_write_b64 v6, v[54:55] offset:58624
  ds_read_b64_tr_b16 v[240:241], v5 offset:3616
  ds_read_b64_tr_b16 v[242:243], v5 offset:3584
  s_waitcnt lgkmcnt(9)
  v_mfma_f32_16x16x32_bf16 v[124:127], v[156:159], v[64:67], 0
  ds_read_b64_tr_b16 v[236:237], v5 offset:3488
  ds_read_b64_tr_b16 v[238:239], v5 offset:3456
  v_mfma_f32_16x16x32_bf16 v[124:127], v[148:151], v[68:71], v[124:127]
  v_mfma_f32_16x16x32_bf16 v[124:127], v[140:143], v[72:75], v[124:127]
  v_mfma_f32_16x16x32_bf16 v[124:127], v[132:135], v[76:79], v[124:127]
  s_waitcnt lgkmcnt(9)
  v_mfma_f32_16x16x32_bf16 v[56:59], v[252:255], v[64:67], 0
  ds_read_b64_tr_b16 v[232:233], v5 offset:3360
  ds_read_b64_tr_b16 v[234:235], v5 offset:3328
  s_waitcnt lgkmcnt(9)
  v_mfma_f32_16x16x32_bf16 v[20:23], v[248:251], v[64:67], 0
  s_waitcnt vmcnt(2)
  ds_read_b64_tr_b16 v[228:229], v5 offset:3232
  ds_read_b64_tr_b16 v[230:231], v5 offset:3200
  s_waitcnt lgkmcnt(9)
  v_mfma_f32_16x16x32_bf16 v[16:19], v[244:247], v[64:67], 0
  v_add_f32_dpp v52, v111, v114 wave_ror:1 row_mask:0xf bank_mask:0xf
  v_add_f32_dpp v53, v115, v118 wave_ror:1 row_mask:0xf bank_mask:0xf
  v_add_f32_dpp v46, v119, v122 wave_ror:1 row_mask:0xf bank_mask:0xf
  s_waitcnt lgkmcnt(6)
  v_mfma_f32_16x16x32_bf16 v[12:15], v[240:243], v[64:67], 0
  v_add_f32_dpp v47, v123, v126 wave_ror:1 row_mask:0xf bank_mask:0xf
  v_add_f32_dpp v52, v115, v114 wave_shr:1 row_mask:0xf bank_mask:0xf
  v_add_f32_dpp v53, v119, v118 wave_shr:1 row_mask:0xf bank_mask:0xf
  s_waitcnt lgkmcnt(4)
  v_mfma_f32_16x16x32_bf16 v[8:11], v[236:239], v[64:67], 0
  v_add_f32_dpp v46, v123, v122 wave_shr:1 row_mask:0xf bank_mask:0xf
  v_add_f32_dpp v47, v127, v126 wave_shr:1 row_mask:0xf bank_mask:0xf
  v_add_f32_dpp v114, v51, v113 wave_ror:1 row_mask:0xf bank_mask:0xf
  v_mfma_f32_16x16x32_bf16 v[56:59], v[244:247], v[68:71], v[56:59]
  v_add_f32_dpp v118, v52, v117 wave_ror:1 row_mask:0xf bank_mask:0xf
  v_add_f32_dpp v122, v53, v121 wave_ror:1 row_mask:0xf bank_mask:0xf
  v_add_f32_dpp v126, v46, v125 wave_ror:1 row_mask:0xf bank_mask:0xf
  s_add_u32 s56, s54, 0x0
  buffer_load_dwordx4 v[24:27], v45, s[36:39], s56 offen
  s_add_u32 s56, s54, 0x500
  ds_read_b64_tr_b16 v[224:225], v5 offset:3104
  ds_read_b64_tr_b16 v[226:227], v5 offset:3072
  v_mfma_f32_16x16x32_bf16 v[20:23], v[240:243], v[68:71], v[20:23]
  v_add_f32_dpp v114, v52, v113 wave_shr:1 row_mask:0xf bank_mask:0xf
  v_add_f32_dpp v118, v53, v117 wave_shr:1 row_mask:0xf bank_mask:0xf
  v_add_f32_dpp v122, v46, v121 wave_shr:1 row_mask:0xf bank_mask:0xf
  ds_read_b64_tr_b16 v[220:221], v5 offset:2976
  ds_read_b64_tr_b16 v[222:223], v5 offset:2944
  v_mfma_f32_16x16x32_bf16 v[16:19], v[236:239], v[68:71], v[16:19]
  v_add_f32_dpp v126, v47, v125 wave_shr:1 row_mask:0xf bank_mask:0xf
  v_add_f32_dpp v113, v110, v112 wave_ror:1 row_mask:0xf bank_mask:0xf
  v_add_f32_dpp v117, v114, v116 wave_ror:1 row_mask:0xf bank_mask:0xf
  s_waitcnt lgkmcnt(6)
  v_mfma_f32_16x16x32_bf16 v[12:15], v[232:235], v[68:71], v[12:15]
  v_add_f32_dpp v121, v118, v120 wave_ror:1 row_mask:0xf bank_mask:0xf
  v_add_f32_dpp v125, v122, v124 wave_ror:1 row_mask:0xf bank_mask:0xf
  v_add_f32_dpp v113, v114, v112 wave_shr:1 row_mask:0xf bank_mask:0xf
  s_waitcnt lgkmcnt(4)
  v_mfma_f32_16x16x32_bf16 v[8:11], v[228:231], v[68:71], v[8:11]
  v_add_f32_dpp v117, v118, v116 wave_shr:1 row_mask:0xf bank_mask:0xf
  v_add_f32_dpp v121, v122, v120 wave_shr:1 row_mask:0xf bank_mask:0xf
  v_add_f32_dpp v125, v126, v124 wave_shr:1 row_mask:0xf bank_mask:0xf
  s_add_u32 s57, s54, 0x50000
  buffer_load_dwordx4 v[28:31], v45, s[36:39], s57 offen
  s_add_u32 s57, s54, 0xa0500
  v_mfma_f32_16x16x32_bf16 v[56:59], v[236:239], v[72:75], v[56:59]
  v_cvt_pk_bf16_f32 v54, v113, v117
  v_cvt_pk_bf16_f32 v55, v121, v125
  ds_write_b64 v6, v[54:55] offset:59136
  ds_read_b64_tr_b16 v[216:217], v5 offset:2848
  ds_read_b64_tr_b16 v[218:219], v5 offset:2816
  v_mfma_f32_16x16x32_bf16 v[20:23], v[232:235], v[72:75], v[20:23]
  s_waitcnt lgkmcnt(0)
  s_barrier
  ds_read_b64_tr_b16 v[36:37], v7 offset:58624
  ds_read_b64_tr_b16 v[212:213], v5 offset:2720
  ds_read_b64_tr_b16 v[214:215], v5 offset:2688
  v_mfma_f32_16x16x32_bf16 v[16:19], v[228:231], v[72:75], v[16:19]
  ds_read_b64_tr_b16 v[80:81], v4 offset:1024
  ds_read_b64_tr_b16 v[82:83], v4 offset:1056
  v_mfma_f32_16x16x32_bf16 v[12:15], v[224:227], v[72:75], v[12:15]
  s_add_u32 s58, s54, 0x230000
  buffer_load_dwordx4 v[32:35], v45, s[36:39], s58 offen
  s_add_u32 s58, s54, 0x460500
  v_mfma_f32_16x16x32_bf16 v[8:11], v[220:223], v[72:75], v[8:11]
  v_mfma_f32_16x16x32_bf16 v[56:59], v[228:231], v[76:79], v[56:59]
  ds_read_b64_tr_b16 v[208:209], v5 offset:2592
  ds_read_b64_tr_b16 v[210:211], v5 offset:2560
  v_mfma_f32_16x16x32_bf16 v[20:23], v[224:227], v[76:79], v[20:23]
  ds_read_b64_tr_b16 v[204:205], v5 offset:2464
  ds_read_b64_tr_b16 v[206:207], v5 offset:2432
  v_mfma_f32_16x16x32_bf16 v[16:19], v[220:223], v[76:79], v[16:19]
  s_andn2_b32 s16, 4, s9
  s_cbranch_scc1 HF0_0E
  buffer_load_dwordx2 v[46:47], v61, s[28:31], s59 offen sc1
HF0_0E:
  ds_read_b64_tr_b16 v[84:85], v4 offset:1280
  ds_read_b64_tr_b16 v[86:87], v4 offset:1312
  v_mfma_f32_16x16x32_bf16 v[12:15], v[216:219], v[76:79], v[12:15]
  s_waitcnt lgkmcnt(8)
  v_mfma_f32_16x16x32_bf16 v[8:11], v[212:215], v[76:79], v[8:11]
  s_waitcnt lgkmcnt(6)
  v_mfma_f32_16x16x32_bf16 v[56:59], v[220:223], v[80:83], v[56:59]
  ds_read_b64_tr_b16 v[200:201], v5 offset:2336
  ds_read_b64_tr_b16 v[202:203], v5 offset:2304
  v_mfma_f32_16x16x32_bf16 v[20:23], v[216:219], v[80:83], v[20:23]
  s_waitcnt vmcnt(4)
  ds_read_b64_tr_b16 v[196:197], v5 offset:2208
  ds_read_b64_tr_b16 v[198:199], v5 offset:2176
  v_mfma_f32_16x16x32_bf16 v[16:19], v[212:215], v[80:83], v[16:19]
  ds_read_b64_tr_b16 v[88:89], v4 offset:1536
  ds_read_b64_tr_b16 v[90:91], v4 offset:1568
  s_waitcnt lgkmcnt(10)
  v_mfma_f32_16x16x32_bf16 v[12:15], v[208:211], v[80:83], v[12:15]
  s_waitcnt lgkmcnt(8)
  v_mfma_f32_16x16x32_bf16 v[8:11], v[204:207], v[80:83], v[8:11]
  s_waitcnt lgkmcnt(6)
  v_mfma_f32_16x16x32_bf16 v[56:59], v[212:215], v[84:87], v[56:59]
  ds_read_b64_tr_b16 v[192:193], v5 offset:2080
  ds_read_b64_tr_b16 v[194:195], v5 offset:2048
  v_mfma_f32_16x16x32_bf16 v[20:23], v[208:211], v[84:87], v[20:23]
  ds_read_b64_tr_b16 v[188:189], v5 offset:1952
  ds_read_b64_tr_b16 v[190:191], v5 offset:1920
  v_mfma_f32_16x16x32_bf16 v[16:19], v[204:207], v[84:87], v[16:19]
  ds_read_b64_tr_b16 v[92:93], v4 offset:1792
  ds_read_b64_tr_b16 v[94:95], v4 offset:1824
  s_waitcnt lgkmcnt(10)
  v_mfma_f32_16x16x32_bf16 v[12:15], v[200:203], v[84:87], v[12:15]
  s_waitcnt lgkmcnt(8)
  v_mfma_f32_16x16x32_bf16 v[8:11], v[196:199], v[84:87], v[8:11]
  s_waitcnt lgkmcnt(6)
  v_mfma_f32_16x16x32_bf16 v[56:59], v[204:207], v[88:91], v[56:59]
  ds_read_b64_tr_b16 v[184:185], v5 offset:1824
  ds_read_b64_tr_b16 v[186:187], v5 offset:1792
  v_mfma_f32_16x16x32_bf16 v[20:23], v[200:203], v[88:91], v[20:23]
  ds_read_b64_tr_b16 v[180:181], v5 offset:1696
  ds_read_b64_tr_b16 v[182:183], v5 offset:1664
  v_mfma_f32_16x16x32_bf16 v[16:19], v[196:199], v[88:91], v[16:19]
  ds_read_b64_tr_b16 v[96:97], v4 offset:2048
  ds_read_b64_tr_b16 v[98:99], v4 offset:2080
  s_waitcnt lgkmcnt(10)
  v_mfma_f32_16x16x32_bf16 v[12:15], v[192:195], v[88:91], v[12:15]
  s_waitcnt lgkmcnt(8)
  v_mfma_f32_16x16x32_bf16 v[8:11], v[188:191], v[88:91], v[8:11]
  s_waitcnt lgkmcnt(6)
  v_mfma_f32_16x16x32_bf16 v[56:59], v[196:199], v[92:95], v[56:59]
  ds_read_b64_tr_b16 v[176:177], v5 offset:1568
  ds_read_b64_tr_b16 v[178:179], v5 offset:1536
  v_mfma_f32_16x16x32_bf16 v[20:23], v[192:195], v[92:95], v[20:23]
  ds_read_b64_tr_b16 v[172:173], v5 offset:1440
  ds_read_b64_tr_b16 v[174:175], v5 offset:1408
  v_mfma_f32_16x16x32_bf16 v[16:19], v[188:191], v[92:95], v[16:19]
  s_cmp_ge_u32 s16, 2
  s_cbranch_scc1 HC0_0_E
  s_waitcnt vmcnt(0)
  s_cmp_eq_u32 s16, 1
  s_cbranch_scc1 HC0_0_I
  v_cmp_ne_u64 vcc, s[10:11], v[46:47]
  s_nop 0
  s_cbranch_vccz HC0_0_OK
  buffer_load_dwordx2 v[46:47], v61, s[28:31], s59 offen sc1
  s_branch HC0_0_E
HC0_0_OK:
  s_add_u32 m0, s44, 0
  s_nop 0
  buffer_load_dwordx4 v62, s[28:31], s60 offen offset:0 sc1 lds
  s_add_u32 m0, s44, 1024
  s_nop 0
  buffer_load_dwordx4 v63, s[28:31], s61 offen offset:0 sc1 lds
HC0_0_I:
  s_add_u32 s16, s16, 1
HC0_0_E:
  ds_read_b64_tr_b16 v[100:101], v4 offset:2304
  ds_read_b64_tr_b16 v[102:103], v4 offset:2336
  ds_read_b64_tr_b16 v[164:165], v5 offset:1184
  ds_read_b64_tr_b16 v[166:167], v5 offset:1152
  s_waitcnt lgkmcnt(12)
  v_mfma_f32_16x16x32_bf16 v[12:15], v[184:187], v[92:95], v[12:15]
  ds_read_b64_tr_b16 v[104:105], v4 offset:2560
  ds_read_b64_tr_b16 v[106:107], v4 offset:2592
  s_waitcnt lgkmcnt(12)
  v_mfma_f32_16x16x32_bf16 v[8:11], v[180:183], v[92:95], v[8:11]
  ds_read_b64_tr_b16 v[108:109], v4 offset:2816
  ds_read_b64_tr_b16 v[110:111], v4 offset:2848
  s_waitcnt lgkmcnt(12)
  v_mfma_f32_16x16x32_bf16 v[56:59], v[188:191], v[96:99], v[56:59]
  s_waitcnt vmcnt(2)
  v_mov_b32_dpp v24, v26 row_shr:4 row_mask:0xf bank_mask:0xa
  v_mov_b32_dpp v25, v27 row_shr:4 row_mask:0xf bank_mask:0xa
  v_and_b32 v27, s55, v25
  ds_read_b64_tr_b16 v[112:113], v4 offset:3072
  ds_read_b64_tr_b16 v[114:115], v4 offset:3104
  v_mfma_f32_16x16x32_bf16 v[20:23], v[184:187], v[96:99], v[20:23]
  v_lshlrev_b32 v26, 16, v25
  v_and_b32 v25, s55, v24
  v_lshlrev_b32 v24, 16, v24
  ds_read_b64_tr_b16 v[116:117], v4 offset:3328
  ds_read_b64_tr_b16 v[118:119], v4 offset:3360
  v_mfma_f32_16x16x32_bf16 v[16:19], v[180:183], v[96:99], v[16:19]
  ds_read_b64_tr_b16 v[168:169], v5 offset:1312
  ds_read_b64_tr_b16 v[170:171], v5 offset:1280
  s_waitcnt lgkmcnt(15)
  v_mfma_f32_16x16x32_bf16 v[12:15], v[176:179], v[96:99], v[12:15]
  v_lshlrev_b32 v40, 16, v36
  v_and_b32 v41, s55, v36
  v_lshlrev_b32 v42, 16, v37
  ds_read_b64_tr_b16 v[160:161], v5 offset:1056
  ds_read_b64_tr_b16 v[162:163], v5 offset:1024
  s_waitcnt lgkmcnt(15)
  v_mfma_f32_16x16x32_bf16 v[8:11], v[172:175], v[96:99], v[8:11]
  v_and_b32 v43, s55, v37
  v_mul_f32 v40, v40, v24
  v_mul_f32 v41, v41, v25
  s_waitcnt lgkmcnt(12)
  v_mfma_f32_16x16x32_bf16 v[8:11], v[164:167], v[100:103], v[8:11]
  v_mul_f32 v42, v42, v26
  v_mul_f32 v43, v43, v27
  v_cvt_pk_bf16_f32 v24, v40, v41
  s_waitcnt lgkmcnt(10)
  v_mfma_f32_16x16x32_bf16 v[8:11], v[156:159], v[104:107], v[8:11]
  v_cvt_pk_bf16_f32 v25, v42, v43
  v_mov_b32_dpp v26, v24 row_shl:4 row_mask:0xf bank_mask:0xf
  s_nop 0
  v_mov_b32_dpp v27, v25 row_shl:4 row_mask:0xf bank_mask:0xf
  s_waitcnt lgkmcnt(8)
  v_mfma_f32_16x16x32_bf16 v[8:11], v[148:151], v[108:111], v[8:11]
  buffer_store_dwordx4 v[24:27], v44, s[40:43], s56 offen
  ds_read_b64_tr_b16 v[36:37], v7 offset:59136
  s_waitcnt vmcnt(2)
  v_mov_b32_dpp v28, v30 row_shr:4 row_mask:0xf bank_mask:0xa
  ds_read_b64_tr_b16 v[120:121], v4 offset:3584
  ds_read_b64_tr_b16 v[122:123], v4 offset:3616
  s_waitcnt lgkmcnt(9)
  v_mfma_f32_16x16x32_bf16 v[8:11], v[140:143], v[112:115], v[8:11]
  v_mov_b32_dpp v29, v31 row_shr:4 row_mask:0xf bank_mask:0xa
  v_and_b32 v31, s55, v29
  v_lshlrev_b32 v30, 16, v29
  s_waitcnt lgkmcnt(7)
  v_mfma_f32_16x16x32_bf16 v[8:11], v[132:135], v[116:119], v[8:11]
  v_and_b32 v29, s55, v28
  v_lshlrev_b32 v28, 16, v28
  s_waitcnt lgkmcnt(5)
  v_mfma_f32_16x16x32_bf16 v[12:15], v[168:171], v[100:103], v[12:15]
  s_waitcnt lgkmcnt(2)
  v_lshlrev_b32 v40, 16, v36
  v_and_b32 v41, s55, v36
  v_lshlrev_b32 v42, 16, v37
  v_mfma_f32_16x16x32_bf16 v[12:15], v[160:163], v[104:107], v[12:15]
  v_and_b32 v43, s55, v37
  v_mul_f32 v40, v40, v28
  v_mul_f32 v41, v41, v29
  v_mfma_f32_16x16x32_bf16 v[12:15], v[152:155], v[108:111], v[12:15]
  v_mul_f32 v42, v42, v30
  v_mul_f32 v43, v43, v31
  v_cvt_pk_bf16_f32 v28, v40, v41
  v_mfma_f32_16x16x32_bf16 v[12:15], v[144:147], v[112:115], v[12:15]
  v_cvt_pk_bf16_f32 v29, v42, v43
  v_mov_b32_dpp v30, v28 row_shl:4 row_mask:0xf bank_mask:0xf
  s_nop 0
  v_mov_b32_dpp v31, v29 row_shl:4 row_mask:0xf bank_mask:0xf
  v_mfma_f32_16x16x32_bf16 v[12:15], v[136:139], v[116:119], v[12:15]
  buffer_store_dwordx4 v[28:31], v44, s[40:43], s57 offen
  s_waitcnt vmcnt(2)
  v_mov_b32_dpp v32, v34 row_shr:4 row_mask:0xf bank_mask:0xa
  v_mov_b32_dpp v33, v35 row_shr:4 row_mask:0xf bank_mask:0xa
  s_waitcnt lgkmcnt(0)
  v_mfma_f32_16x16x32_bf16 v[12:15], v[128:131], v[120:123], v[12:15]
  v_and_b32 v35, s55, v33
  v_lshlrev_b32 v34, 16, v33
  v_and_b32 v33, s55, v32
  v_mfma_f32_16x16x32_bf16 v[16:19], v[172:175], v[100:103], v[16:19]
  v_lshlrev_b32 v32, 16, v32
  v_add_f32_dpp v48, v11, v10 wave_shr:1 row_mask:0xf bank_mask:0xf bound_ctrl:0
  s_nop 1
  v_add_f32_dpp v10, v48, v9 wave_shr:1 row_mask:0xf bank_mask:0xf bound_ctrl:0
  v_mfma_f32_16x16x32_bf16 v[16:19], v[164:167], v[104:107], v[16:19]
  s_cmp_ge_u32 s16, 2
  s_cbranch_scc1 HC0_1_E
  s_waitcnt vmcnt(2)
  s_cmp_eq_u32 s16, 1
  s_cbranch_scc1 HC0_1_I
  v_cmp_ne_u64 vcc, s[10:11], v[46:47]
  s_nop 0
  s_cbranch_vccz HC0_1_OK
  buffer_load_dwordx2 v[46:47], v61, s[28:31], s59 offen sc1
  s_branch HC0_1_E
HC0_1_OK:
  s_add_u32 m0, s44, 0
  s_nop 0
  buffer_load_dwordx4 v62, s[28:31], s60 offen offset:0 sc1 lds
  s_add_u32 m0, s44, 1024
  s_nop 0
  buffer_load_dwordx4 v63, s[28:31], s61 offen offset:0 sc1 lds
HC0_1_I:
  s_add_u32 s16, s16, 1
HC0_1_E:
  v_mfma_f32_16x16x32_bf16 v[16:19], v[156:159], v[108:111], v[16:19]
  v_add_f32_dpp v49, v11, v14 wave_ror:1 row_mask:0xf bank_mask:0xf
  v_add_f32_dpp v38, v48, v13 wave_ror:1 row_mask:0xf bank_mask:0xf
  v_add_f32_dpp v8, v10, v12 wave_ror:1 row_mask:0xf bank_mask:0xf
  v_mfma_f32_16x16x32_bf16 v[16:19], v[148:151], v[112:115], v[16:19]
  v_add_f32_dpp v49, v15, v14 wave_shr:1 row_mask:0xf bank_mask:0xf
  v_mfma_f32_16x16x32_bf16 v[16:19], v[140:143], v[116:119], v[16:19]
  s_nop 0
  v_add_f32_dpp v38, v49, v13 wave_shr:1 row_mask:0xf bank_mask:0xf
  ds_read_b64_tr_b16 v[124:125], v4 offset:3840
  ds_read_b64_tr_b16 v[126:127], v4 offset:3872
  v_mfma_f32_16x16x32_bf16 v[16:19], v[132:135], v[120:123], v[16:19]
  v_add_f32_dpp v8, v38, v12 wave_shr:1 row_mask:0xf bank_mask:0xf
  v_mfma_f32_16x16x32_bf16 v[20:23], v[176:179], v[100:103], v[20:23]
  v_mfma_f32_16x16x32_bf16 v[20:23], v[168:171], v[104:107], v[20:23]
  v_mfma_f32_16x16x32_bf16 v[20:23], v[160:163], v[108:111], v[20:23]
  s_nop 3
  v_add_f32_dpp v50, v15, v18 wave_ror:1 row_mask:0xf bank_mask:0xf
  v_add_f32_dpp v39, v49, v17 wave_ror:1 row_mask:0xf bank_mask:0xf
  v_add_f32_dpp v12, v38, v16 wave_ror:1 row_mask:0xf bank_mask:0xf
  v_mfma_f32_16x16x32_bf16 v[20:23], v[152:155], v[112:115], v[20:23]
  v_add_f32_dpp v50, v19, v18 wave_shr:1 row_mask:0xf bank_mask:0xf
  v_mfma_f32_16x16x32_bf16 v[20:23], v[144:147], v[116:119], v[20:23]
  s_nop 0
  v_add_f32_dpp v39, v50, v17 wave_shr:1 row_mask:0xf bank_mask:0xf
  v_mfma_f32_16x16x32_bf16 v[20:23], v[136:139], v[120:123], v[20:23]
  s_nop 0
  v_add_f32_dpp v12, v39, v16 wave_shr:1 row_mask:0xf bank_mask:0xf
  s_waitcnt lgkmcnt(0)
  v_mfma_f32_16x16x32_bf16 v[20:23], v[128:131], v[124:127], v[20:23]
  s_bitcmp1_b32 s9, 2
  s_cbranch_scc0 PA_NOA2
  v_xor_b32 v24, 0, v60
  v_xor_b32 v25, 32, v60
  v_xor_b32 v26, 64, v60
  v_xor_b32 v27, 96, v60
  v_lshl_add_u32 v28, v2, 12, v3
  v_add_u32 v28, 71424, v28
  ds_read_b128 v[64:67], v28 offset:0
  ds_read_b128 v[68:71], v28 offset:1024
  ds_read_b128 v[72:75], v28 offset:2048
  ds_read_b128 v[76:79], v28 offset:3072
  s_cmp_ge_u32 s16, 2
  s_cbranch_scc1 HC0_2_E
  s_waitcnt vmcnt(0)
  s_cmp_eq_u32 s16, 1
  s_cbranch_scc1 HC0_2_I
  v_cmp_ne_u64 vcc, s[10:11], v[46:47]
  s_nop 0
  s_cbranch_vccz HC0_2_OK
  s_mov_b32 s23, 0
HC0_2_L:
  buffer_load_dwordx2 v[46:47], v61, s[28:31], s59 offen sc1
  s_add_u32 s23, s23, 1
  s_waitcnt vmcnt(0)
  v_cmp_ne_u64 vcc, s[10:11], v[46:47]
  s_cmp_ge_u32 s23, 4000
  s_cbranch_scc1 HC0_2_OK
  s_cbranch_vccnz HC0_2_L
HC0_2_OK:
  s_add_u32 m0, s44, 0
  s_nop 0
  buffer_load_dwordx4 v62, s[28:31], s60 offen offset:0 sc1 lds
  s_add_u32 m0, s44, 1024
  s_nop 0
  buffer_load_dwordx4 v63, s[28:31], s61 offen offset:0 sc1 lds
  s_waitcnt vmcnt(0)
HC0_2_I:
  s_add_u32 s16, s16, 1
HC0_2_E:
  s_barrier
  ds_read_b64_tr_b16 v[192:193], v24 offset:0
  ds_read_b64_tr_b16 v[194:195], v24 offset:512
  ds_read_b64_tr_b16 v[196:197], v25 offset:0
  ds_read_b64_tr_b16 v[198:199], v25 offset:512
  ds_read_b64_tr_b16 v[200:201], v26 offset:0
  ds_read_b64_tr_b16 v[202:203], v26 offset:512
  ds_read_b64_tr_b16 v[204:205], v27 offset:0
  ds_read_b64_tr_b16 v[206:207], v27 offset:512
  ds_read_b64_tr_b16 v[208:209], v24 offset:4096
  ds_read_b64_tr_b16 v[210:211], v24 offset:4608
  ds_read_b64_tr_b16 v[212:213], v25 offset:4096
  ds_read_b64_tr_b16 v[214:215], v25 offset:4608
  v_mfma_f32_16x16x32_bf16 v[56:59], v[180:183], v[100:103], v[56:59]
  v_mfma_f32_16x16x32_bf16 v[56:59], v[172:175], v[104:107], v[56:59]
  v_mfma_f32_16x16x32_bf16 v[56:59], v[164:167], v[108:111], v[56:59]
  v_add_f32_dpp v51, v19, v22 wave_ror:1 row_mask:0xf bank_mask:0xf
  v_add_f32_dpp v38, v50, v21 wave_ror:1 row_mask:0xf bank_mask:0xf
  v_add_f32_dpp v16, v39, v20 wave_ror:1 row_mask:0xf bank_mask:0xf
  ds_read_b64_tr_b16 v[216:217], v26 offset:4096
  ds_read_b64_tr_b16 v[218:219], v26 offset:4608
  s_waitcnt lgkmcnt(12)
  v_mfma_f32_16x16x32_bf16 v[80:83], v[64:67], v[192:195], 0
  v_add_f32_dpp v51, v23, v22 wave_shr:1 row_mask:0xf bank_mask:0xf
  ds_read_b64_tr_b16 v[220:221], v27 offset:4096
  ds_read_b64_tr_b16 v[222:223], v27 offset:4608
  s_waitcnt lgkmcnt(12)
  v_mfma_f32_16x16x32_bf16 v[84:87], v[64:67], v[196:199], 0
  v_add_f32_dpp v38, v51, v21 wave_shr:1 row_mask:0xf bank_mask:0xf
  ds_read_b64_tr_b16 v[224:225], v24 offset:8192
  ds_read_b64_tr_b16 v[226:227], v24 offset:8704
  s_waitcnt lgkmcnt(12)
  v_mfma_f32_16x16x32_bf16 v[88:91], v[64:67], v[200:203], 0
  v_add_f32_dpp v16, v38, v20 wave_shr:1 row_mask:0xf bank_mask:0xf
  ds_read_b64_tr_b16 v[228:229], v25 offset:8192
  ds_read_b64_tr_b16 v[230:231], v25 offset:8704
  s_waitcnt lgkmcnt(12)
  v_mfma_f32_16x16x32_bf16 v[92:95], v[64:67], v[204:207], 0
  ds_read_b64_tr_b16 v[232:233], v26 offset:8192
  ds_read_b64_tr_b16 v[234:235], v26 offset:8704
  s_waitcnt lgkmcnt(12)
  v_mfma_f32_16x16x32_bf16 v[80:83], v[68:71], v[208:211], v[80:83]
  ds_read_b64_tr_b16 v[236:237], v27 offset:8192
  ds_read_b64_tr_b16 v[238:239], v27 offset:8704
  s_waitcnt lgkmcnt(12)
  v_mfma_f32_16x16x32_bf16 v[84:87], v[68:71], v[212:215], v[84:87]
  ds_read_b64_tr_b16 v[240:241], v24 offset:12288
  ds_read_b64_tr_b16 v[242:243], v24 offset:12800
  s_waitcnt lgkmcnt(12)
  v_mfma_f32_16x16x32_bf16 v[88:91], v[68:71], v[216:219], v[88:91]
  ds_read_b64_tr_b16 v[244:245], v25 offset:12288
  ds_read_b64_tr_b16 v[246:247], v25 offset:12800
  s_waitcnt lgkmcnt(12)
  v_mfma_f32_16x16x32_bf16 v[92:95], v[68:71], v[220:223], v[92:95]
  ds_read_b64_tr_b16 v[248:249], v26 offset:12288
  ds_read_b64_tr_b16 v[250:251], v26 offset:12800
  s_waitcnt lgkmcnt(12)
  v_mfma_f32_16x16x32_bf16 v[80:83], v[72:75], v[224:227], v[80:83]
  ds_read_b64_tr_b16 v[252:253], v27 offset:12288
  ds_read_b64_tr_b16 v[254:255], v27 offset:12800
  s_waitcnt lgkmcnt(12)
  v_mfma_f32_16x16x32_bf16 v[84:87], v[72:75], v[228:231], v[84:87]
  s_waitcnt lgkmcnt(10)
  v_mfma_f32_16x16x32_bf16 v[88:91], v[72:75], v[232:235], v[88:91]
  s_waitcnt lgkmcnt(8)
  v_mfma_f32_16x16x32_bf16 v[92:95], v[72:75], v[236:239], v[92:95]
  s_waitcnt lgkmcnt(6)
  v_mfma_f32_16x16x32_bf16 v[80:83], v[76:79], v[240:243], v[80:83]
  s_waitcnt lgkmcnt(4)
  v_mfma_f32_16x16x32_bf16 v[84:87], v[76:79], v[244:247], v[84:87]
  s_waitcnt lgkmcnt(2)
  v_mfma_f32_16x16x32_bf16 v[88:91], v[76:79], v[248:251], v[88:91]
  s_waitcnt lgkmcnt(0)
  v_mfma_f32_16x16x32_bf16 v[92:95], v[76:79], v[252:255], v[92:95]
  v_mfma_f32_16x16x32_bf16 v[56:59], v[156:159], v[112:115], v[56:59]
  v_mfma_f32_16x16x32_bf16 v[56:59], v[148:151], v[116:119], v[56:59]
  s_nop 1
  v_cvt_pk_bf16_f32 v184, v80, v84
  s_nop 2
  v_cvt_pk_bf16_f32 v185, v88, v92
  buffer_store_dwordx2 v[184:185], v0, s[40:43], s64 offen offset:0 sc1
  v_cvt_pk_bf16_f32 v186, v81, v85
  v_mfma_f32_16x16x32_bf16 v[56:59], v[140:143], v[120:123], v[56:59]
  v_cvt_pk_bf16_f32 v187, v89, v93
  buffer_store_dwordx2 v[186:187], v0, s[40:43], s65 offen offset:0 sc1
  v_cvt_pk_bf16_f32 v188, v82, v86
  v_cvt_pk_bf16_f32 v189, v90, v94
  buffer_store_dwordx2 v[188:189], v0, s[40:43], s66 offen offset:0 sc1
  v_cvt_pk_bf16_f32 v190, v83, v87
  v_cvt_pk_bf16_f32 v191, v91, v95
  buffer_store_dwordx2 v[190:191], v0, s[40:43], s67 offen offset:0 sc1
  v_mfma_f32_16x16x32_bf16 v[56:59], v[132:135], v[124:127], v[56:59]
  s_nop 7
  v_add_f32_dpp v52, v23, v58 wave_ror:1 row_mask:0xf bank_mask:0xf
  v_add_f32_dpp v39, v51, v57 wave_ror:1 row_mask:0xf bank_mask:0xf
  v_add_f32_dpp v20, v38, v56 wave_ror:1 row_mask:0xf bank_mask:0xf
  v_add_f32_dpp v52, v59, v58 wave_shr:1 row_mask:0xf bank_mask:0xf
  s_nop 1
  v_add_f32_dpp v39, v52, v57 wave_shr:1 row_mask:0xf bank_mask:0xf
  s_nop 1
  v_add_f32_dpp v20, v39, v56 wave_shr:1 row_mask:0xf bank_mask:0xf
  v_cvt_pk_bf16_f32 v54, v8, v12
  v_cvt_pk_bf16_f32 v55, v16, v20
  ds_write_b64 v6, v[54:55] offset:59648
  s_waitcnt lgkmcnt(0)
  s_barrier
  ds_read_b64_tr_b16 v[36:37], v7 offset:59648
  s_waitcnt lgkmcnt(0)
  v_lshlrev_b32 v40, 16, v36
  v_and_b32 v41, s55, v36
  v_lshlrev_b32 v42, 16, v37
  v_and_b32 v43, s55, v37
  v_mul_f32 v40, v40, v32
  v_mul_f32 v41, v41, v33
  v_mul_f32 v42, v42, v34
  v_mul_f32 v43, v43, v35
  v_cvt_pk_bf16_f32 v32, v40, v41
  v_cvt_pk_bf16_f32 v33, v42, v43
  s_nop 0
  v_mov_b32_dpp v34, v32 row_shl:4 row_mask:0xf bank_mask:0xf
  v_mov_b32_dpp v35, v33 row_shl:4 row_mask:0xf bank_mask:0xf
  buffer_store_dwordx4 v[32:35], v44, s[40:43], s58 offen
  s_endpgm
PA_NOA2:
  v_mfma_f32_16x16x32_bf16 v[56:59], v[180:183], v[100:103], v[56:59]
  v_mfma_f32_16x16x32_bf16 v[56:59], v[172:175], v[104:107], v[56:59]
  v_mfma_f32_16x16x32_bf16 v[56:59], v[164:167], v[108:111], v[56:59]
  s_nop 2
  v_add_f32_dpp v51, v19, v22 wave_ror:1 row_mask:0xf bank_mask:0xf
  v_add_f32_dpp v38, v50, v21 wave_ror:1 row_mask:0xf bank_mask:0xf
  v_add_f32_dpp v16, v39, v20 wave_ror:1 row_mask:0xf bank_mask:0xf
  v_mfma_f32_16x16x32_bf16 v[56:59], v[156:159], v[112:115], v[56:59]
  v_add_f32_dpp v51, v23, v22 wave_shr:1 row_mask:0xf bank_mask:0xf
  v_mfma_f32_16x16x32_bf16 v[56:59], v[148:151], v[116:119], v[56:59]
  s_nop 0
  v_add_f32_dpp v38, v51, v21 wave_shr:1 row_mask:0xf bank_mask:0xf
  v_mfma_f32_16x16x32_bf16 v[56:59], v[140:143], v[120:123], v[56:59]
  s_nop 0
  v_add_f32_dpp v16, v38, v20 wave_shr:1 row_mask:0xf bank_mask:0xf
  v_mfma_f32_16x16x32_bf16 v[56:59], v[132:135], v[124:127], v[56:59]
  s_nop 7
  v_add_f32_dpp v52, v23, v58 wave_ror:1 row_mask:0xf bank_mask:0xf
  v_add_f32_dpp v39, v51, v57 wave_ror:1 row_mask:0xf bank_mask:0xf
  v_add_f32_dpp v20, v38, v56 wave_ror:1 row_mask:0xf bank_mask:0xf
  v_add_f32_dpp v52, v59, v58 wave_shr:1 row_mask:0xf bank_mask:0xf
  s_nop 1
  v_add_f32_dpp v39, v52, v57 wave_shr:1 row_mask:0xf bank_mask:0xf
  s_nop 1
  v_add_f32_dpp v20, v39, v56 wave_shr:1 row_mask:0xf bank_mask:0xf
  v_cvt_pk_bf16_f32 v54, v8, v12
  v_cvt_pk_bf16_f32 v55, v16, v20
  ds_write_b64 v6, v[54:55] offset:59648
  s_waitcnt lgkmcnt(0)
  s_barrier
  ds_read_b64_tr_b16 v[36:37], v7 offset:59648
  s_waitcnt lgkmcnt(0)
  v_lshlrev_b32 v40, 16, v36
  v_and_b32 v41, s55, v36
  v_lshlrev_b32 v42, 16, v37
  v_and_b32 v43, s55, v37
  v_mul_f32 v40, v40, v32
  v_mul_f32 v41, v41, v33
  v_mul_f32 v42, v42, v34
  v_mul_f32 v43, v43, v35
  v_cvt_pk_bf16_f32 v32, v40, v41
  v_cvt_pk_bf16_f32 v33, v42, v43
  s_nop 0
  v_mov_b32_dpp v34, v32 row_shl:4 row_mask:0xf bank_mask:0xf
  v_mov_b32_dpp v35, v33 row_shl:4 row_mask:0xf bank_mask:0xf
  buffer_store_dwordx4 v[32:35], v44, s[40:43], s58 offen
  s_endpgm
.p2align 6
P_3:
  v_xor_b32 v56, 0, v60
  v_xor_b32 v57, 32, v60
  v_xor_b32 v58, 64, v60
  v_xor_b32 v59, 96, v60
  s_waitcnt vmcnt(0)
  s_mov_b64 exec, 1
  buffer_store_dwordx2 v[248:249], off, s[28:31], s49 sc1
  s_mov_b64 exec, -1
  s_barrier
  buffer_load_dwordx2 v[24:25], v61, s[28:31], s59 offen sc1
  s_waitcnt vmcnt(0)
  v_cmp_ne_u64 vcc, s[10:11], v[24:25]
  s_nop 0
  s_cbranch_vccz P3H_OK
  s_mov_b32 s23, 0
P3H_L:
  buffer_load_dwordx2 v[24:25], v61, s[28:31], s59 offen sc1
  s_add_u32 s23, s23, 1
  s_waitcnt vmcnt(0)
  v_cmp_ne_u64 vcc, s[10:11], v[24:25]
  s_cmp_ge_u32 s23, 4000
  s_cbranch_scc1 P3H_OK
  s_cbranch_vccnz P3H_L
P3H_OK:
  s_add_u32 m0, s44, 0
  s_nop 0
  buffer_load_dwordx4 v62, s[28:31], s60 offen offset:0 sc1 lds
  s_add_u32 m0, s44, 1024
  s_nop 0
  buffer_load_dwordx4 v63, s[28:31], s61 offen offset:0 sc1 lds
  s_add_u32 m0, s44, 16256
  s_nop 0
  buffer_load_dwordx4 v62, s[28:31], s60 offen offset:128 sc1 lds
  s_add_u32 m0, s44, 17280
  s_nop 0
  buffer_load_dwordx4 v63, s[28:31], s61 offen offset:128 sc1 lds
  s_add_u32 m0, s44, 32512
  s_nop 0
  buffer_load_dwordx4 v62, s[28:31], s60 offen offset:256 sc1 lds
  s_add_u32 m0, s44, 33536
  s_nop 0
  buffer_load_dwordx4 v63, s[28:31], s61 offen offset:256 sc1 lds
  v_lshl_add_u32 v52, v2, 12, v3
  v_add_u32 v52, 71424, v52
  ds_read_b128 v[8:11], v52 offset:0
  ds_read_b128 v[12:15], v52 offset:1024
  ds_read_b128 v[16:19], v52 offset:2048
  ds_read_b128 v[20:23], v52 offset:3072
  s_waitcnt lgkmcnt(0)
  s_waitcnt vmcnt(4)
  s_barrier
  ds_read_b64_tr_b16 v[64:65], v56 offset:0
  ds_read_b64_tr_b16 v[66:67], v56 offset:512
  ds_read_b64_tr_b16 v[68:69], v57 offset:0
  ds_read_b64_tr_b16 v[70:71], v57 offset:512
  ds_read_b64_tr_b16 v[72:73], v58 offset:0
  ds_read_b64_tr_b16 v[74:75], v58 offset:512
  ds_read_b64_tr_b16 v[76:77], v59 offset:0
  ds_read_b64_tr_b16 v[78:79], v59 offset:512
  ds_read_b64_tr_b16 v[80:81], v56 offset:4096
  ds_read_b64_tr_b16 v[82:83], v56 offset:4608
  ds_read_b64_tr_b16 v[84:85], v57 offset:4096
  ds_read_b64_tr_b16 v[86:87], v57 offset:4608
  s_waitcnt lgkmcnt(10)
  v_mfma_f32_16x16x32_bf16 v[192:195], v[8:11], v[64:67], 0
  ds_read_b64_tr_b16 v[88:89], v58 offset:4096
  ds_read_b64_tr_b16 v[90:91], v58 offset:4608
  ds_read_b64_tr_b16 v[92:93], v59 offset:4096
  s_waitcnt lgkmcnt(11)
  v_mfma_f32_16x16x32_bf16 v[196:199], v[8:11], v[68:71], 0
  ds_read_b64_tr_b16 v[94:95], v59 offset:4608
  ds_read_b64_tr_b16 v[96:97], v56 offset:8192
  s_waitcnt lgkmcnt(11)
  v_mfma_f32_16x16x32_bf16 v[200:203], v[8:11], v[72:75], 0
  ds_read_b64_tr_b16 v[98:99], v56 offset:8704
  ds_read_b64_tr_b16 v[100:101], v57 offset:8192
  s_waitcnt lgkmcnt(11)
  v_mfma_f32_16x16x32_bf16 v[204:207], v[8:11], v[76:79], 0
  ds_read_b64_tr_b16 v[102:103], v57 offset:8704
  ds_read_b64_tr_b16 v[104:105], v58 offset:8192
  s_waitcnt lgkmcnt(11)
  v_mfma_f32_16x16x32_bf16 v[192:195], v[12:15], v[80:83], v[192:195]
  ds_read_b64_tr_b16 v[106:107], v58 offset:8704
  ds_read_b64_tr_b16 v[108:109], v59 offset:8192
  s_waitcnt lgkmcnt(11)
  v_mfma_f32_16x16x32_bf16 v[196:199], v[12:15], v[84:87], v[196:199]
  ds_read_b64_tr_b16 v[110:111], v59 offset:8704
  ds_read_b64_tr_b16 v[112:113], v56 offset:12288
  s_waitcnt lgkmcnt(11)
  v_mfma_f32_16x16x32_bf16 v[200:203], v[12:15], v[88:91], v[200:203]
  ds_read_b64_tr_b16 v[114:115], v56 offset:12800
  ds_read_b64_tr_b16 v[116:117], v57 offset:12288
  s_waitcnt lgkmcnt(11)
  v_mfma_f32_16x16x32_bf16 v[204:207], v[12:15], v[92:95], v[204:207]
  ds_read_b64_tr_b16 v[118:119], v57 offset:12800
  ds_read_b64_tr_b16 v[120:121], v58 offset:12288
  s_waitcnt lgkmcnt(11)
  v_mfma_f32_16x16x32_bf16 v[192:195], v[16:19], v[96:99], v[192:195]
  ds_read_b64_tr_b16 v[122:123], v58 offset:12800
  ds_read_b64_tr_b16 v[124:125], v59 offset:12288
  s_waitcnt lgkmcnt(11)
  v_mfma_f32_16x16x32_bf16 v[196:199], v[16:19], v[100:103], v[196:199]
  ds_read_b64_tr_b16 v[126:127], v59 offset:12800
  s_waitcnt vmcnt(2)
  s_barrier
  s_waitcnt lgkmcnt(10)
  v_mfma_f32_16x16x32_bf16 v[200:203], v[16:19], v[104:107], v[200:203]
  ds_read_b64_tr_b16 v[128:129], v56 offset:16384
  ds_read_b64_tr_b16 v[130:131], v56 offset:16896
  s_waitcnt lgkmcnt(10)
  v_mfma_f32_16x16x32_bf16 v[204:207], v[16:19], v[108:111], v[204:207]
  ds_read_b64_tr_b16 v[132:133], v57 offset:16384
  ds_read_b64_tr_b16 v[134:135], v57 offset:16896
  s_waitcnt lgkmcnt(10)
  v_mfma_f32_16x16x32_bf16 v[192:195], v[20:23], v[112:115], v[192:195]
  ds_read_b64_tr_b16 v[136:137], v58 offset:16384
  ds_read_b64_tr_b16 v[138:139], v58 offset:16896
  s_waitcnt lgkmcnt(10)
  v_mfma_f32_16x16x32_bf16 v[196:199], v[20:23], v[116:119], v[196:199]
  ds_read_b64_tr_b16 v[140:141], v59 offset:16384
  ds_read_b64_tr_b16 v[142:143], v59 offset:16896
  s_waitcnt lgkmcnt(10)
  v_mfma_f32_16x16x32_bf16 v[200:203], v[20:23], v[120:123], v[200:203]
  ds_read_b64_tr_b16 v[144:145], v56 offset:20480
  ds_read_b64_tr_b16 v[146:147], v56 offset:20992
  s_waitcnt lgkmcnt(10)
  v_mfma_f32_16x16x32_bf16 v[204:207], v[20:23], v[124:127], v[204:207]
  ds_read_b64_tr_b16 v[148:149], v57 offset:20480
  ds_read_b64_tr_b16 v[150:151], v57 offset:20992
  ds_read_b64_tr_b16 v[152:153], v58 offset:20480
  s_waitcnt lgkmcnt(11)
  v_mfma_f32_16x16x32_bf16 v[208:211], v[8:11], v[128:131], 0
  ds_read_b64_tr_b16 v[154:155], v58 offset:20992
  ds_read_b64_tr_b16 v[156:157], v59 offset:20480
  s_waitcnt lgkmcnt(11)
  v_mfma_f32_16x16x32_bf16 v[212:215], v[8:11], v[132:135], 0
  ds_read_b64_tr_b16 v[158:159], v59 offset:20992
  ds_read_b64_tr_b16 v[160:161], v56 offset:24576
  s_waitcnt lgkmcnt(11)
  v_mfma_f32_16x16x32_bf16 v[216:219], v[8:11], v[136:139], 0
  ds_read_b64_tr_b16 v[162:163], v56 offset:25088
  ds_read_b64_tr_b16 v[164:165], v57 offset:24576
  v_cvt_pk_bf16_f32 v224, v192, v196
  s_waitcnt lgkmcnt(11)
  v_mfma_f32_16x16x32_bf16 v[220:223], v[8:11], v[140:143], 0
  ds_read_b64_tr_b16 v[166:167], v57 offset:25088
  ds_read_b64_tr_b16 v[168:169], v58 offset:24576
  v_cvt_pk_bf16_f32 v225, v200, v204
  s_waitcnt lgkmcnt(11)
  v_mfma_f32_16x16x32_bf16 v[208:211], v[12:15], v[144:147], v[208:211]
  ds_read_b64_tr_b16 v[170:171], v58 offset:25088
  ds_read_b64_tr_b16 v[172:173], v59 offset:24576
  buffer_store_dwordx2 v[224:225], v0, s[40:43], s64 offen offset:0 sc1
  s_waitcnt lgkmcnt(11)
  v_mfma_f32_16x16x32_bf16 v[212:215], v[12:15], v[148:151], v[212:215]
  ds_read_b64_tr_b16 v[174:175], v59 offset:25088
  ds_read_b64_tr_b16 v[176:177], v56 offset:28672
  v_cvt_pk_bf16_f32 v226, v193, v197
  s_waitcnt lgkmcnt(11)
  v_mfma_f32_16x16x32_bf16 v[216:219], v[12:15], v[152:155], v[216:219]
  ds_read_b64_tr_b16 v[178:179], v56 offset:29184
  ds_read_b64_tr_b16 v[180:181], v57 offset:28672
  v_cvt_pk_bf16_f32 v227, v201, v205
  s_waitcnt lgkmcnt(11)
  v_mfma_f32_16x16x32_bf16 v[220:223], v[12:15], v[156:159], v[220:223]
  ds_read_b64_tr_b16 v[182:183], v57 offset:29184
  ds_read_b64_tr_b16 v[184:185], v58 offset:28672
  buffer_store_dwordx2 v[226:227], v0, s[40:43], s65 offen offset:0 sc1
  s_waitcnt lgkmcnt(11)
  v_mfma_f32_16x16x32_bf16 v[208:211], v[16:19], v[160:163], v[208:211]
  ds_read_b64_tr_b16 v[186:187], v58 offset:29184
  ds_read_b64_tr_b16 v[188:189], v59 offset:28672
  v_cvt_pk_bf16_f32 v228, v194, v198
  s_waitcnt lgkmcnt(11)
  v_mfma_f32_16x16x32_bf16 v[212:215], v[16:19], v[164:167], v[212:215]
  ds_read_b64_tr_b16 v[190:191], v59 offset:29184
  s_waitcnt vmcnt(2)
  s_barrier
  v_cvt_pk_bf16_f32 v229, v202, v206
  s_waitcnt lgkmcnt(10)
  v_mfma_f32_16x16x32_bf16 v[216:219], v[16:19], v[168:171], v[216:219]
  ds_read_b64_tr_b16 v[64:65], v56 offset:32768
  ds_read_b64_tr_b16 v[66:67], v56 offset:33280
  buffer_store_dwordx2 v[228:229], v0, s[40:43], s66 offen offset:0 sc1
  s_waitcnt lgkmcnt(10)
  v_mfma_f32_16x16x32_bf16 v[220:223], v[16:19], v[172:175], v[220:223]
  ds_read_b64_tr_b16 v[68:69], v57 offset:32768
  ds_read_b64_tr_b16 v[70:71], v57 offset:33280
  v_cvt_pk_bf16_f32 v230, v195, v199
  s_waitcnt lgkmcnt(10)
  v_mfma_f32_16x16x32_bf16 v[208:211], v[20:23], v[176:179], v[208:211]
  ds_read_b64_tr_b16 v[72:73], v58 offset:32768
  ds_read_b64_tr_b16 v[74:75], v58 offset:33280
  v_cvt_pk_bf16_f32 v231, v203, v207
  s_waitcnt lgkmcnt(10)
  v_mfma_f32_16x16x32_bf16 v[212:215], v[20:23], v[180:183], v[212:215]
  ds_read_b64_tr_b16 v[76:77], v59 offset:32768
  ds_read_b64_tr_b16 v[78:79], v59 offset:33280
  buffer_store_dwordx2 v[230:231], v0, s[40:43], s67 offen offset:0 sc1
  s_waitcnt lgkmcnt(10)
  v_mfma_f32_16x16x32_bf16 v[216:219], v[20:23], v[184:187], v[216:219]
  ds_read_b64_tr_b16 v[80:81], v56 offset:36864
  ds_read_b64_tr_b16 v[82:83], v56 offset:37376
  s_waitcnt lgkmcnt(10)
  v_mfma_f32_16x16x32_bf16 v[220:223], v[20:23], v[188:191], v[220:223]
  ds_read_b64_tr_b16 v[84:85], v57 offset:36864
  ds_read_b64_tr_b16 v[86:87], v57 offset:37376
  ds_read_b64_tr_b16 v[88:89], v58 offset:36864
  s_waitcnt lgkmcnt(11)
  v_mfma_f32_16x16x32_bf16 v[192:195], v[8:11], v[64:67], 0
  ds_read_b64_tr_b16 v[90:91], v58 offset:37376
  ds_read_b64_tr_b16 v[92:93], v59 offset:36864
  s_waitcnt lgkmcnt(11)
  v_mfma_f32_16x16x32_bf16 v[196:199], v[8:11], v[68:71], 0
  ds_read_b64_tr_b16 v[94:95], v59 offset:37376
  ds_read_b64_tr_b16 v[96:97], v56 offset:40960
  s_waitcnt lgkmcnt(11)
  v_mfma_f32_16x16x32_bf16 v[200:203], v[8:11], v[72:75], 0
  ds_read_b64_tr_b16 v[98:99], v56 offset:41472
  ds_read_b64_tr_b16 v[100:101], v57 offset:40960
  v_cvt_pk_bf16_f32 v232, v208, v212
  s_waitcnt lgkmcnt(11)
  v_mfma_f32_16x16x32_bf16 v[204:207], v[8:11], v[76:79], 0
  ds_read_b64_tr_b16 v[102:103], v57 offset:41472
  ds_read_b64_tr_b16 v[104:105], v58 offset:40960
  v_cvt_pk_bf16_f32 v233, v216, v220
  s_waitcnt lgkmcnt(11)
  v_mfma_f32_16x16x32_bf16 v[192:195], v[12:15], v[80:83], v[192:195]
  ds_read_b64_tr_b16 v[106:107], v58 offset:41472
  ds_read_b64_tr_b16 v[108:109], v59 offset:40960
  buffer_store_dwordx2 v[232:233], v0, s[40:43], s64 offen offset:128 sc1
  s_waitcnt lgkmcnt(11)
  v_mfma_f32_16x16x32_bf16 v[196:199], v[12:15], v[84:87], v[196:199]
  ds_read_b64_tr_b16 v[110:111], v59 offset:41472
  ds_read_b64_tr_b16 v[112:113], v56 offset:45056
  v_cvt_pk_bf16_f32 v234, v209, v213
  s_waitcnt lgkmcnt(11)
  v_mfma_f32_16x16x32_bf16 v[200:203], v[12:15], v[88:91], v[200:203]
  ds_read_b64_tr_b16 v[114:115], v56 offset:45568
  ds_read_b64_tr_b16 v[116:117], v57 offset:45056
  v_cvt_pk_bf16_f32 v235, v217, v221
  s_waitcnt lgkmcnt(11)
  v_mfma_f32_16x16x32_bf16 v[204:207], v[12:15], v[92:95], v[204:207]
  ds_read_b64_tr_b16 v[118:119], v57 offset:45568
  ds_read_b64_tr_b16 v[120:121], v58 offset:45056
  buffer_store_dwordx2 v[234:235], v0, s[40:43], s65 offen offset:128 sc1
  s_waitcnt lgkmcnt(11)
  v_mfma_f32_16x16x32_bf16 v[192:195], v[16:19], v[96:99], v[192:195]
  ds_read_b64_tr_b16 v[122:123], v58 offset:45568
  ds_read_b64_tr_b16 v[124:125], v59 offset:45056
  v_cvt_pk_bf16_f32 v236, v210, v214
  s_waitcnt lgkmcnt(11)
  v_mfma_f32_16x16x32_bf16 v[196:199], v[16:19], v[100:103], v[196:199]
  ds_read_b64_tr_b16 v[126:127], v59 offset:45568
  v_cvt_pk_bf16_f32 v237, v218, v222
  s_waitcnt lgkmcnt(10)
  v_mfma_f32_16x16x32_bf16 v[200:203], v[16:19], v[104:107], v[200:203]
  buffer_store_dwordx2 v[236:237], v0, s[40:43], s66 offen offset:128 sc1
  s_waitcnt lgkmcnt(8)
  v_mfma_f32_16x16x32_bf16 v[204:207], v[16:19], v[108:111], v[204:207]
  v_cvt_pk_bf16_f32 v238, v211, v215
  s_waitcnt lgkmcnt(6)
  v_mfma_f32_16x16x32_bf16 v[192:195], v[20:23], v[112:115], v[192:195]
  v_cvt_pk_bf16_f32 v239, v219, v223
  s_waitcnt lgkmcnt(4)
  v_mfma_f32_16x16x32_bf16 v[196:199], v[20:23], v[116:119], v[196:199]
  buffer_store_dwordx2 v[238:239], v0, s[40:43], s67 offen offset:128 sc1
  s_waitcnt lgkmcnt(2)
  v_mfma_f32_16x16x32_bf16 v[200:203], v[20:23], v[120:123], v[200:203]
  s_waitcnt lgkmcnt(0)
  v_mfma_f32_16x16x32_bf16 v[204:207], v[20:23], v[124:127], v[204:207]
  s_nop 2
  v_cvt_pk_bf16_f32 v224, v192, v196
  s_nop 3
  v_cvt_pk_bf16_f32 v225, v200, v204
  buffer_store_dwordx2 v[224:225], v0, s[40:43], s64 offen offset:256 sc1
  v_cvt_pk_bf16_f32 v226, v193, v197
  v_cvt_pk_bf16_f32 v227, v201, v205
  buffer_store_dwordx2 v[226:227], v0, s[40:43], s65 offen offset:256 sc1
  v_cvt_pk_bf16_f32 v228, v194, v198
  v_cvt_pk_bf16_f32 v229, v202, v206
  buffer_store_dwordx2 v[228:229], v0, s[40:43], s66 offen offset:256 sc1
  v_cvt_pk_bf16_f32 v230, v195, v199
  v_cvt_pk_bf16_f32 v231, v203, v207
  buffer_store_dwordx2 v[230:231], v0, s[40:43], s67 offen offset:256 sc1
  s_endpgm
K_END:
  s_endpgm
.p2align 8
.type TBL2,@object
TBL2:
.quad 0x3f803f803f803f80,0x3f803f803f803f80,0x3f7d3f7f3f803f80,0x3f713f753f783f7b,0x3f753f7b3f7f3f80,0x3f463f553f623f6d,0x3f673f753f7d3f80,0x3f043f223f3e3f55
.quad 0x3f553f6d3f7b3f80,0x3e483ec43f0e3f35,0x3f3e3f623f783f80,0xbe163dc93eac3f0e,0x3f223f553f753f80,0xbef1be483dc93ec4,0x3f043f463f713f80,0xbf3ebef1be163e48
.quad 0x3ec43f353f6d3f80,0xbf6dbf35bec4248d,0x3e793f223f673f80,0xbf80bf62bf18be48,0x3dc93f0e3f623f80,0xbf75bf7bbf46bec4,0xbd493ef13f5c3f80,0xbf4ebf7fbf67bf0e
.quad 0xbe483ec43f553f80,0xbf0ebf6dbf7bbf35,0xbeac3e953f4e3f80,0xbe79bf46bf80bf55,0xbef13e483f463f80,0x3dc9bf0ebf75bf6d,0xbf183dc93f3e3f80,0x3edbbe95bf5cbf7b
.quad 0x3f803f803f803f80,0x3f803f803f803f80,0x3f5c3f623f673f6d,0x3f3e3f463f4e3f55,0x3ef13f0e3f223f35,0x3dc93e483e953ec4,0xbd493dc93e793ec4,0xbf18bef1beacbe48
.quad 0xbf0ebec4be48248d,0xbf7bbf6dbf55bf35,0xbf67bf46bf18bec4,0xbf5cbf75bf80bf7b,0xbf7fbf7bbf62bf35,0xbe95bf0ebf46bf6d,0xbf4ebf75bf80bf6d,0x3edb3dc9be79bf0e
.quad 0xbec4bf35bf6dbf80,0x3f6d3f353ec4a554,0x3e16be95bf2cbf6d,0x3f713f7f3f5c3f0e,0x3f223e48be95bf35,0x3ef13f553f7f3f6d,0x3f713f223e16bec4,0xbe793e953f3e3f7b
.quad 0x3f7b3f6d3f0ea554,0xbf55bec43e483f35,0x3f3e3f7f3f5c3ec4,0xbf7dbf62bedb3e48,0x3e953f553f7f3f35,0xbf22bf7bbf62bec4,0xbe793ef13f713f6d,0x3d49bf22bf7dbf55
.quad 0x3f803f803f803f80,0x3f803f803f803f80,0x3f183f223f2c3f35,0x3edb3ef13f043f0e,0xbe95be48bdc9248d,0xbf22bf0ebef1bec4,0xbf71bf62bf4ebf35,0xbf78bf7fbf80bf7b
.quad 0xbf55bf6dbf7bbf80,0xbe48bec4bf0ebf35,0xbd49be95bf04bf35,0x3f4e3f223edb3e48,0x3f463f0e3e95a554,0x3f623f7b3f7f3f6d,0x3f783f7f3f673f35,0xbd493e953f183f55
.quad 0x3ec43f353f6d3f80,0xbf6dbf35bec4248d,0xbf04bdc93eac3f35,0xbf3ebf75bf7dbf55,0xbf7fbf55bef1248d,0x3e95be48bf22bf6d,0xbf2cbf75bf78bf35,0x3f7d3f463eacbe48
.quad 0x3e48bec4bf55bf80,0x3f0e3f6d3f7b3f35,0x3f673ef1be16bf35,0xbf043dc93f2c3f7b,0x3f623f7b3f22a554,0xbf7fbf55be953ec4,0x3e163f463f803f35,0xbeacbf62bf78bf0e
.quad 0x3f803f803f803f80,0x3f803f803f803f80,0x3e793e953eac3ec4,0x3d493dc93e163e48,0xbf62bf55bf46bf35,0xbf7fbf7bbf75bf6d,0xbf2cbf46bf5cbf6d,0xbe16be95bedbbf0e
.quad 0x3f0e3ec43e48a554,0x3f7b3f6d3f553f35,0x3f713f7f3f7d3f6d,0x3e793ef13f2c3f55,0xbdc93e483ef13f35,0xbf75bf55bf22bec4,0xbf7dbf62bf2cbec4,0xbeacbf22bf5cbf7b
.quad 0xbec4bf35bf6dbf80,0x3f6d3f353ec4a554,0x3f4e3ef13d49bec4,0x3edb3f463f783f7b,0x3f463f7b3f753f35,0xbf62bf0ebdc93ec4,0xbedb3dc93f183f6d,0xbf04bf62bf80bf55
.quad 0xbf7bbf6dbf0e248d,0x3f553ec4be48bf35,0xbd49bf22bf78bf6d,0x3f183f753f713f0e,0x3f753f0ebdc9bf35,0xbf46be483ef13f6d,0x3f043f753f673ec4,0xbf2cbf7fbf4ebe48
.quad 0x3f803f803f803f80,0x3f803f803f803f80,0xbe16bdc9bd49248d,0xbeacbe95be79be48,0xbf75bf7bbf7fbf80,0xbf46bf55bf62bf6d,0x3edb3e953e16a554,0x3f5c3f463f2c3f0e
.quad 0x3f553f6d3f7b3f80,0x3e483ec43f0e3f35,0xbf2cbef1be79248d,0xbf7dbf7fbf71bf55,0xbf22bf55bf75bf80,0x3ef13e48bdc9bec4,0x3f5c3f223eaca554,0x3f2c3f623f7d3f7b
.quad 0x3ec43f353f6d3f80,0xbf6dbf35bec4248d,0xbf78bf46bedb248d,0xbd49bef1bf4ebf7b,0xbdc9bf0ebf62bf80,0x3f753f7b3f463ec4,0x3f803f623f04a554,0xbf18bdc93edb3f55
.quad 0xbe483ec43f553f80,0xbf0ebf6dbf7bbf35,0xbf71bf75bf18248d,0x3f783f223d49bf0e,0x3ef1be48bf46bf80,0xbdc93f0e3f753f6d,0x3f4e3f7f3f2ca554,0xbf67bf75bf043e48
.quad 0x3f803f803f803f80,0x3f803f803f803f80,0xbf04bef1bedbbec4,0xbf2cbf22bf18bf0e,0xbef1bf0ebf22bf35,0xbdc9be48be95bec4,0x3f803f7f3f783f6d,0x3f4e3f623f713f7b
.quad 0xbf0ebec4be48248d,0xbf7bbf6dbf55bf35,0xbedbbf22bf4ebf6d,0x3f043e953d49be48,0x3f7f3f7b3f623f35,0x3e953f0e3f463f6d,0xbf18be953d493ec4,0xbf67bf7fbf78bf55
.quad 0xbec4bf35bf6dbf80,0x3f6d3f353ec4a554,0x3f7d3f753f3e3ec4,0xbeac3dc93f043f55,0xbf22be483e953f35,0xbef1bf55bf7fbf6d,0xbeacbf46bf7dbf6d,0x3f783f753f2c3e48
.quad 0x3f7b3f6d3f0ea554,0xbf55bec43e483f35,0xbf2cbdc93f043f6d,0x3e16bef1bf67bf7b,0xbe95bf55bf7fbf35,0x3f223f7b3f623ec4,0x3f783f623eacbec4,0xbf80bf46be163f0e
.quad 0x3f803f803f803f80,0x3f803f803f803f80,0xbf4ebf46bf3ebf35,0xbf67bf62bf5cbf55,0x3e953e483dc9a554,0x3f223f0e3ef13ec4,0x3eac3ef13f183f35,0xbe79bdc93d493e48
.quad 0xbf55bf6dbf7bbf80,0xbe48bec4bf0ebf35,0x3f803f753f5c3f35,0x3f183f463f673f7b,0xbf46bf0ebe95248d,0xbf62bf7bbf7fbf6d,0x3e79bdc9bedbbf35,0x3f803f753f4e3f0e
.quad 0x3ec43f353f6d3f80,0xbf6dbf35bec4248d,0xbf5cbf7fbf71bf35,0x3f2c3e95be16bf0e,0x3f7f3f553ef1a554,0xbe953e483f223f6d,0xbf3ebe953e793f35,0xbe16bf22bf71bf7b
.quad 0x3e48bec4bf55bf80,0x3f0e3f6d3f7b3f35,0x3edb3f623f7d3f35,0xbf5cbf7fbf3ebe48,0xbf62bf7bbf22248d,0x3f7f3f553e95bec4,0x3f7d3f22bd49bf35,0xbf71bef13e793f55
.quad 0x3f803f803f803f80,0x3f803f803f803f80,0xbf78bf75bf71bf6d,0xbf80bf7fbf7dbf7b,0x3f623f553f463f35,0x3f7f3f7b3f753f6d,0xbf3ebf22bf04bec4,0xbf7dbf75bf67bf55
.quad 0x3f0e3ec43e48a554,0x3f7b3f6d3f553f35,0xbeacbdc93e163ec4,0xbf78bf62bf3ebf0e,0x3dc9be48bef1bf35,0x3f753f553f223ec4,0x3e163ef13f3e3f6d,0xbf71bf46bf04be48
.quad 0xbec4bf35bf6dbf80,0x3f6d3f353ec4a554,0x3f183f623f803f6d,0xbf67bf22be793e48,0xbf46bf7bbf75bf35,0x3f623f0e3dc9bec4,0x3f673f7f3f4e3ec4,0xbf5cbef13d493f0e
.quad 0xbf7bbf6dbf0e248d,0x3f553ec4be48bf35,0x3f803f463e79bec4,0xbf4ebe953eac3f55,0xbf75bf0e3dc93f35,0x3f463e48bef1bf6d,0x3f5c3e95bedbbf6d,0xbf3ebdc93f183f7b
.quad 0x3f80,0x0,0x3e163dc93d49bf80,0x3eac3e953e793e48,0x3e953e483dc93f80,0x3f223f0e3ef13ec4,0x3edb3e953e16bf80,0x3f5c3f463f2c3f0e
.quad 0x3f0e3ec43e483f80,0x3f7b3f6d3f553f35,0x3f2c3ef13e79bf80,0x3f7d3f7f3f713f55,0x3f463f0e3e953f80,0x3f623f7b3f7f3f6d,0x3f5c3f223eacbf80,0x3f2c3f623f7d3f7b
.quad 0x3f6d3f353ec43f80,0x3ec43f353f6d3f80,0x3f783f463edbbf80,0x3d493ef13f4e3f7b,0x3f7f3f553ef13f80,0xbe953e483f223f6d,0x3f803f623f04bf80,0xbf18bdc93edb3f55
.quad 0x3f7b3f6d3f0e3f80,0xbf55bec43e483f35,0x3f713f753f18bf80,0xbf78bf22bd493f0e,0x3f623f7b3f223f80,0xbf7fbf55be953ec4,0x3f4e3f7f3f2cbf80,0xbf67bf75bf043e48
.quad 0x0,0x0,0x3f043ef13edb3ec4,0x3f2c3f223f183f0e,0x3f623f553f463f35,0x3f7f3f7b3f753f6d,0x3f803f7f3f783f6d,0x3f4e3f623f713f7b
.quad 0x3f553f6d3f7b3f80,0x3e483ec43f0e3f35,0x3edb3f223f4e3f6d,0xbf04be95bd493e48,0xbdc93e483ef13f35,0xbf75bf55bf22bec4,0xbf18be953d493ec4,0xbf67bf7fbf78bf55
.quad 0xbf6dbf35bec4250d,0xbec4bf35bf6dbf80,0xbf7dbf75bf3ebec4,0x3eacbdc9bf04bf55,0xbf46bf7bbf75bf35,0x3f623f0e3dc9bec4,0xbeacbf46bf7dbf6d,0x3f783f753f2c3e48
.quad 0x3e48bec4bf55bf80,0x3f0e3f6d3f7b3f35,0x3f2c3dc9bf04bf6d,0xbe163ef13f673f7b,0x3f753f0ebdc9bf35,0xbf46be483ef13f6d,0x3f783f623eacbec4,0xbf80bf46be163f0e
.quad 0x0,0x0,0x3f4e3f463f3e3f35,0x3f673f623f5c3f55,0x3f753f7b3f7f3f80,0x3f463f553f623f6d,0x3eac3ef13f183f35,0xbe79bdc93d493e48
.quad 0xbf0ebec4be48250d,0xbf7bbf6dbf55bf35,0xbf80bf75bf5cbf35,0xbf18bf46bf67bf7b,0xbf22bf55bf75bf80,0x3ef13e48bdc9bec4,0x3e79bdc9bedbbf35,0x3f803f753f4e3f0e
.quad 0x3f6d3f353ec40000,0x3ec43f353f6d3f80,0x3f5c3f7f3f713f35,0xbf2cbe953e163f0e,0x3dc93f0e3f623f80,0xbf75bf7bbf46bec4,0xbf3ebe953e793f35,0xbe16bf22bf71bf7b
.quad 0xbf7bbf6dbf0e250d,0x3f553ec4be48bf35,0xbedbbf62bf7dbf35,0x3f5c3f7f3f3e3e48,0x3ef1be48bf46bf80,0xbdc93f0e3f753f6d,0x3f7d3f22bd49bf35,0xbf71bef13e793f55
.quad 0x0,0x0,0x3f783f753f713f6d,0x3f803f7f3f7d3f7b,0x3ef13f0e3f223f35,0x3dc93e483e953ec4,0xbf3ebf22bf04bec4,0xbf7dbf75bf67bf55
.quad 0xbf55bf6dbf7bbf80,0xbe48bec4bf0ebf35,0x3eac3dc9be16bec4,0x3f783f623f3e3f0e,0x3f7f3f7b3f623f35,0x3e953f0e3f463f6d,0x3e163ef13f3e3f6d,0xbf71bf46bf04be48
.quad 0xbf6dbf35bec4250d,0xbec4bf35bf6dbf80,0xbf18bf62bf80bf6d,0x3f673f223e79be48,0x3f223e48be95bf35,0x3ef13f553f7f3f6d,0x3f673f7f3f4e3ec4,0xbf5cbef13d493f0e
.quad 0xbe483ec43f553f80,0xbf0ebf6dbf7bbf35,0xbf80bf46be793ec4,0x3f4e3e95beacbf55,0xbe95bf55bf7fbf35,0x3f223f7b3f623ec4,0x3f5c3e95bedbbf6d,0xbf3ebdc93f183f7b
.quad 0x0,0x0,0x3f7d3f7f3f803f80,0x3f713f753f783f7b,0xbe95be48bdc9250d,0xbf22bf0ebef1bec4,0xbf67bf75bf7dbf80,0xbf04bf22bf3ebf55
.quad 0x3f0e3ec43e480000,0x3f7b3f6d3f553f35,0x3f3e3f623f783f80,0xbe163dc93eac3f0e,0xbf46bf0ebe95250d,0xbf62bf7bbf7fbf6d,0xbf04bf46bf71bf80,0x3f3e3ef13e16be48
.quad 0x3f6d3f353ec40000,0x3ec43f353f6d3f80,0x3e793f223f673f80,0xbf80bf62bf18be48,0xbf7fbf55bef1250d,0x3e95be48bf22bf6d,0x3d49bef1bf5cbf80,0x3f4e3f7f3f673f0e
.quad 0x3f7b3f6d3f0e0000,0xbf55bec43e483f35,0xbeac3e953f4e3f80,0xbe79bf46bf80bf55,0xbf62bf7bbf22250d,0x3f7f3f553e95bec4,0x3f18bdc9bf3ebf80,0xbedb3e953f5c3f7b
.quad 0x0,0x0,0x3f5c3f623f673f6d,0x3f3e3f463f4e3f55,0xbf62bf55bf46bf35,0xbf7fbf7bbf75bf6d,0x3d49bdc9be79bec4,0x3f183ef13eac3e48
.quad 0x3f553f6d3f7b3f80,0x3e483ec43f0e3f35,0xbf67bf46bf18bec4,0xbf5cbf75bf80bf7b,0x3dc9be48bef1bf35,0x3f753f553f223ec4,0x3f4e3f753f803f6d,0xbedbbdc93e793f0e
.quad 0xbf6dbf35bec4250d,0xbec4bf35bf6dbf80,0x3e16be95bf2cbf6d,0x3f713f7f3f5c3f0e,0x3f463f7b3f753f35,0xbf62bf0ebdc93ec4,0xbf71bf22be163ec4,0x3e79be95bf3ebf7b
.quad 0x3e48bec4bf55bf80,0x3f0e3f6d3f7b3f35,0x3f3e3f7f3f5c3ec4,0xbf7dbf62bedb3e48,0xbf75bf0e3dc93f35,0x3f463e48bef1bf6d,0x3e79bef1bf71bf6d,0xbd493f223f7d3f55
.quad 0x0,0x0,0x3f183f223f2c3f35,0x3edb3ef13f043f0e,0xbf75bf7bbf7fbf80,0xbf46bf55bf62bf6d,0x3f713f623f4e3f35,0x3f783f7f3f803f7b
.quad 0xbf0ebec4be48250d,0xbf7bbf6dbf55bf35,0xbd49be95bf04bf35,0x3f4e3f223edb3e48,0x3f223f553f753f80,0xbef1be483dc93ec4,0xbf78bf7fbf67bf35,0x3d49be95bf18bf55
.quad 0x3f6d3f353ec40000,0x3ec43f353f6d3f80,0xbf04bdc93eac3f35,0xbf3ebf75bf7dbf55,0xbdc9bf0ebf62bf80,0x3f753f7b3f463ec4,0x3f2c3f753f783f35,0xbf7dbf46beac3e48
.quad 0xbf7bbf6dbf0e250d,0x3f553ec4be48bf35,0x3f673ef1be16bf35,0xbf043dc93f2c3f7b,0xbef13e483f463f80,0x3dc9bf0ebf75bf6d,0xbe16bf46bf80bf35,0x3eac3f623f783f0e
.quad 0x0,0x0,0x3e793e953eac3ec4,0x3d493dc93e163e48,0xbef1bf0ebf22bf35,0xbdc9be48be95bec4,0x3f2c3f463f5c3f6d,0x3e163e953edb3f0e
.quad 0xbf55bf6dbf7bbf80,0xbe48bec4bf0ebf35,0x3f713f7f3f7d3f6d,0x3e793ef13f2c3f55,0xbf7fbf7bbf62bf35,0xbe95bf0ebf46bf6d,0x3f7d3f623f2c3ec4,0x3eac3f223f5c3f7b
.quad 0xbf6dbf35bec4250d,0xbec4bf35bf6dbf80,0x3f4e3ef13d49bec4,0x3edb3f463f783f7b,0xbf22be483e953f35,0xbef1bf55bf7fbf6d,0x3edbbdc9bf18bf6d,0x3f043f623f803f55
.quad 0xbe483ec43f553f80,0xbf0ebf6dbf7bbf35,0xbd49bf22bf78bf6d,0x3f183f753f713f0e,0x3e953f553f7f3f35,0xbf22bf7bbf62bec4,0xbf04bf75bf67bec4,0x3f2c3f7f3f4e3e48
.quad 0xbf35248d3f353f80,0x3f35a554bf35bf80,0xbf4ebdc93f2c3f80,0x3f673e95bf04bf7b,0xbf62be483f223f80,0x3f7f3f0ebe95bf6d,0xbf71be953f183f80,0x3f783f46bd49bf55
.quad 0xbf7bbec43f0e3f80,0x3f553f6d3e48bf35,0xbf80bef13f043f80,0x3f183f7f3edbbf0e,0xbf7fbf0e3ef13f80,0x3e953f7b3f22bec4,0xbf78bf223edb3f80,0xbd493f623f4ebe48
.quad 0xbf6dbf353ec43f80,0xbec43f353f6da554,0xbf5cbf463eac3f80,0xbf2c3ef13f7d3e48,0xbf46bf553e953f80,0xbf623e483f7f3ec4,0xbf2cbf623e793f80,0xbf7dbdc93f713f0e
.quad 0xbf0ebf6d3e483f80,0xbf7bbec43f553f35,0xbedbbf753e163f80,0xbf5cbf223f2c3f55,0xbe95bf7b3dc93f80,0xbf22bf553ef13f6d,0xbe16bf7f3d493f80,0xbeacbf753e793f7b
.quad 0xbf35248d3f353f80,0x3f35a554bf35bf80,0xbf78bef13eac3f6d,0x3f803f22be16bf55,0xbf75bf55bdc93f35,0x3f463f7b3ef1bec4,0xbf2cbf7fbf043ec4,0x3e163f623f673e48
.quad 0xbe48bf6dbf55248d,0xbf0e3ec43f7b3f35,0x3eacbf22bf7dbec4,0xbf78be953f2c3f7b,0x3f46be48bf75bf35,0xbf62bf553dc93f6d,0x3f7d3e95bf3ebf6d,0xbeacbf7fbf043f0e
.quad 0x3f6d3f35bec4bf80,0x3ec4bf35bf6d248d,0x3f183f753d49bf6d,0x3f67bdc9bf78bf0e,0x3dc93f7b3ef1bf35,0x3f753f0ebf22bf6d,0xbedb3f463f4ebec4,0x3f043f75bd49bf7b
.quad 0xbf553ec43f7ba554,0xbe483f6d3f0ebf35,0xbf80bdc93f783ec4,0xbf4e3ef13f71be48,0xbf62bf0e3f463f35,0xbf7fbe483f753ec4,0xbf04bf623edb3f6d,0xbf2cbf463f183f55
.quad 0xbf35248d3f353f80,0x3f35a554bf35bf80,0xbf7dbf46bd493f35,0x3f713f623e79bf0e,0xbef1bf7bbf46248d,0x3dc93f553f753ec4,0x3edbbef1bf7dbf35,0xbf5cbdc93f3e3f7b
.quad 0x3f7b3ec4bf0ebf80,0xbf55bf6dbe483f35,0x3f3e3f753e79bf35,0x3e16bf46bf71be48,0xbdc93f553f62a554,0x3f753e48bf46bf6d,0xbf5c3dc93f713f35,0x3f2c3f753e16bf55
.quad 0xbf6dbf353ec43f80,0xbec43f353f6da554,0xbe79bf7fbedb3f35,0xbf80be953f4e3f55,0x3f22bf0ebf75248d,0xbef1bf7bbdc93f6d,0x3f803e95bf5cbf35,0x3f18bf22bf673e48
.quad 0x3f0e3f6dbe48bf80,0x3f7b3ec4bf55bf35,0xbeac3f623f18bf35,0x3e793f7f3d49bf7b,0xbf753e483f7fa554,0xbf463f0e3f62bec4,0xbf4ebf223f3e3f35,0xbf67bef13f5c3f0e
.quad 0xbf35248d3f353f80,0x3f35a554bf35bf80,0xbf5cbf75bedb3ec4,0x3f3e3f7f3f18be48,0x3e95bf0ebf7fbf35,0xbf223e483f623f6d,0x3f803f22be79bf6d,0xbf4ebf75beac3f0e
.quad 0x3e483f6d3f55a554,0x3f0ebec4bf7bbf35,0xbf67bdc93f4e3f6d,0x3f5c3f623d49bf55,0xbf22bf7bbe953f35,0xbef13f0e3f7f3ec4,0x3f18bef1bf80bec4,0xbf67bf463e793f7b
.quad 0x3f6d3f35bec4bf80,0x3ec4bf35bf6d248d,0xbe163f623f3ebec4,0x3f713f22bf04bf7b,0xbf7fbe483f623f35,0xbe953f553f46bec4,0xbeacbf7fbe163f6d,0xbf78bef13f3e3f55
.quad 0x3f55bec4bf7b248d,0x3e48bf6dbf0e3f35,0x3f3e3f46bf04bf6d,0x3f7d3e95bf67bf0e,0xbef13f553f22bf35,0xbdc93f7b3e95bf6d,0xbf78be953f713ec4,0xbf80bdc93f7d3e48
.quad 0xbf35248d3f353f80,0x3f35a554bf35bf80,0xbf18bf7fbf3e248d,0x3edb3f753f5c3e48,0x3f623e48bf22bf80,0xbf7fbf0e3e953f6d,0x3eac3f753f4ea554,0x3e79bf22bf80bf0e
.quad 0xbf7bbec43f0e3f80,0x3f553f6d3e48bf35,0xbd49bf62bf5c248d,0xbf4e3dc93f673f55,0x3f7f3f0ebef1bf80,0xbe95bf7bbf223ec4,0xbe793f463f67a554,0x3f803ef1bf18bf7b
.quad 0xbf6dbf353ec43f80,0xbec43f353f6da554,0x3f04bf22bf71248d,0xbf3ebf623e163f7b,0x3f463f55be95bf80,0x3f62be48bf7fbec4,0xbf3e3ef13f78a554,0x3e163f7f3eacbf55
.quad 0xbf0ebf6d3e483f80,0xbf7bbec43f553f35,0x3f67be95bf7d248d,0x3f04bf46bf3e3f0e,0x3e953f7bbdc9bf80,0x3f223f55bef1bf6d,0xbf7d3dc93f80a554,0xbf713e953f78be48
.quad 0xbf35248d3f353f80,0x3f35a554bf35bf80,0xbe79bf62bf71bec4,0x3d493f463f7d3f0e,0x3f753f553dc9bf35,0xbf46bf7bbef13ec4,0xbf3e3dc93f5c3f6d,0x3f7d3ef1bedbbf7b
.quad 0xbe48bf6dbf55248d,0xbf0e3ec43f7b3f35,0x3f713f46be16bf6d,0xbe79bf75bf3e3e48,0xbf463e483f753f35,0x3f623f55bdc9bf6d,0xbe16bf75bf2c3ec4,0xbf71bdc93f5c3f55
.quad 0x3f6d3f35bec4bf80,0x3ec4bf35bf6d248d,0xbf4e3e953f803ec4,0x3edb3f7f3e79bf55,0xbdc9bf7bbef13f35,0xbf75bf0e3f223f6d,0x3f673f22bf18bf6d,0x3f5cbe95bf80be48
.quad 0xbf553ec43f7ba554,0xbe483f6d3f0ebf35,0xbd49bf7fbe793f6d,0xbf18bf623eac3f7b,0x3f623f0ebf46bf35,0x3f7f3e48bf75bec4,0xbf5c3ef13f67bec4,0xbf3e3f223f4ebf0e
.quad 0xbf35248d3f353f80,0x3f35a554bf35bf80,0x3e16bf22bf80bf35,0xbeac3ef13f783f55,0x3ef13f7b3f46a554,0xbdc9bf55bf75bec4,0xbf67bf62be163f35,0x3f043f7f3f2cbe48
.quad 0x3f7b3ec4bf0ebf80,0xbf55bf6dbe483f35,0xbf2c3e953f783f35,0x3f7d3f22beacbf7b,0x3dc9bf55bf62248d,0xbf75be483f463f6d,0x3f043f7f3eacbf35,0x3f3ebe95bf7dbf0e
.quad 0xbf6dbf353ec43f80,0xbec43f353f6da554,0x3f783dc9bf67bf35,0xbd49bf75bf183f0e,0xbf223f0e3f75a554,0x3ef13f7b3dc9bf6d,0x3d49bf75bf043f35,0xbf4ebf463edb3f7b
.quad 0x3f0e3f6dbe48bf80,0x3f7b3ec4bf55bf35,0xbf71bef13f4e3f35,0xbf783dc93f803e48,0x3f75be48bf7f248d,0x3f46bf0ebf623ec4,0xbf183f463f2cbf35,0xbedb3f623f04bf55
.quad 0xbf35248d3f353f80,0x3f35a554bf35bf80,0x3f04be95bf67bf6d,0xbf2c3dc93f4e3f7b,0xbe953f0e3f7f3f35,0x3f22be48bf62bf6d,0x3d49bf46bf78bec4,0xbf183e953f713f55
.quad 0x3e483f6d3f55a554,0x3f0ebec4bf7bbf35,0xbedbbf7fbf183ec4,0xbf043ef13f803f0e,0x3f223f7b3e95bf35,0x3ef1bf0ebf7fbec4,0xbf4ebf623d493f6d,0xbedb3f223f783e48
.quad 0x3f6d3f35bec4bf80,0x3ec4bf35bf6d248d,0xbf7dbef13f2c3f6d,0xbeac3f463f5cbe48,0x3f7f3e48bf62bf35,0x3e95bf55bf463ec4,0xbf713dc93f7d3ec4,0xbe793f623f2cbf0e
.quad 0x3f55bec4bf7b248d,0x3e48bf6dbf0e3f35,0xbf2c3f223f5cbec4,0xbe163f753edbbf55,0x3ef1bf55bf223f35,0x3dc9bf7bbe953f6d,0xbe793f753eacbf6d,0xbd493f7f3e16bf7b
.quad 0x3f353f803f353f80,0xbf35bf80bf35250d,0x3f183f7f3f3ebf80,0xbedbbf75bf5cbe48,0x3ef13f7b3f463f80,0xbdc9bf55bf75bec4,0x3eac3f753f4ebf80,0x3e79bf22bf80bf0e
.quad 0x3e483f6d3f553f80,0x3f0ebec4bf7bbf35,0x3d493f623f5cbf80,0x3f4ebdc9bf67bf55,0xbdc93f553f623f80,0x3f753e48bf46bf6d,0xbe793f463f67bf80,0x3f803ef1bf18bf7b
.quad 0xbec43f353f6d3f80,0x3f6d3f35bec4bf80,0xbf043f223f71bf80,0x3f3e3f62be16bf7b,0xbf223f0e3f753f80,0x3ef13f7b3dc9bf6d,0xbf3e3ef13f78bf80,0x3e163f7f3eacbf55
.quad 0xbf553ec43f7b3f80,0xbe483f6d3f0ebf35,0xbf673e953f7dbf80,0xbf043f463f3ebf0e,0xbf753e483f7f3f80,0xbf463f0e3f62bec4,0xbf7d3dc93f80bf80,0xbf713e953f78be48
.quad 0x3f353f803f350000,0xbf35bf80bf35250d,0x3e793f623f713ec4,0xbd49bf46bf7dbf0e,0xbe953f0e3f7f3f35,0x3f22be48bf62bf6d,0xbf3e3dc93f5c3f6d,0x3f7d3ef1bedbbf7b
.quad 0xbf7bbec43f0e3f80,0x3f553f6d3e48bf35,0xbf71bf463e163f6d,0x3e793f753f3ebe48,0xbf22bf7bbe953f35,0xbef13f0e3f7f3ec4,0xbe16bf75bf2c3ec4,0xbf71bdc93f5c3f55
.quad 0x3ec4bf35bf6d250d,0xbf6dbf353ec43f80,0x3f4ebe95bf80bec4,0xbedbbf7fbe793f55,0x3f7f3e48bf62bf35,0x3e95bf55bf463ec4,0x3f673f22bf18bf6d,0x3f5cbe95bf80be48
.quad 0x3f0e3f6dbe48bf80,0x3f7b3ec4bf55bf35,0x3d493f7f3e79bf6d,0x3f183f62beacbf7b,0xbef13f553f22bf35,0xbdc93f7b3e95bf6d,0xbf5c3ef13f67bec4,0xbf3e3f223f4ebf0e
.quad 0x3f353f803f350000,0xbf35bf80bf35250d,0xbe163f223f803f35,0x3eacbef1bf78bf55,0xbf62be483f223f80,0x3f7f3f0ebe95bf6d,0xbf67bf62be163f35,0x3f043f7f3f2cbe48
.quad 0xbe48bf6dbf55250d,0xbf0e3ec43f7b3f35,0x3f2cbe95bf78bf35,0xbf7dbf223eac3f7b,0x3f7f3f0ebef1bf80,0xbe95bf7bbf223ec4,0x3f043f7f3eacbf35,0x3f3ebe95bf7dbf0e
.quad 0xbec43f353f6d0000,0x3f6d3f35bec4bf80,0xbf78bdc93f673f35,0x3d493f753f18bf0e,0xbf46bf553e953f80,0xbf623e483f7f3ec4,0x3d49bf75bf043f35,0xbf4ebf463edb3f7b
.quad 0x3f55bec4bf7b250d,0x3e48bf6dbf0e3f35,0x3f713ef1bf4ebf35,0x3f78bdc9bf80be48,0x3e953f7bbdc9bf80,0x3f223f55bef1bf6d,0xbf183f463f2cbf35,0xbedb3f623f04bf55
.quad 0x3f353f803f350000,0xbf35bf80bf35250d,0xbf043e953f673f6d,0x3f2cbdc9bf4ebf7b,0xbf75bf55bdc93f35,0x3f463f7b3ef1bec4,0x3d49bf46bf78bec4,0xbf183e953f713f55
.quad 0x3f7b3ec4bf0ebf80,0xbf55bf6dbe483f35,0x3edb3f7f3f18bec4,0x3f04bef1bf80bf0e,0xbf463e483f753f35,0x3f623f55bdc9bf6d,0xbf4ebf623d493f6d,0xbedb3f223f783e48
.quad 0x3ec4bf35bf6d250d,0xbf6dbf353ec43f80,0x3f7d3ef1bf2cbf6d,0x3eacbf46bf5c3e48,0x3dc93f7b3ef1bf35,0x3f753f0ebf22bf6d,0xbf713dc93f7d3ec4,0xbe793f623f2cbf0e
.quad 0xbf0ebf6d3e483f80,0xbf7bbec43f553f35,0x3f2cbf22bf5c3ec4,0x3e16bf75bedb3f55,0x3f623f0ebf46bf35,0x3f7f3e48bf75bec4,0xbe793f753eacbf6d,0xbd493f7f3e16bf7b
.quad 0x3f353f803f350000,0xbf35bf80bf35250d,0xbf4ebdc93f2c3f80,0x3f673e95bf04bf7b,0xbef1bf7bbf46250d,0x3dc93f553f753ec4,0x3f713e95bf18bf80,0xbf78bf463d493f55
.quad 0x3e483f6d3f550000,0x3f0ebec4bf7bbf35,0xbf80bef13f043f80,0x3f183f7f3edbbf0e,0x3dc9bf55bf62250d,0xbf75be483f463f6d,0x3f783f22bedbbf80,0x3d49bf62bf4e3e48
.quad 0xbec43f353f6d0000,0x3f6d3f35bec4bf80,0xbf5cbf463eac3f80,0xbf2c3ef13f7d3e48,0x3f22bf0ebf75250d,0xbef1bf7bbdc93f6d,0x3f2c3f62be79bf80,0x3f7d3dc9bf71bf0e
.quad 0xbf553ec43f7b0000,0xbe483f6d3f0ebf35,0xbedbbf753e163f80,0xbf5cbf223f2c3f55,0x3f75be48bf7f250d,0x3f46bf0ebf623ec4,0x3e163f7fbd49bf80,0x3eac3f75be79bf7b
.quad 0x3f353f803f350000,0xbf35bf80bf35250d,0xbf78bef13eac3f6d,0x3f803f22be16bf55,0x3e95bf0ebf7fbf35,0xbf223e483f623f6d,0x3f2c3f7f3f04bec4,0xbe16bf62bf67be48
.quad 0xbf7bbec43f0e3f80,0x3f553f6d3e48bf35,0x3eacbf22bf7dbec4,0xbf78be953f2c3f7b,0x3f223f7b3e95bf35,0x3ef1bf0ebf7fbec4,0xbf7dbe953f3e3f6d,0x3eac3f7f3f04bf0e
.quad 0x3ec4bf35bf6d250d,0xbf6dbf353ec43f80,0x3f183f753d49bf6d,0x3f67bdc9bf78bf0e,0xbf7fbe483f623f35,0xbe953f553f46bec4,0x3edbbf46bf4e3ec4,0xbf04bf753d493f7b
.quad 0x3f0e3f6dbe48bf80,0x3f7b3ec4bf55bf35,0xbf80bdc93f783ec4,0xbf4e3ef13f71be48,0x3ef1bf55bf223f35,0x3dc9bf7bbe953f6d,0x3f043f62bedbbf6d,0x3f2c3f46bf18bf55
.quad 0x3f353f803f350000,0xbf35bf80bf35250d,0xbf7dbf46bd493f35,0x3f713f623e79bf0e,0x3f623e48bf22bf80,0xbf7fbf0e3e953f6d,0xbedb3ef13f7d3f35,0x3f5c3dc9bf3ebf7b
.quad 0xbe48bf6dbf55250d,0xbf0e3ec43f7b3f35,0x3f3e3f753e79bf35,0x3e16bf46bf71be48,0xbf7fbf0e3ef13f80,0x3e953f7b3f22bec4,0x3f5cbdc9bf71bf35,0xbf2cbf75be163f55
.quad 0xbec43f353f6d0000,0x3f6d3f35bec4bf80,0xbe79bf7fbedb3f35,0xbf80be953f4e3f55,0x3f463f55be95bf80,0x3f62be48bf7fbec4,0xbf80be953f5c3f35,0xbf183f223f67be48
.quad 0x3f55bec4bf7b250d,0x3e48bf6dbf0e3f35,0xbeac3f623f18bf35,0x3e793f7f3d49bf7b,0xbe95bf7b3dc93f80,0xbf22bf553ef13f6d,0x3f4e3f22bf3ebf35,0x3f673ef1bf5cbf0e
.quad 0x3f353f803f350000,0xbf35bf80bf35250d,0xbf5cbf75bedb3ec4,0x3f3e3f7f3f18be48,0x3f753f553dc9bf35,0xbf46bf7bbef13ec4,0xbf80bf223e793f6d,0x3f4e3f753eacbf0e
.quad 0x3f7b3ec4bf0ebf80,0xbf55bf6dbe483f35,0xbf67bdc93f4e3f6d,0x3f5c3f623d49bf55,0x3f46be48bf75bf35,0xbf62bf553dc93f6d,0xbf183ef13f803ec4,0x3f673f46be79bf7b
.quad 0x3ec4bf35bf6d250d,0xbf6dbf353ec43f80,0xbe163f623f3ebec4,0x3f713f22bf04bf7b,0xbdc9bf7bbef13f35,0xbf75bf0e3f223f6d,0x3eac3f7f3e16bf6d,0x3f783ef1bf3ebf55
.quad 0xbf0ebf6d3e483f80,0xbf7bbec43f553f35,0x3f3e3f46bf04bf6d,0x3f7d3e95bf67bf0e,0xbf62bf0e3f463f35,0xbf7fbe483f753ec4,0x3f783e95bf71bec4,0x3f803dc9bf7dbe48
.quad 0xa554bf80248d3f80,0xa554bf80248d3f80,0x3e16bf7fbd493f80,0x3eacbf75be793f7b,0x3e95bf7bbdc93f80,0x3f22bf55bef13f6d,0x3edbbf75be163f80,0x3f5cbf22bf2c3f55
.quad 0x3f0ebf6dbe483f80,0x3f7bbec4bf553f35,0x3f2cbf62be793f80,0x3f7dbdc9bf713f0e,0x3f46bf55be953f80,0x3f623e48bf7f3ec4,0x3f5cbf46beac3f80,0x3f2c3ef1bf7d3e48
.quad 0x3f6dbf35bec43f80,0x3ec43f35bf6d248d,0x3f78bf22bedb3f80,0x3d493f62bf4ebe48,0x3f7fbf0ebef13f80,0xbe953f7bbf22bec4,0x3f80bef1bf043f80,0xbf183f7fbedbbf0e
.quad 0x3f7bbec4bf0e3f80,0xbf553f6dbe48bf35,0x3f71be95bf183f80,0xbf783f463d49bf55,0x3f62be48bf223f80,0xbf7f3f0e3e95bf6d,0x3f4ebdc9bf2c3f80,0xbf673e953f04bf7b
.quad 0xa554bf80248d3f80,0xa554bf80248d3f80,0x3f04bf62bedb3f6d,0x3f2cbf46bf183f55,0x3f62bf0ebf463f35,0x3f7fbe48bf753ec4,0x3f80bdc9bf783ec4,0x3f4e3ef1bf71be48
.quad 0x3f553ec4bf7b248d,0x3e483f6dbf0ebf35,0x3edb3f46bf4ebec4,0xbf043f753d49bf7b,0xbdc93f7bbef1bf35,0xbf753f0e3f22bf6d,0xbf183f75bd49bf6d,0xbf67bdc93f78bf0e
.quad 0xbf6d3f353ec4bf80,0xbec4bf353f6da554,0xbf7d3e953f3ebf6d,0x3eacbf7f3f043f0e,0xbf46be483f75bf35,0x3f62bf55bdc93f6d,0xbeacbf223f7dbec4,0x3f78be95bf2c3f7b
.quad 0x3e48bf6d3f55a554,0x3f0e3ec4bf7b3f35,0x3f2cbf7f3f043ec4,0xbe163f62bf673e48,0x3f75bf553dc93f35,0xbf463f7bbef1bec4,0x3f78bef1beac3f6d,0xbf803f223e16bf55
.quad 0xa554bf80248d3f80,0xa554bf80248d3f80,0x3f4ebf22bf3e3f35,0x3f67bef1bf5c3f0e,0x3f753e48bf7f248d,0x3f463f0ebf62bec4,0x3eac3f62bf18bf35,0xbe793f7fbd49bf7b
.quad 0xbf0e3f6d3e48bf80,0xbf7b3ec43f55bf35,0xbf803e953f5cbf35,0xbf18bf223f673e48,0xbf22bf0e3f75a554,0x3ef1bf7b3dc93f6d,0x3e79bf7f3edb3f35,0x3f80be95bf4e3f55
.quad 0x3f6dbf35bec43f80,0x3ec43f35bf6d248d,0x3f5c3dc9bf713f35,0xbf2c3f75be16bf55,0x3dc93f55bf62248d,0xbf753e483f46bf6d,0xbf3e3f75be79bf35,0xbe16bf463f71be48
.quad 0xbf7b3ec43f0ebf80,0x3f55bf6d3e483f35,0xbedbbef13f7dbf35,0x3f5cbdc9bf3e3f7b,0x3ef1bf7b3f46a554,0xbdc93f55bf753ec4,0x3f7dbf463d493f35,0xbf713f62be79bf0e
.quad 0xa554bf80248d3f80,0xa554bf80248d3f80,0x3f78be95bf713ec4,0x3f80bdc9bf7d3e48,0x3ef13f55bf22bf35,0x3dc93f7bbe95bf6d,0xbf3e3f463f04bf6d,0xbf7d3e953f67bf0e
.quad 0xbf55bec43f7ba554,0xbe48bf6d3f0e3f35,0x3eacbf7f3e163f6d,0x3f78bef1bf3e3f55,0x3f7fbe48bf623f35,0x3e953f55bf46bec4,0x3e163f62bf3ebec4,0xbf713f223f04bf7b
.quad 0xbf6d3f353ec4bf80,0xbec4bf353f6da554,0xbf18bef13f80bec4,0x3f67bf46be793f7b,0x3f22bf7b3e953f35,0x3ef13f0ebf7f3ec4,0x3f67bdc9bf4e3f6d,0xbf5c3f62bd49bf55
.quad 0xbe483f6dbf55248d,0xbf0ebec43f7bbf35,0xbf803f223e79bf6d,0x3f4ebf753eac3f0e,0xbe95bf0e3f7fbf35,0x3f223e48bf623f6d,0x3f5cbf753edb3ec4,0xbf3e3f7fbf18be48
.quad 0xa554bf80248d3f80,0xa554bf80248d3f80,0x3f7d3dc9bf80248d,0x3f713e95bf78be48,0xbe953f7b3dc9bf80,0xbf223f553ef1bf6d,0xbf67be953f7da554,0xbf04bf463f3e3f0e
.quad 0x3f0ebf6dbe483f80,0x3f7bbec4bf553f35,0x3f3e3ef1bf78248d,0xbe163f7fbeacbf55,0xbf463f553e95bf80,0xbf62be483f7fbec4,0xbf04bf223f71a554,0x3f3ebf62be163f7b
.quad 0x3f6dbf35bec43f80,0x3ec43f35bf6d248d,0x3e793f46bf67248d,0xbf803ef13f18bf7b,0xbf7f3f0e3ef1bf80,0x3e95bf7b3f223ec4,0x3d49bf623f5ca554,0x3f4e3dc9bf673f55
.quad 0x3f7bbec4bf0e3f80,0xbf553f6dbe48bf35,0xbeac3f75bf4e248d,0xbe79bf223f80bf0e,0xbf623e483f22bf80,0x3f7fbf0ebe953f6d,0x3f18bf7f3f3ea554,0xbedb3f75bf5c3e48
.quad 0xa554bf80248d3f80,0xa554bf80248d3f80,0x3f5c3ef1bf67bec4,0x3f3e3f22bf4ebf0e,0xbf623f0e3f46bf35,0xbf7f3e483f75bec4,0x3d49bf7f3e793f6d,0x3f18bf62beac3f7b
.quad 0x3f553ec4bf7b248d,0x3e483f6dbf0ebf35,0xbf673f223f18bf6d,0xbf5cbe953f80be48,0x3dc9bf7b3ef13f35,0x3f75bf0ebf223f6d,0x3f4e3e95bf803ec4,0xbedb3f7fbe79bf55
.quad 0xbf6d3f353ec4bf80,0xbec4bf353f6da554,0x3e16bf753f2c3ec4,0x3f71bdc9bf5c3f55,0x3f463e48bf753f35,0xbf623f553dc9bf6d,0xbf713f463e16bf6d,0x3e79bf753f3e3e48
.quad 0x3e48bf6d3f55a554,0x3f0e3ec4bf7b3f35,0x3f3e3dc9bf5c3f6d,0xbf7d3ef13edbbf7b,0xbf753f55bdc9bf35,0x3f46bf7b3ef13ec4,0x3e79bf623f71bec4,0xbd493f46bf7d3f0e
.quad 0xa554bf80248d3f80,0xa554bf80248d3f80,0x3f183f46bf2cbf35,0x3edb3f62bf04bf55,0xbf75be483f7fa554,0xbf46bf0e3f623ec4,0x3f71bef1bf4e3f35,0x3f783dc9bf803e48
.quad 0xbf0e3f6d3e48bf80,0xbf7b3ec43f55bf35,0xbd49bf753f043f35,0x3f4ebf46bedb3f7b,0x3f223f0ebf75248d,0xbef13f7bbdc9bf6d,0xbf783dc93f67bf35,0x3d49bf753f183f0e
.quad 0x3f6dbf35bec43f80,0x3ec43f35bf6d248d,0xbf043f7fbeacbf35,0xbf3ebe953f7dbf0e,0xbdc9bf553f62a554,0x3f75be48bf463f6d,0x3f2c3e95bf783f35,0xbf7d3f223eacbf7b
.quad 0xbf7b3ec43f0ebf80,0x3f55bf6d3e483f35,0x3f67bf623e163f35,0xbf043f7fbf2cbe48,0xbef13f7bbf46248d,0x3dc9bf553f75bec4,0xbe16bf223f80bf35,0x3eac3ef1bf783f55
.quad 0xa554bf80248d3f80,0xa554bf80248d3f80,0x3e793f75beacbf6d,0x3d493f7fbe16bf7b,0xbef1bf553f223f35,0xbdc9bf7b3e953f6d,0x3f2c3f22bf5cbec4,0x3e163f75bedbbf55
.quad 0xbf55bec43f7ba554,0xbe48bf6d3f0e3f35,0x3f713dc9bf7d3ec4,0x3e793f62bf2cbf0e,0xbf7f3e483f62bf35,0xbe95bf553f463ec4,0x3f7dbef1bf2c3f6d,0x3eac3f46bf5cbe48
.quad 0xbf6d3f353ec4bf80,0xbec4bf353f6da554,0x3f4ebf62bd493f6d,0x3edb3f22bf783e48,0xbf223f7bbe95bf35,0xbef1bf0e3f7fbec4,0x3edbbf7f3f183ec4,0x3f043ef1bf803f0e
.quad 0xbe483f6dbf55248d,0xbf0ebec43f7bbf35,0xbd49bf463f78bec4,0x3f183e95bf713f55,0x3e953f0ebf7f3f35,0xbf22be483f62bf6d,0xbf04be953f67bf6d,0x3f2c3dc9bf4e3f7b
.quad 0xbf80250d3f803f80,0xbf80250d3f800000,0xbf7dbdc93f80bf80,0xbf71be953f783e48,0xbf75be483f7f3f80,0xbf46bf0e3f623ec4,0xbf67be953f7dbf80,0xbf04bf463f3e3f0e
.quad 0xbf55bec43f7b3f80,0xbe48bf6d3f0e3f35,0xbf3ebef13f78bf80,0x3e16bf7f3eac3f55,0xbf22bf0e3f753f80,0x3ef1bf7b3dc93f6d,0xbf04bf223f71bf80,0x3f3ebf62be163f7b
.quad 0xbec4bf353f6d3f80,0x3f6dbf35bec43f80,0xbe79bf463f67bf80,0x3f80bef1bf183f7b,0xbdc9bf553f623f80,0x3f75be48bf463f6d,0x3d49bf623f5cbf80,0x3f4e3dc9bf673f55
.quad 0x3e48bf6d3f553f80,0x3f0e3ec4bf7b3f35,0x3eacbf753f4ebf80,0x3e793f22bf803f0e,0x3ef1bf7b3f463f80,0xbdc93f55bf753ec4,0x3f18bf7f3f3ebf80,0xbedb3f75bf5c3e48
.quad 0xbf80250d3f800000,0xbf80250d3f800000,0xbf5cbef13f673ec4,0xbf3ebf223f4e3f0e,0xbef1bf553f223f35,0xbdc9bf7b3e953f6d,0x3d49bf7f3e793f6d,0x3f18bf62beac3f7b
.quad 0x3f0ebf6dbe483f80,0x3f7bbec4bf553f35,0x3f67bf22bf183f6d,0x3f5c3e95bf803e48,0x3f7fbe48bf623f35,0x3e953f55bf46bec4,0x3f4e3e95bf803ec4,0xbedb3f7fbe79bf55
.quad 0x3ec43f35bf6d250d,0xbf6d3f353ec4bf80,0xbe163f75bf2cbec4,0xbf713dc93f5cbf55,0xbf223f7bbe95bf35,0xbef1bf0e3f7fbec4,0xbf713f463e16bf6d,0x3e79bf753f3e3e48
.quad 0xbf7b3ec43f0ebf80,0x3f55bf6d3e483f35,0xbf3ebdc93f5cbf6d,0x3f7dbef1bedb3f7b,0xbe95bf0e3f7fbf35,0x3f223e48bf623f6d,0x3e79bf623f71bec4,0xbd493f46bf7d3f0e
.quad 0xbf80250d3f800000,0xbf80250d3f800000,0xbf18bf463f2c3f35,0xbedbbf623f043f55,0x3e95bf7bbdc93f80,0x3f22bf55bef13f6d,0x3f71bef1bf4e3f35,0x3f783dc9bf803e48
.quad 0x3f553ec4bf7b250d,0x3e483f6dbf0ebf35,0x3d493f75bf04bf35,0xbf4e3f463edbbf7b,0xbf463f553e95bf80,0xbf62be483f7fbec4,0xbf783dc93f67bf35,0x3d49bf753f183f0e
.quad 0xbec4bf353f6d0000,0x3f6dbf35bec43f80,0x3f04bf7f3eac3f35,0x3f3e3e95bf7d3f0e,0x3f7fbf0ebef13f80,0xbe953f7bbf22bec4,0x3f2c3e95bf783f35,0xbf7d3f223eacbf7b
.quad 0xbe483f6dbf55250d,0xbf0ebec43f7bbf35,0xbf673f62be16bf35,0x3f04bf7f3f2c3e48,0xbf623e483f22bf80,0x3f7fbf0ebe953f6d,0xbe16bf223f80bf35,0x3eac3ef1bf783f55
.quad 0xbf80250d3f800000,0xbf80250d3f800000,0xbe79bf753eac3f6d,0xbd49bf7f3e163f7b,0x3f62bf0ebf463f35,0x3f7fbe48bf753ec4,0x3f2c3f22bf5cbec4,0x3e163f75bedbbf55
.quad 0xbf0e3f6d3e48bf80,0xbf7b3ec43f55bf35,0xbf71bdc93f7dbec4,0xbe79bf623f2c3f0e,0x3dc9bf7b3ef13f35,0x3f75bf0ebf223f6d,0x3f7dbef1bf2c3f6d,0x3eac3f46bf5cbe48
.quad 0x3ec43f35bf6d250d,0xbf6d3f353ec4bf80,0xbf4e3f623d49bf6d,0xbedbbf223f78be48,0xbf46be483f75bf35,0x3f62bf55bdc93f6d,0x3edbbf7f3f183ec4,0x3f043ef1bf803f0e
.quad 0x3f7bbec4bf0e3f80,0xbf553f6dbe48bf35,0x3d493f46bf783ec4,0xbf18be953f71bf55,0xbf753f55bdc9bf35,0x3f46bf7b3ef13ec4,0xbf04be953f67bf6d,0x3f2c3dc9bf4e3f7b
.quad 0xbf80250d3f800000,0xbf80250d3f800000,0x3e16bf7fbd493f80,0x3eacbf75be793f7b,0x3f753e48bf7f250d,0x3f463f0ebf62bec4,0xbedb3f753e16bf80,0xbf5c3f223f2cbf55
.quad 0xbf55bec43f7b0000,0xbe48bf6d3f0e3f35,0x3f2cbf62be793f80,0x3f7dbdc9bf713f0e,0x3f223f0ebf75250d,0xbef13f7bbdc9bf6d,0xbf5c3f463eacbf80,0xbf2cbef13f7dbe48
.quad 0xbec4bf353f6d0000,0x3f6dbf35bec43f80,0x3f78bf22bedb3f80,0x3d493f62bf4ebe48,0x3dc93f55bf62250d,0xbf753e483f46bf6d,0xbf803ef13f04bf80,0x3f18bf7f3edb3f0e
.quad 0x3e48bf6d3f550000,0x3f0e3ec4bf7b3f35,0x3f71be95bf183f80,0xbf783f463d49bf55,0xbef13f7bbf46250d,0x3dc9bf553f75bec4,0xbf4e3dc93f2cbf80,0x3f67be95bf043f7b
.quad 0xbf80250d3f800000,0xbf80250d3f800000,0x3f04bf62bedb3f6d,0x3f2cbf46bf183f55,0x3ef13f55bf22bf35,0x3dc93f7bbe95bf6d,0xbf803dc93f78bec4,0xbf4ebef13f713e48
.quad 0x3f0ebf6dbe483f80,0x3f7bbec4bf553f35,0x3edb3f46bf4ebec4,0xbf043f753d49bf7b,0xbf7f3e483f62bf35,0xbe95bf553f463ec4,0x3f18bf753d493f6d,0x3f673dc9bf783f0e
.quad 0x3ec43f35bf6d250d,0xbf6d3f353ec4bf80,0xbf7d3e953f3ebf6d,0x3eacbf7f3f043f0e,0x3f22bf7b3e953f35,0x3ef13f0ebf7f3ec4,0x3eac3f22bf7d3ec4,0xbf783e953f2cbf7b
.quad 0xbf7b3ec43f0ebf80,0x3f55bf6d3e483f35,0x3f2cbf7f3f043ec4,0xbe163f62bf673e48,0x3e953f0ebf7f3f35,0xbf22be483f62bf6d,0xbf783ef13eacbf6d,0x3f80bf22be163f55
.quad 0xbf80250d3f800000,0xbf80250d3f800000,0x3f4ebf22bf3e3f35,0x3f67bef1bf5c3f0e,0xbe953f7b3dc9bf80,0xbf223f553ef1bf6d,0xbeacbf623f183f35,0x3e79bf7f3d493f7b
.quad 0x3f553ec4bf7b250d,0x3e483f6dbf0ebf35,0xbf803e953f5cbf35,0xbf18bf223f673e48,0x3f46bf55be953f80,0x3f623e48bf7f3ec4,0xbe793f7fbedbbf35,0xbf803e953f4ebf55
.quad 0xbec4bf353f6d0000,0x3f6dbf35bec43f80,0x3f5c3dc9bf713f35,0xbf2c3f75be16bf55,0xbf7f3f0e3ef1bf80,0x3e95bf7b3f223ec4,0x3f3ebf753e793f35,0x3e163f46bf713e48
.quad 0xbe483f6dbf55250d,0xbf0ebec43f7bbf35,0xbedbbef13f7dbf35,0x3f5cbdc9bf3e3f7b,0x3f62be48bf223f80,0xbf7f3f0e3e95bf6d,0xbf7d3f46bd49bf35,0x3f71bf623e793f0e
.quad 0xbf80250d3f800000,0xbf80250d3f800000,0x3f78be95bf713ec4,0x3f80bdc9bf7d3e48,0xbf623f0e3f46bf35,0xbf7f3e483f75bec4,0x3f3ebf46bf043f6d,0x3f7dbe95bf673f0e
.quad 0xbf0e3f6d3e48bf80,0xbf7b3ec43f55bf35,0x3eacbf7f3e163f6d,0x3f78bef1bf3e3f55,0xbdc93f7bbef1bf35,0xbf753f0e3f22bf6d,0xbe16bf623f3e3ec4,0x3f71bf22bf043f7b
.quad 0x3ec43f35bf6d250d,0xbf6d3f353ec4bf80,0xbf18bef13f80bec4,0x3f67bf46be793f7b,0x3f463e48bf753f35,0xbf623f553dc9bf6d,0xbf673dc93f4ebf6d,0x3f5cbf623d493f55
.quad 0x3f7bbec4bf0e3f80,0xbf553f6dbe48bf35,0xbf803f223e79bf6d,0x3f4ebf753eac3f0e,0x3f75bf553dc93f35,0xbf463f7bbef1bec4,0xbf5c3f75bedbbec4,0x3f3ebf7f3f183e48
.quad 0x3f35a554bf353f80,0xbf35248d3f35bf80,0x3f183dc9bf3e3f80,0xbedbbe953f5cbf7b,0x3ef13e48bf463f80,0xbdc9bf0e3f75bf6d,0x3eac3e95bf4e3f80,0x3e79bf463f80bf55
.quad 0x3e483ec4bf553f80,0x3f0ebf6d3f7bbf35,0x3d493ef1bf5c3f80,0x3f4ebf7f3f67bf0e,0xbdc93f0ebf623f80,0x3f75bf7b3f46bec4,0xbe793f22bf673f80,0x3f80bf623f18be48
.quad 0xbec43f35bf6d3f80,0x3f6dbf353ec4a554,0xbf043f46bf713f80,0x3f3ebef13e163e48,0xbf223f55bf753f80,0x3ef1be48bdc93ec4,0xbf3e3f62bf783f80,0x3e163dc9beac3f0e
.quad 0xbf553f6dbf7b3f80,0xbe483ec4bf0e3f35,0xbf673f75bf7d3f80,0xbf043f22bf3e3f55,0xbf753f7bbf7f3f80,0xbf463f55bf623f6d,0xbf7d3f7fbf803f80,0xbf713f75bf783f7b
.quad 0x3f35a554bf353f80,0xbf35248d3f35bf80,0x3e793ef1bf713f6d,0xbd49bf223f7dbf55,0xbe953f55bf7f3f35,0x3f22bf7b3f62bec4,0xbf3e3f7fbf5c3ec4,0x3f7dbf623edb3e48
.quad 0xbf7b3f6dbf0e248d,0x3f55bec4be483f35,0xbf713f22be16bec4,0x3e793e95bf3e3f7b,0xbf223e483e95bf35,0xbef13f55bf7f3f6d,0xbe16be953f2cbf6d,0xbf713f7fbf5c3f0e
.quad 0x3ec4bf353f6dbf80,0xbf6d3f35bec4248d,0x3f4ebf753f80bf6d,0xbedb3dc93e79bf0e,0x3f7fbf7b3f62bf35,0x3e95bf0e3f46bf6d,0x3f67bf463f18bec4,0x3f5cbf753f80bf7b
.quad 0x3f0ebec43e48a554,0x3f7bbf6d3f55bf35,0x3d493dc9be793ec4,0x3f18bef13eacbe48,0xbef13f0ebf223f35,0xbdc93e48be953ec4,0xbf5c3f62bf673f6d,0xbf3e3f46bf4e3f55
.quad 0x3f35a554bf353f80,0xbf35248d3f35bf80,0xbe163f46bf803f35,0x3eacbf623f78bf0e,0xbf623f7bbf22248d,0x3f7fbf553e953ec4,0xbf673ef13e16bf35,0x3f043dc9bf2c3f7b
.quad 0xbe48bec43f55bf80,0xbf0e3f6dbf7b3f35,0x3f2cbf753f78bf35,0xbf7d3f46beacbe48,0x3f7fbf553ef1a554,0xbe95be483f22bf6d,0x3f04bdc9beac3f35,0x3f3ebf753f7dbf55
.quad 0xbec43f35bf6d3f80,0x3f6dbf353ec4a554,0xbf783f7fbf673f35,0x3d493e95bf183f55,0xbf463f0ebe95248d,0xbf623f7bbf7f3f6d,0x3d49be953f04bf35,0xbf4e3f22bedb3e48
.quad 0x3f55bf6d3f7bbf80,0x3e48bec43f0ebf35,0x3f71bf623f4ebf35,0x3f78bf7f3f80bf7b,0x3e95be483dc9a554,0x3f22bf0e3ef1bec4,0xbf183f22bf2c3f35,0xbedb3ef1bf043f0e
.quad 0x3f35a554bf353f80,0xbf35248d3f35bf80,0xbf043f75bf673ec4,0x3f2cbf7f3f4ebe48,0xbf753f0e3dc9bf35,0x3f46be48bef13f6d,0x3d49bf223f78bf6d,0xbf183f75bf713f0e
.quad 0x3f7bbf6d3f0ea554,0xbf553ec43e48bf35,0x3edb3dc9bf183f6d,0x3f04bf623f80bf55,0xbf463f7bbf753f35,0x3f62bf0e3dc93ec4,0xbf4e3ef1bd49bec4,0xbedb3f46bf783f7b
.quad 0x3ec4bf353f6dbf80,0xbf6d3f35bec4248d,0x3f7dbf623f2cbec4,0x3eacbf223f5cbf7b,0x3dc93e48bef13f35,0x3f75bf553f22bec4,0xbf713f7fbf7d3f6d,0xbe793ef1bf2c3f55
.quad 0xbf0e3ec4be48248d,0xbf7b3f6dbf553f35,0x3f2cbf463f5cbf6d,0x3e16be953edbbf0e,0x3f62bf553f46bf35,0x3f7fbf7b3f75bf6d,0xbe793e95beac3ec4,0xbd493dc9be163e48
.quad 0x3f35a554bf353f80,0xbf35248d3f35bf80,0xbf4e3f7fbf2c248d,0x3f67bf753f043e48,0xbef1be483f46bf80,0x3dc93f0ebf753f6d,0x3f71bf753f18a554,0xbf783f22bd49bf0e
.quad 0x3e483ec4bf553f80,0x3f0ebf6d3f7bbf35,0xbf803f62bf04248d,0x3f18bdc9bedb3f55,0x3dc9bf0e3f62bf80,0xbf753f7bbf463ec4,0x3f78bf463edba554,0x3d49bef13f4ebf7b
.quad 0xbec43f35bf6d3f80,0x3f6dbf353ec4a554,0xbf5c3f22beac248d,0xbf2c3f62bf7d3f7b,0x3f22bf553f75bf80,0xbef13e483dc9bec4,0x3f2cbef13e79a554,0x3f7dbf7f3f71bf55
.quad 0xbf553f6dbf7b3f80,0xbe483ec4bf0e3f35,0xbedb3e95be16248d,0xbf5c3f46bf2c3f0e,0x3f75bf7b3f7fbf80,0x3f46bf553f62bf6d,0x3e16bdc93d49a554,0x3eacbe953e79be48
.quad 0x3f35a554bf353f80,0xbf35248d3f35bf80,0xbf783f62beacbec4,0x3f80bf463e163f0e,0x3e95bf553f7fbf35,0xbf223f7bbf623ec4,0x3f2cbdc9bf043f6d,0xbe16bef13f67bf7b
.quad 0xbf7b3f6dbf0e248d,0x3f55bec4be483f35,0x3eacbf463f7dbf6d,0xbf783f75bf2c3e48,0x3f22be48be953f35,0x3ef1bf553f7fbf6d,0xbf7d3f75bf3e3ec4,0x3eac3dc9bf043f55
.quad 0x3ec4bf353f6dbf80,0xbf6d3f35bec4248d,0x3f18be95bd493ec4,0x3f67bf7f3f78bf55,0xbf7f3f7bbf623f35,0xbe953f0ebf463f6d,0x3edbbf223f4ebf6d,0xbf043e95bd49be48
.quad 0x3f0ebec43e48a554,0x3f7bbf6d3f55bf35,0xbf803f7fbf783f6d,0xbf4e3f62bf713f7b,0x3ef1bf0e3f22bf35,0x3dc9be483e95bec4,0x3f04bef13edbbec4,0x3f2cbf223f18bf0e
.quad 0x3f35a554bf353f80,0xbf35248d3f35bf80,0xbf7d3f223d49bf35,0x3f71bef1be793f55,0x3f62bf7b3f22a554,0xbf7f3f55be95bec4,0xbedb3f62bf7d3f35,0x3f5cbf7f3f3ebe48
.quad 0xbe48bec43f55bf80,0xbf0e3f6dbf7b3f35,0x3f3ebe95be793f35,0x3e16bf223f71bf7b,0xbf7f3f55bef1248d,0x3e953e48bf223f6d,0x3f5cbf7f3f71bf35,0xbf2c3e953e16bf0e
.quad 0xbec43f35bf6d3f80,0x3f6dbf353ec4a554,0xbe79bdc93edbbf35,0xbf803f75bf4e3f0e,0x3f46bf0e3e95a554,0x3f62bf7b3f7fbf6d,0xbf803f75bf5c3f35,0xbf183f46bf673f7b
.quad 0x3f55bf6d3f7bbf80,0x3e48bec43f0ebf35,0xbeac3ef1bf183f35,0x3e79bdc9bd493e48,0xbe953e48bdc9248d,0xbf223f0ebef13ec4,0x3f4ebf463f3ebf35,0x3f67bf623f5cbf55
.quad 0x3f35a554bf353f80,0xbf35248d3f35bf80,0xbf5c3e953edbbf6d,0x3f3ebdc9bf183f7b,0x3f75bf0ebdc93f35,0xbf463e483ef1bf6d,0xbf803f46be79bec4,0x3f4ebe95beac3f55
.quad 0x3f7bbf6d3f0ea554,0xbf553ec43e48bf35,0xbf673f7fbf4e3ec4,0x3f5cbef1bd493f0e,0x3f46bf7b3f75bf35,0xbf623f0ebdc9bec4,0xbf183f62bf803f6d,0x3f67bf223e793e48
.quad 0x3ec4bf353f6dbf80,0xbf6d3f35bec4248d,0xbe163ef1bf3e3f6d,0x3f71bf463f04be48,0xbdc9be483ef1bf35,0xbf753f55bf223ec4,0x3eacbdc9be163ec4,0x3f78bf623f3ebf0e
.quad 0xbf0e3ec4be48248d,0xbf7b3f6dbf553f35,0x3f3ebf223f04bec4,0x3f7dbf753f67bf55,0xbf623f55bf463f35,0xbf7f3f7bbf753f6d,0x3f78bf753f71bf6d,0x3f80bf7f3f7dbf7b
.quad 0x3f35bf803f353f80,0xbf353f80bf35250d,0x3f4ebf7f3f2cbf80,0xbf673f75bf04be48,0x3f62bf7b3f223f80,0xbf7f3f55be95bec4,0x3f71bf753f18bf80,0xbf783f22bd49bf0e
.quad 0x3f7bbf6d3f0e3f80,0xbf553ec43e48bf35,0x3f80bf623f04bf80,0xbf183dc93edbbf55,0x3f7fbf553ef13f80,0xbe95be483f22bf6d,0x3f78bf463edbbf80,0x3d49bef13f4ebf7b
.quad 0x3f6dbf353ec43f80,0x3ec4bf353f6dbf80,0x3f5cbf223eacbf80,0x3f2cbf623f7dbf7b,0x3f46bf0e3e953f80,0x3f62bf7b3f7fbf6d,0x3f2cbef13e79bf80,0x3f7dbf7f3f71bf55
.quad 0x3f0ebec43e483f80,0x3f7bbf6d3f55bf35,0x3edbbe953e16bf80,0x3f5cbf463f2cbf0e,0x3e95be483dc93f80,0x3f22bf0e3ef1bec4,0x3e16bdc93d49bf80,0x3eacbe953e79be48
.quad 0x3f35bf803f350000,0xbf353f80bf35250d,0x3f78bf623eac3ec4,0xbf803f46be16bf0e,0x3f75bf0ebdc93f35,0xbf463e483ef1bf6d,0x3f2cbdc9bf043f6d,0xbe16bef13f67bf7b
.quad 0x3e483ec4bf553f80,0x3f0ebf6d3f7bbf35,0xbeac3f46bf7d3f6d,0x3f78bf753f2cbe48,0xbf463f7bbf753f35,0x3f62bf0e3dc93ec4,0xbf7d3f75bf3e3ec4,0x3eac3dc9bf043f55
.quad 0xbf6d3f35bec4250d,0xbec43f35bf6d3f80,0xbf183e953d49bec4,0xbf673f7fbf783f55,0xbdc9be483ef1bf35,0xbf753f55bf223ec4,0x3edbbf223f4ebf6d,0xbf043e95bd49be48
.quad 0x3f55bf6d3f7bbf80,0x3e48bec43f0ebf35,0x3f80bf7f3f78bf6d,0x3f4ebf623f71bf7b,0x3f62bf553f46bf35,0x3f7fbf7b3f75bf6d,0x3f04bef13edbbec4,0x3f2cbf223f18bf0e
.quad 0x3f35bf803f350000,0xbf353f80bf35250d,0x3f7dbf22bd493f35,0xbf713ef13e79bf55,0x3ef13e48bf463f80,0xbdc9bf0e3f75bf6d,0xbedb3f62bf7d3f35,0x3f5cbf7f3f3ebe48
.quad 0xbf7b3f6dbf0e250d,0x3f55bec4be483f35,0xbf3e3e953e79bf35,0xbe163f22bf713f7b,0x3dc9bf0e3f62bf80,0xbf753f7bbf463ec4,0x3f5cbf7f3f71bf35,0xbf2c3e953e16bf0e
.quad 0x3f6dbf353ec40000,0x3ec4bf353f6dbf80,0x3e793dc9bedb3f35,0x3f80bf753f4ebf0e,0xbf223f55bf753f80,0x3ef1be48bdc93ec4,0xbf803f75bf5c3f35,0xbf183f46bf673f7b
.quad 0xbf0e3ec4be48250d,0xbf7b3f6dbf553f35,0x3eacbef13f18bf35,0xbe793dc93d49be48,0x3f75bf7b3f7fbf80,0x3f46bf553f62bf6d,0x3f4ebf463f3ebf35,0x3f67bf623f5cbf55
.quad 0x3f35bf803f350000,0xbf353f80bf35250d,0x3f5cbe95bedb3f6d,0xbf3e3dc93f18bf7b,0xbe953f55bf7f3f35,0x3f22bf7b3f62bec4,0xbf803f46be79bec4,0x3f4ebe95beac3f55
.quad 0xbe48bec43f55bf80,0xbf0e3f6dbf7b3f35,0x3f67bf7f3f4ebec4,0xbf5c3ef13d49bf0e,0x3f22be48be953f35,0x3ef1bf553f7fbf6d,0xbf183f62bf803f6d,0x3f67bf223e793e48
.quad 0xbf6d3f35bec4250d,0xbec43f35bf6d3f80,0x3e16bef13f3ebf6d,0xbf713f46bf043e48,0x3f7fbf7b3f62bf35,0x3e95bf0e3f46bf6d,0x3eacbdc9be163ec4,0x3f78bf623f3ebf0e
.quad 0xbf553f6dbf7b3f80,0xbe483ec4bf0e3f35,0xbf3e3f22bf043ec4,0xbf7d3f75bf673f55,0x3ef1bf0e3f22bf35,0x3dc9be483e95bec4,0x3f78bf753f71bf6d,0x3f80bf7f3f7dbf7b
.quad 0x3f35bf803f350000,0xbf353f80bf35250d,0x3f183dc9bf3e3f80,0xbedbbe953f5cbf7b,0xbf623f7bbf22250d,0x3f7fbf553e953ec4,0xbeacbe953f4ebf80,0xbe793f46bf803f55
.quad 0x3f7bbf6d3f0e0000,0xbf553ec43e48bf35,0x3d493ef1bf5c3f80,0x3f4ebf7f3f67bf0e,0xbf7f3f55bef1250d,0x3e953e48bf223f6d,0x3e79bf223f67bf80,0xbf803f62bf183e48
.quad 0x3f6dbf353ec40000,0x3ec4bf353f6dbf80,0xbf043f46bf713f80,0x3f3ebef13e163e48,0xbf463f0ebe95250d,0xbf623f7bbf7f3f6d,0x3f3ebf623f78bf80,0xbe16bdc93eacbf0e
.quad 0x3f0ebec43e480000,0x3f7bbf6d3f55bf35,0xbf673f75bf7d3f80,0xbf043f22bf3e3f55,0xbe953e48bdc9250d,0xbf223f0ebef13ec4,0x3f7dbf7f3f80bf80,0x3f71bf753f78bf7b
.quad 0x3f35bf803f350000,0xbf353f80bf35250d,0x3e793ef1bf713f6d,0xbd49bf223f7dbf55,0xbf753f0e3dc9bf35,0x3f46be48bef13f6d,0x3f3ebf7f3f5cbec4,0xbf7d3f62bedbbe48
.quad 0x3e483ec4bf553f80,0x3f0ebf6d3f7bbf35,0xbf713f22be16bec4,0x3e793e95bf3e3f7b,0x3f46bf7b3f75bf35,0xbf623f0ebdc9bec4,0x3e163e95bf2c3f6d,0x3f71bf7f3f5cbf0e
.quad 0xbf6d3f35bec4250d,0xbec43f35bf6d3f80,0x3f4ebf753f80bf6d,0xbedb3dc93e79bf0e,0x3dc93e48bef13f35,0x3f75bf553f22bec4,0xbf673f46bf183ec4,0xbf5c3f75bf803f7b
.quad 0x3f55bf6d3f7bbf80,0x3e48bec43f0ebf35,0x3d493dc9be793ec4,0x3f18bef13eacbe48,0xbf623f55bf463f35,0xbf7f3f7bbf753f6d,0x3f5cbf623f67bf6d,0x3f3ebf463f4ebf55
.quad 0x3f35bf803f350000,0xbf353f80bf35250d,0xbe163f46bf803f35,0x3eacbf623f78bf0e,0xbef1be483f46bf80,0x3dc93f0ebf753f6d,0x3f67bef1be163f35,0xbf04bdc93f2cbf7b
.quad 0xbf7b3f6dbf0e250d,0x3f55bec4be483f35,0x3f2cbf753f78bf35,0xbf7d3f46beacbe48,0xbdc93f0ebf623f80,0x3f75bf7b3f46bec4,0xbf043dc93eacbf35,0xbf3e3f75bf7d3f55
.quad 0x3f6dbf353ec40000,0x3ec4bf353f6dbf80,0xbf783f7fbf673f35,0x3d493e95bf183f55,0x3f22bf553f75bf80,0xbef13e483dc9bec4,0xbd493e95bf043f35,0x3f4ebf223edbbe48
.quad 0xbf0e3ec4be48250d,0xbf7b3f6dbf553f35,0x3f71bf623f4ebf35,0x3f78bf7f3f80bf7b,0xbf753f7bbf7f3f80,0xbf463f55bf623f6d,0x3f18bf223f2cbf35,0x3edbbef13f04bf0e
.quad 0x3f35bf803f350000,0xbf353f80bf35250d,0xbf043f75bf673ec4,0x3f2cbf7f3f4ebe48,0x3e95bf553f7fbf35,0xbf223f7bbf623ec4,0xbd493f22bf783f6d,0x3f18bf753f71bf0e
.quad 0xbe48bec43f55bf80,0xbf0e3f6dbf7b3f35,0x3edb3dc9bf183f6d,0x3f04bf623f80bf55,0xbf223e483e95bf35,0xbef13f55bf7f3f6d,0x3f4ebef13d493ec4,0x3edbbf463f78bf7b
.quad 0xbf6d3f35bec4250d,0xbec43f35bf6d3f80,0x3f7dbf623f2cbec4,0x3eacbf223f5cbf7b,0xbf7f3f7bbf623f35,0xbe953f0ebf463f6d,0x3f71bf7f3f7dbf6d,0x3e79bef13f2cbf55
.quad 0xbf553f6dbf7b3f80,0xbe483ec4bf0e3f35,0x3f2cbf463f5cbf6d,0x3e16be953edbbf0e,0xbef13f0ebf223f35,0xbdc93e48be953ec4,0x3e79be953eacbec4,0x3d49bdc93e16be48
.quad 0xbf803f80bf803f80,0xbf803f80bf803f80,0xbf7d3f7fbf803f80,0xbf713f75bf783f7b,0xbf753f7bbf7f3f80,0xbf463f55bf623f6d,0xbf673f75bf7d3f80,0xbf043f22bf3e3f55
.quad 0xbf553f6dbf7b3f80,0xbe483ec4bf0e3f35,0xbf3e3f62bf783f80,0x3e163dc9beac3f0e,0xbf223f55bf753f80,0x3ef1be48bdc93ec4,0xbf043f46bf713f80,0x3f3ebef13e163e48
.quad 0xbec43f35bf6d3f80,0x3f6dbf353ec4248d,0xbe793f22bf673f80,0x3f80bf623f18be48,0xbdc93f0ebf623f80,0x3f75bf7b3f46bec4,0x3d493ef1bf5c3f80,0x3f4ebf7f3f67bf0e
.quad 0x3e483ec4bf553f80,0x3f0ebf6d3f7bbf35,0x3eac3e95bf4e3f80,0x3e79bf463f80bf55,0x3ef13e48bf463f80,0xbdc9bf0e3f75bf6d,0x3f183dc9bf3e3f80,0xbedbbe953f5cbf7b
.quad 0xbf803f80bf803f80,0xbf803f80bf803f80,0xbf5c3f62bf673f6d,0xbf3e3f46bf4e3f55,0xbef13f0ebf223f35,0xbdc93e48be953ec4,0x3d493dc9be793ec4,0x3f18bef13eacbe48
.quad 0x3f0ebec43e48248d,0x3f7bbf6d3f55bf35,0x3f67bf463f18bec4,0x3f5cbf753f80bf7b,0x3f7fbf7b3f62bf35,0x3e95bf0e3f46bf6d,0x3f4ebf753f80bf6d,0xbedb3dc93e79bf0e
.quad 0x3ec4bf353f6dbf80,0xbf6d3f35bec4a554,0xbe16be953f2cbf6d,0xbf713f7fbf5c3f0e,0xbf223e483e95bf35,0xbef13f55bf7f3f6d,0xbf713f22be16bec4,0x3e793e95bf3e3f7b
.quad 0xbf7b3f6dbf0ea554,0x3f55bec4be483f35,0xbf3e3f7fbf5c3ec4,0x3f7dbf623edb3e48,0xbe953f55bf7f3f35,0x3f22bf7b3f62bec4,0x3e793ef1bf713f6d,0xbd49bf223f7dbf55
.quad 0xbf803f80bf803f80,0xbf803f80bf803f80,0xbf183f22bf2c3f35,0xbedb3ef1bf043f0e,0x3e95be483dc9248d,0x3f22bf0e3ef1bec4,0x3f71bf623f4ebf35,0x3f78bf7f3f80bf7b
.quad 0x3f55bf6d3f7bbf80,0x3e48bec43f0ebf35,0x3d49be953f04bf35,0xbf4e3f22bedb3e48,0xbf463f0ebe95a554,0xbf623f7bbf7f3f6d,0xbf783f7fbf673f35,0x3d493e95bf183f55
.quad 0xbec43f35bf6d3f80,0x3f6dbf353ec4248d,0x3f04bdc9beac3f35,0x3f3ebf753f7dbf55,0x3f7fbf553ef1248d,0xbe95be483f22bf6d,0x3f2cbf753f78bf35,0xbf7d3f46beacbe48
.quad 0xbe48bec43f55bf80,0xbf0e3f6dbf7b3f35,0xbf673ef13e16bf35,0x3f043dc9bf2c3f7b,0xbf623f7bbf22a554,0x3f7fbf553e953ec4,0xbe163f46bf803f35,0x3eacbf623f78bf0e
.quad 0xbf803f80bf803f80,0xbf803f80bf803f80,0xbe793e95beac3ec4,0xbd493dc9be163e48,0x3f62bf553f46bf35,0x3f7fbf7b3f75bf6d,0x3f2cbf463f5cbf6d,0x3e16be953edbbf0e
.quad 0xbf0e3ec4be48a554,0xbf7b3f6dbf553f35,0xbf713f7fbf7d3f6d,0xbe793ef1bf2c3f55,0x3dc93e48bef13f35,0x3f75bf553f22bec4,0x3f7dbf623f2cbec4,0x3eacbf223f5cbf7b
.quad 0x3ec4bf353f6dbf80,0xbf6d3f35bec4a554,0xbf4e3ef1bd49bec4,0xbedb3f46bf783f7b,0xbf463f7bbf753f35,0x3f62bf0e3dc93ec4,0x3edb3dc9bf183f6d,0x3f04bf623f80bf55
.quad 0x3f7bbf6d3f0e248d,0xbf553ec43e48bf35,0x3d49bf223f78bf6d,0xbf183f75bf713f0e,0xbf753f0e3dc9bf35,0x3f46be48bef13f6d,0xbf043f75bf673ec4,0x3f2cbf7f3f4ebe48
.quad 0xbf803f80bf803f80,0xbf803f80bf803f80,0x3e16bdc93d49248d,0x3eacbe953e79be48,0x3f75bf7b3f7fbf80,0x3f46bf553f62bf6d,0xbedb3e95be16a554,0xbf5c3f46bf2c3f0e
.quad 0xbf553f6dbf7b3f80,0xbe483ec4bf0e3f35,0x3f2cbef13e79248d,0x3f7dbf7f3f71bf55,0x3f22bf553f75bf80,0xbef13e483dc9bec4,0xbf5c3f22beaca554,0xbf2c3f62bf7d3f7b
.quad 0xbec43f35bf6d3f80,0x3f6dbf353ec4248d,0x3f78bf463edb248d,0x3d49bef13f4ebf7b,0x3dc9bf0e3f62bf80,0xbf753f7bbf463ec4,0xbf803f62bf04a554,0x3f18bdc9bedb3f55
.quad 0x3e483ec4bf553f80,0x3f0ebf6d3f7bbf35,0x3f71bf753f18248d,0xbf783f22bd49bf0e,0xbef1be483f46bf80,0x3dc93f0ebf753f6d,0xbf4e3f7fbf2ca554,0x3f67bf753f043e48
.quad 0xbf803f80bf803f80,0xbf803f80bf803f80,0x3f04bef13edbbec4,0x3f2cbf223f18bf0e,0x3ef1bf0e3f22bf35,0x3dc9be483e95bec4,0xbf803f7fbf783f6d,0xbf4e3f62bf713f7b
.quad 0x3f0ebec43e48248d,0x3f7bbf6d3f55bf35,0x3edbbf223f4ebf6d,0xbf043e95bd49be48,0xbf7f3f7bbf623f35,0xbe953f0ebf463f6d,0x3f18be95bd493ec4,0x3f67bf7f3f78bf55
.quad 0x3ec4bf353f6dbf80,0xbf6d3f35bec4a554,0xbf7d3f75bf3e3ec4,0x3eac3dc9bf043f55,0x3f22be48be953f35,0x3ef1bf553f7fbf6d,0x3eacbf463f7dbf6d,0xbf783f75bf2c3e48
.quad 0xbf7b3f6dbf0ea554,0x3f55bec4be483f35,0x3f2cbdc9bf043f6d,0xbe16bef13f67bf7b,0x3e95bf553f7fbf35,0xbf223f7bbf623ec4,0xbf783f62beacbec4,0x3f80bf463e163f0e
.quad 0xbf803f80bf803f80,0xbf803f80bf803f80,0x3f4ebf463f3ebf35,0x3f67bf623f5cbf55,0xbe953e48bdc9a554,0xbf223f0ebef13ec4,0xbeac3ef1bf183f35,0x3e79bdc9bd493e48
.quad 0x3f55bf6d3f7bbf80,0x3e48bec43f0ebf35,0xbf803f75bf5c3f35,0xbf183f46bf673f7b,0x3f46bf0e3e95248d,0x3f62bf7b3f7fbf6d,0xbe79bdc93edbbf35,0xbf803f75bf4e3f0e
.quad 0xbec43f35bf6d3f80,0x3f6dbf353ec4248d,0x3f5cbf7f3f71bf35,0xbf2c3e953e16bf0e,0xbf7f3f55bef1a554,0x3e953e48bf223f6d,0x3f3ebe95be793f35,0x3e16bf223f71bf7b
.quad 0xbe48bec43f55bf80,0xbf0e3f6dbf7b3f35,0xbedb3f62bf7d3f35,0x3f5cbf7f3f3ebe48,0x3f62bf7b3f22248d,0xbf7f3f55be95bec4,0xbf7d3f223d49bf35,0x3f71bef1be793f55
.quad 0xbf803f80bf803f80,0xbf803f80bf803f80,0x3f78bf753f71bf6d,0x3f80bf7f3f7dbf7b,0xbf623f55bf463f35,0xbf7f3f7bbf753f6d,0x3f3ebf223f04bec4,0x3f7dbf753f67bf55
.quad 0xbf0e3ec4be48a554,0xbf7b3f6dbf553f35,0x3eacbdc9be163ec4,0x3f78bf623f3ebf0e,0xbdc9be483ef1bf35,0xbf753f55bf223ec4,0xbe163ef1bf3e3f6d,0x3f71bf463f04be48
.quad 0x3ec4bf353f6dbf80,0xbf6d3f35bec4a554,0xbf183f62bf803f6d,0x3f67bf223e793e48,0x3f46bf7b3f75bf35,0xbf623f0ebdc9bec4,0xbf673f7fbf4e3ec4,0x3f5cbef1bd493f0e
.quad 0x3f7bbf6d3f0e248d,0xbf553ec43e48bf35,0xbf803f46be79bec4,0x3f4ebe95beac3f55,0x3f75bf0ebdc93f35,0xbf463e483ef1bf6d,0xbf5c3e953edbbf6d,0x3f3ebdc9bf183f7b
.quad 0x250d0000250d3f80,0x250d0000250d0000,0xbe163dc9bd49bf80,0xbeac3e95be793e48,0xbe953e48bdc93f80,0xbf223f0ebef13ec4,0xbedb3e95be16bf80,0xbf5c3f46bf2c3f0e
.quad 0xbf0e3ec4be483f80,0xbf7b3f6dbf553f35,0xbf2c3ef1be79bf80,0xbf7d3f7fbf713f55,0xbf463f0ebe953f80,0xbf623f7bbf7f3f6d,0xbf5c3f22beacbf80,0xbf2c3f62bf7d3f7b
.quad 0xbf6d3f35bec43f80,0xbec43f35bf6d3f80,0xbf783f46bedbbf80,0xbd493ef1bf4e3f7b,0xbf7f3f55bef13f80,0x3e953e48bf223f6d,0xbf803f62bf04bf80,0x3f18bdc9bedb3f55
.quad 0xbf7b3f6dbf0e3f80,0x3f55bec4be483f35,0xbf713f75bf18bf80,0x3f78bf223d493f0e,0xbf623f7bbf223f80,0x3f7fbf553e953ec4,0xbf4e3f7fbf2cbf80,0x3f67bf753f043e48
.quad 0x250d0000250d0000,0x250d0000250d0000,0xbf043ef1bedb3ec4,0xbf2c3f22bf183f0e,0xbf623f55bf463f35,0xbf7f3f7bbf753f6d,0xbf803f7fbf783f6d,0xbf4e3f62bf713f7b
.quad 0xbf553f6dbf7b3f80,0xbe483ec4bf0e3f35,0xbedb3f22bf4e3f6d,0x3f04be953d493e48,0x3dc93e48bef13f35,0x3f75bf553f22bec4,0x3f18be95bd493ec4,0x3f67bf7f3f78bf55
.quad 0x3f6dbf353ec4250d,0x3ec4bf353f6dbf80,0x3f7dbf753f3ebec4,0xbeacbdc93f04bf55,0x3f46bf7b3f75bf35,0xbf623f0ebdc9bec4,0x3eacbf463f7dbf6d,0xbf783f75bf2c3e48
.quad 0xbe48bec43f55bf80,0xbf0e3f6dbf7b3f35,0xbf2c3dc93f04bf6d,0x3e163ef1bf673f7b,0xbf753f0e3dc9bf35,0x3f46be48bef13f6d,0xbf783f62beacbec4,0x3f80bf463e163f0e
.quad 0x250d0000250d0000,0x250d0000250d0000,0xbf4e3f46bf3e3f35,0xbf673f62bf5c3f55,0xbf753f7bbf7f3f80,0xbf463f55bf623f6d,0xbeac3ef1bf183f35,0x3e79bdc9bd493e48
.quad 0x3f0ebec43e48250d,0x3f7bbf6d3f55bf35,0x3f80bf753f5cbf35,0x3f18bf463f67bf7b,0x3f22bf553f75bf80,0xbef13e483dc9bec4,0xbe79bdc93edbbf35,0xbf803f75bf4e3f0e
.quad 0xbf6d3f35bec40000,0xbec43f35bf6d3f80,0xbf5c3f7fbf713f35,0x3f2cbe95be163f0e,0xbdc93f0ebf623f80,0x3f75bf7b3f46bec4,0x3f3ebe95be793f35,0x3e16bf223f71bf7b
.quad 0x3f7bbf6d3f0e250d,0xbf553ec43e48bf35,0x3edbbf623f7dbf35,0xbf5c3f7fbf3e3e48,0xbef1be483f46bf80,0x3dc93f0ebf753f6d,0xbf7d3f223d49bf35,0x3f71bef1be793f55
.quad 0x250d0000250d0000,0x250d0000250d0000,0xbf783f75bf713f6d,0xbf803f7fbf7d3f7b,0xbef13f0ebf223f35,0xbdc93e48be953ec4,0x3f3ebf223f04bec4,0x3f7dbf753f67bf55
.quad 0x3f55bf6d3f7bbf80,0x3e48bec43f0ebf35,0xbeac3dc93e16bec4,0xbf783f62bf3e3f0e,0xbf7f3f7bbf623f35,0xbe953f0ebf463f6d,0xbe163ef1bf3e3f6d,0x3f71bf463f04be48
.quad 0x3f6dbf353ec4250d,0x3ec4bf353f6dbf80,0x3f18bf623f80bf6d,0xbf673f22be79be48,0xbf223e483e95bf35,0xbef13f55bf7f3f6d,0xbf673f7fbf4e3ec4,0x3f5cbef1bd493f0e
.quad 0x3e483ec4bf553f80,0x3f0ebf6d3f7bbf35,0x3f80bf463e793ec4,0xbf4e3e953eacbf55,0x3e95bf553f7fbf35,0xbf223f7bbf623ec4,0xbf5c3e953edbbf6d,0x3f3ebdc9bf183f7b
.quad 0x250d0000250d0000,0x250d0000250d0000,0xbf7d3f7fbf803f80,0xbf713f75bf783f7b,0x3e95be483dc9250d,0x3f22bf0e3ef1bec4,0x3f67bf753f7dbf80,0x3f04bf223f3ebf55
.quad 0xbf0e3ec4be480000,0xbf7b3f6dbf553f35,0xbf3e3f62bf783f80,0x3e163dc9beac3f0e,0x3f46bf0e3e95250d,0x3f62bf7b3f7fbf6d,0x3f04bf463f71bf80,0xbf3e3ef1be16be48
.quad 0xbf6d3f35bec40000,0xbec43f35bf6d3f80,0xbe793f22bf673f80,0x3f80bf623f18be48,0x3f7fbf553ef1250d,0xbe95be483f22bf6d,0xbd49bef13f5cbf80,0xbf4e3f7fbf673f0e
.quad 0xbf7b3f6dbf0e0000,0x3f55bec4be483f35,0x3eac3e95bf4e3f80,0x3e79bf463f80bf55,0x3f62bf7b3f22250d,0xbf7f3f55be95bec4,0xbf18bdc93f3ebf80,0x3edb3e95bf5c3f7b
.quad 0x250d0000250d0000,0x250d0000250d0000,0xbf5c3f62bf673f6d,0xbf3e3f46bf4e3f55,0x3f62bf553f46bf35,0x3f7fbf7b3f75bf6d,0xbd49bdc93e79bec4,0xbf183ef1beac3e48
.quad 0xbf553f6dbf7b3f80,0xbe483ec4bf0e3f35,0x3f67bf463f18bec4,0x3f5cbf753f80bf7b,0xbdc9be483ef1bf35,0xbf753f55bf223ec4,0xbf4e3f75bf803f6d,0x3edbbdc9be793f0e
.quad 0x3f6dbf353ec4250d,0x3ec4bf353f6dbf80,0xbe16be953f2cbf6d,0xbf713f7fbf5c3f0e,0xbf463f7bbf753f35,0x3f62bf0e3dc93ec4,0x3f71bf223e163ec4,0xbe79be953f3ebf7b
.quad 0xbe48bec43f55bf80,0xbf0e3f6dbf7b3f35,0xbf3e3f7fbf5c3ec4,0x3f7dbf623edb3e48,0x3f75bf0ebdc93f35,0xbf463e483ef1bf6d,0xbe79bef13f71bf6d,0x3d493f22bf7d3f55
.quad 0x250d0000250d0000,0x250d0000250d0000,0xbf183f22bf2c3f35,0xbedb3ef1bf043f0e,0x3f75bf7b3f7fbf80,0x3f46bf553f62bf6d,0xbf713f62bf4e3f35,0xbf783f7fbf803f7b
.quad 0x3f0ebec43e48250d,0x3f7bbf6d3f55bf35,0x3d49be953f04bf35,0xbf4e3f22bedb3e48,0xbf223f55bf753f80,0x3ef1be48bdc93ec4,0x3f78bf7f3f67bf35,0xbd49be953f18bf55
.quad 0xbf6d3f35bec40000,0xbec43f35bf6d3f80,0x3f04bdc9beac3f35,0x3f3ebf753f7dbf55,0x3dc9bf0e3f62bf80,0xbf753f7bbf463ec4,0xbf2c3f75bf783f35,0x3f7dbf463eac3e48
.quad 0x3f7bbf6d3f0e250d,0xbf553ec43e48bf35,0xbf673ef13e16bf35,0x3f043dc9bf2c3f7b,0x3ef13e48bf463f80,0xbdc9bf0e3f75bf6d,0x3e16bf463f80bf35,0xbeac3f62bf783f0e
.quad 0x250d0000250d0000,0x250d0000250d0000,0xbe793e95beac3ec4,0xbd493dc9be163e48,0x3ef1bf0e3f22bf35,0x3dc9be483e95bec4,0xbf2c3f46bf5c3f6d,0xbe163e95bedb3f0e
.quad 0x3f55bf6d3f7bbf80,0x3e48bec43f0ebf35,0xbf713f7fbf7d3f6d,0xbe793ef1bf2c3f55,0x3f7fbf7b3f62bf35,0x3e95bf0e3f46bf6d,0xbf7d3f62bf2c3ec4,0xbeac3f22bf5c3f7b
.quad 0x3f6dbf353ec4250d,0x3ec4bf353f6dbf80,0xbf4e3ef1bd49bec4,0xbedb3f46bf783f7b,0x3f22be48be953f35,0x3ef1bf553f7fbf6d,0xbedbbdc93f18bf6d,0xbf043f62bf803f55
.quad 0x3e483ec4bf553f80,0x3f0ebf6d3f7bbf35,0x3d49bf223f78bf6d,0xbf183f75bf713f0e,0xbe953f55bf7f3f35,0x3f22bf7b3f62bec4,0x3f04bf753f67bec4,0xbf2c3f7fbf4e3e48
.quad 0x3f35248dbf353f80,0xbf35a5543f35bf80,0x3f4ebdc9bf2c3f80,0xbf673e953f04bf7b,0x3f62be48bf223f80,0xbf7f3f0e3e95bf6d,0x3f71be95bf183f80,0xbf783f463d49bf55
.quad 0x3f7bbec4bf0e3f80,0xbf553f6dbe48bf35,0x3f80bef1bf043f80,0xbf183f7fbedbbf0e,0x3f7fbf0ebef13f80,0xbe953f7bbf22bec4,0x3f78bf22bedb3f80,0x3d493f62bf4ebe48
.quad 0x3f6dbf35bec43f80,0x3ec43f35bf6da554,0x3f5cbf46beac3f80,0x3f2c3ef1bf7d3e48,0x3f46bf55be953f80,0x3f623e48bf7f3ec4,0x3f2cbf62be793f80,0x3f7dbdc9bf713f0e
.quad 0x3f0ebf6dbe483f80,0x3f7bbec4bf553f35,0x3edbbf75be163f80,0x3f5cbf22bf2c3f55,0x3e95bf7bbdc93f80,0x3f22bf55bef13f6d,0x3e16bf7fbd493f80,0x3eacbf75be793f7b
.quad 0x3f35248dbf353f80,0xbf35a5543f35bf80,0x3f78bef1beac3f6d,0xbf803f223e16bf55,0x3f75bf553dc93f35,0xbf463f7bbef1bec4,0x3f2cbf7f3f043ec4,0xbe163f62bf673e48
.quad 0x3e48bf6d3f55248d,0x3f0e3ec4bf7b3f35,0xbeacbf223f7dbec4,0x3f78be95bf2c3f7b,0xbf46be483f75bf35,0x3f62bf55bdc93f6d,0xbf7d3e953f3ebf6d,0x3eacbf7f3f043f0e
.quad 0xbf6d3f353ec4bf80,0xbec4bf353f6d248d,0xbf183f75bd49bf6d,0xbf67bdc93f78bf0e,0xbdc93f7bbef1bf35,0xbf753f0e3f22bf6d,0x3edb3f46bf4ebec4,0xbf043f753d49bf7b
.quad 0x3f553ec4bf7ba554,0x3e483f6dbf0ebf35,0x3f80bdc9bf783ec4,0x3f4e3ef1bf71be48,0x3f62bf0ebf463f35,0x3f7fbe48bf753ec4,0x3f04bf62bedb3f6d,0x3f2cbf46bf183f55
.quad 0x3f35248dbf353f80,0xbf35a5543f35bf80,0x3f7dbf463d493f35,0xbf713f62be79bf0e,0x3ef1bf7b3f46248d,0xbdc93f55bf753ec4,0xbedbbef13f7dbf35,0x3f5cbdc9bf3e3f7b
.quad 0xbf7b3ec43f0ebf80,0x3f55bf6d3e483f35,0xbf3e3f75be79bf35,0xbe16bf463f71be48,0x3dc93f55bf62a554,0xbf753e483f46bf6d,0x3f5c3dc9bf713f35,0xbf2c3f75be16bf55
.quad 0x3f6dbf35bec43f80,0x3ec43f35bf6da554,0x3e79bf7f3edb3f35,0x3f80be95bf4e3f55,0xbf22bf0e3f75248d,0x3ef1bf7b3dc93f6d,0xbf803e953f5cbf35,0xbf18bf223f673e48
.quad 0xbf0e3f6d3e48bf80,0xbf7b3ec43f55bf35,0x3eac3f62bf18bf35,0xbe793f7fbd49bf7b,0x3f753e48bf7fa554,0x3f463f0ebf62bec4,0x3f4ebf22bf3e3f35,0x3f67bef1bf5c3f0e
.quad 0x3f35248dbf353f80,0xbf35a5543f35bf80,0x3f5cbf753edb3ec4,0xbf3e3f7fbf18be48,0xbe95bf0e3f7fbf35,0x3f223e48bf623f6d,0xbf803f223e79bf6d,0x3f4ebf753eac3f0e
.quad 0xbe483f6dbf55a554,0xbf0ebec43f7bbf35,0x3f67bdc9bf4e3f6d,0xbf5c3f62bd49bf55,0x3f22bf7b3e953f35,0x3ef13f0ebf7f3ec4,0xbf18bef13f80bec4,0x3f67bf46be793f7b
.quad 0xbf6d3f353ec4bf80,0xbec4bf353f6d248d,0x3e163f62bf3ebec4,0xbf713f223f04bf7b,0x3f7fbe48bf623f35,0x3e953f55bf46bec4,0x3eacbf7f3e163f6d,0x3f78bef1bf3e3f55
.quad 0xbf55bec43f7b248d,0xbe48bf6d3f0e3f35,0xbf3e3f463f04bf6d,0xbf7d3e953f67bf0e,0x3ef13f55bf22bf35,0x3dc93f7bbe95bf6d,0x3f78be95bf713ec4,0x3f80bdc9bf7d3e48
.quad 0x3f35248dbf353f80,0xbf35a5543f35bf80,0x3f18bf7f3f3e248d,0xbedb3f75bf5c3e48,0xbf623e483f22bf80,0x3f7fbf0ebe953f6d,0xbeac3f75bf4ea554,0xbe79bf223f80bf0e
.quad 0x3f7bbec4bf0e3f80,0xbf553f6dbe48bf35,0x3d49bf623f5c248d,0x3f4e3dc9bf673f55,0xbf7f3f0e3ef1bf80,0x3e95bf7b3f223ec4,0x3e793f46bf67a554,0xbf803ef13f18bf7b
.quad 0x3f6dbf35bec43f80,0x3ec43f35bf6da554,0xbf04bf223f71248d,0x3f3ebf62be163f7b,0xbf463f553e95bf80,0xbf62be483f7fbec4,0x3f3e3ef1bf78a554,0xbe163f7fbeacbf55
.quad 0x3f0ebf6dbe483f80,0x3f7bbec4bf553f35,0xbf67be953f7d248d,0xbf04bf463f3e3f0e,0xbe953f7b3dc9bf80,0xbf223f553ef1bf6d,0x3f7d3dc9bf80a554,0x3f713e95bf78be48
.quad 0x3f35248dbf353f80,0xbf35a5543f35bf80,0x3e79bf623f71bec4,0xbd493f46bf7d3f0e,0xbf753f55bdc9bf35,0x3f46bf7b3ef13ec4,0x3f3e3dc9bf5c3f6d,0xbf7d3ef13edbbf7b
.quad 0x3e48bf6d3f55248d,0x3f0e3ec4bf7b3f35,0xbf713f463e16bf6d,0x3e79bf753f3e3e48,0x3f463e48bf753f35,0xbf623f553dc9bf6d,0x3e16bf753f2c3ec4,0x3f71bdc9bf5c3f55
.quad 0xbf6d3f353ec4bf80,0xbec4bf353f6d248d,0x3f4e3e95bf803ec4,0xbedb3f7fbe79bf55,0x3dc9bf7b3ef13f35,0x3f75bf0ebf223f6d,0xbf673f223f18bf6d,0xbf5cbe953f80be48
.quad 0x3f553ec4bf7ba554,0x3e483f6dbf0ebf35,0x3d49bf7f3e793f6d,0x3f18bf62beac3f7b,0xbf623f0e3f46bf35,0xbf7f3e483f75bec4,0x3f5c3ef1bf67bec4,0x3f3e3f22bf4ebf0e
.quad 0x3f35248dbf353f80,0xbf35a5543f35bf80,0xbe16bf223f80bf35,0x3eac3ef1bf783f55,0xbef13f7bbf46a554,0x3dc9bf553f75bec4,0x3f67bf623e163f35,0xbf043f7fbf2cbe48
.quad 0xbf7b3ec43f0ebf80,0x3f55bf6d3e483f35,0x3f2c3e95bf783f35,0xbf7d3f223eacbf7b,0xbdc9bf553f62248d,0x3f75be48bf463f6d,0xbf043f7fbeacbf35,0xbf3ebe953f7dbf0e
.quad 0x3f6dbf35bec43f80,0x3ec43f35bf6da554,0xbf783dc93f67bf35,0x3d49bf753f183f0e,0x3f223f0ebf75a554,0xbef13f7bbdc9bf6d,0xbd49bf753f043f35,0x3f4ebf46bedb3f7b
.quad 0xbf0e3f6d3e48bf80,0xbf7b3ec43f55bf35,0x3f71bef1bf4e3f35,0x3f783dc9bf803e48,0xbf75be483f7f248d,0xbf46bf0e3f623ec4,0x3f183f46bf2cbf35,0x3edb3f62bf04bf55
.quad 0x3f35248dbf353f80,0xbf35a5543f35bf80,0xbf04be953f67bf6d,0x3f2c3dc9bf4e3f7b,0x3e953f0ebf7f3f35,0xbf22be483f62bf6d,0xbd49bf463f78bec4,0x3f183e95bf713f55
.quad 0xbe483f6dbf55a554,0xbf0ebec43f7bbf35,0x3edbbf7f3f183ec4,0x3f043ef1bf803f0e,0xbf223f7bbe95bf35,0xbef1bf0e3f7fbec4,0x3f4ebf62bd493f6d,0x3edb3f22bf783e48
.quad 0xbf6d3f353ec4bf80,0xbec4bf353f6d248d,0x3f7dbef1bf2c3f6d,0x3eac3f46bf5cbe48,0xbf7f3e483f62bf35,0xbe95bf553f463ec4,0x3f713dc9bf7d3ec4,0x3e793f62bf2cbf0e
.quad 0xbf55bec43f7b248d,0xbe48bf6d3f0e3f35,0x3f2c3f22bf5cbec4,0x3e163f75bedbbf55,0xbef1bf553f223f35,0xbdc9bf7b3e953f6d,0x3e793f75beacbf6d,0x3d493f7fbe16bf7b
.quad 0xbf353f80bf353f80,0x3f35bf803f35250d,0xbf183f7fbf3ebf80,0x3edbbf753f5cbe48,0xbef13f7bbf463f80,0x3dc9bf553f75bec4,0xbeac3f75bf4ebf80,0xbe79bf223f80bf0e
.quad 0xbe483f6dbf553f80,0xbf0ebec43f7bbf35,0xbd493f62bf5cbf80,0xbf4ebdc93f67bf55,0x3dc93f55bf623f80,0xbf753e483f46bf6d,0x3e793f46bf67bf80,0xbf803ef13f18bf7b
.quad 0x3ec43f35bf6d3f80,0xbf6d3f353ec4bf80,0x3f043f22bf71bf80,0xbf3e3f623e16bf7b,0x3f223f0ebf753f80,0xbef13f7bbdc9bf6d,0x3f3e3ef1bf78bf80,0xbe163f7fbeacbf55
.quad 0x3f553ec4bf7b3f80,0x3e483f6dbf0ebf35,0x3f673e95bf7dbf80,0x3f043f46bf3ebf0e,0x3f753e48bf7f3f80,0x3f463f0ebf62bec4,0x3f7d3dc9bf80bf80,0x3f713e95bf78be48
.quad 0xbf353f80bf350000,0x3f35bf803f35250d,0xbe793f62bf713ec4,0x3d49bf463f7dbf0e,0x3e953f0ebf7f3f35,0xbf22be483f62bf6d,0x3f3e3dc9bf5c3f6d,0xbf7d3ef13edbbf7b
.quad 0x3f7bbec4bf0e3f80,0xbf553f6dbe48bf35,0x3f71bf46be163f6d,0xbe793f75bf3ebe48,0x3f22bf7b3e953f35,0x3ef13f0ebf7f3ec4,0x3e16bf753f2c3ec4,0x3f71bdc9bf5c3f55
.quad 0xbec4bf353f6d250d,0x3f6dbf35bec43f80,0xbf4ebe953f80bec4,0x3edbbf7f3e793f55,0xbf7f3e483f62bf35,0xbe95bf553f463ec4,0xbf673f223f18bf6d,0xbf5cbe953f80be48
.quad 0xbf0e3f6d3e48bf80,0xbf7b3ec43f55bf35,0xbd493f7fbe79bf6d,0xbf183f623eacbf7b,0x3ef13f55bf22bf35,0x3dc93f7bbe95bf6d,0x3f5c3ef1bf67bec4,0x3f3e3f22bf4ebf0e
.quad 0xbf353f80bf350000,0x3f35bf803f35250d,0x3e163f22bf803f35,0xbeacbef13f78bf55,0x3f62be48bf223f80,0xbf7f3f0e3e95bf6d,0x3f67bf623e163f35,0xbf043f7fbf2cbe48
.quad 0x3e48bf6d3f55250d,0x3f0e3ec4bf7b3f35,0xbf2cbe953f78bf35,0x3f7dbf22beac3f7b,0xbf7f3f0e3ef1bf80,0x3e95bf7b3f223ec4,0xbf043f7fbeacbf35,0xbf3ebe953f7dbf0e
.quad 0x3ec43f35bf6d0000,0xbf6d3f353ec4bf80,0x3f78bdc9bf673f35,0xbd493f75bf18bf0e,0x3f46bf55be953f80,0x3f623e48bf7f3ec4,0xbd49bf753f043f35,0x3f4ebf46bedb3f7b
.quad 0xbf55bec43f7b250d,0xbe48bf6d3f0e3f35,0xbf713ef13f4ebf35,0xbf78bdc93f80be48,0xbe953f7b3dc9bf80,0xbf223f553ef1bf6d,0x3f183f46bf2cbf35,0x3edb3f62bf04bf55
.quad 0xbf353f80bf350000,0x3f35bf803f35250d,0x3f043e95bf673f6d,0xbf2cbdc93f4ebf7b,0x3f75bf553dc93f35,0xbf463f7bbef1bec4,0xbd49bf463f78bec4,0x3f183e95bf713f55
.quad 0xbf7b3ec43f0ebf80,0x3f55bf6d3e483f35,0xbedb3f7fbf18bec4,0xbf04bef13f80bf0e,0x3f463e48bf753f35,0xbf623f553dc9bf6d,0x3f4ebf62bd493f6d,0x3edb3f22bf783e48
.quad 0xbec4bf353f6d250d,0x3f6dbf35bec43f80,0xbf7d3ef13f2cbf6d,0xbeacbf463f5c3e48,0xbdc93f7bbef1bf35,0xbf753f0e3f22bf6d,0x3f713dc9bf7d3ec4,0x3e793f62bf2cbf0e
.quad 0x3f0ebf6dbe483f80,0x3f7bbec4bf553f35,0xbf2cbf223f5c3ec4,0xbe16bf753edb3f55,0xbf623f0e3f46bf35,0xbf7f3e483f75bec4,0x3e793f75beacbf6d,0x3d493f7fbe16bf7b
.quad 0xbf353f80bf350000,0x3f35bf803f35250d,0x3f4ebdc9bf2c3f80,0xbf673e953f04bf7b,0x3ef1bf7b3f46250d,0xbdc93f55bf753ec4,0xbf713e953f18bf80,0x3f78bf46bd493f55
.quad 0xbe483f6dbf550000,0xbf0ebec43f7bbf35,0x3f80bef1bf043f80,0xbf183f7fbedbbf0e,0xbdc9bf553f62250d,0x3f75be48bf463f6d,0xbf783f223edbbf80,0xbd49bf623f4e3e48
.quad 0x3ec43f35bf6d0000,0xbf6d3f353ec4bf80,0x3f5cbf46beac3f80,0x3f2c3ef1bf7d3e48,0xbf22bf0e3f75250d,0x3ef1bf7b3dc93f6d,0xbf2c3f623e79bf80,0xbf7d3dc93f71bf0e
.quad 0x3f553ec4bf7b0000,0x3e483f6dbf0ebf35,0x3edbbf75be163f80,0x3f5cbf22bf2c3f55,0xbf75be483f7f250d,0xbf46bf0e3f623ec4,0xbe163f7f3d49bf80,0xbeac3f753e79bf7b
.quad 0xbf353f80bf350000,0x3f35bf803f35250d,0x3f78bef1beac3f6d,0xbf803f223e16bf55,0xbe95bf0e3f7fbf35,0x3f223e48bf623f6d,0xbf2c3f7fbf04bec4,0x3e16bf623f67be48
.quad 0x3f7bbec4bf0e3f80,0xbf553f6dbe48bf35,0xbeacbf223f7dbec4,0x3f78be95bf2c3f7b,0xbf223f7bbe95bf35,0xbef1bf0e3f7fbec4,0x3f7dbe95bf3e3f6d,0xbeac3f7fbf04bf0e
.quad 0xbec4bf353f6d250d,0x3f6dbf35bec43f80,0xbf183f75bd49bf6d,0xbf67bdc93f78bf0e,0x3f7fbe48bf623f35,0x3e953f55bf46bec4,0xbedbbf463f4e3ec4,0x3f04bf75bd493f7b
.quad 0xbf0e3f6d3e48bf80,0xbf7b3ec43f55bf35,0x3f80bdc9bf783ec4,0x3f4e3ef1bf71be48,0xbef1bf553f223f35,0xbdc9bf7b3e953f6d,0xbf043f623edbbf6d,0xbf2c3f463f18bf55
.quad 0xbf353f80bf350000,0x3f35bf803f35250d,0x3f7dbf463d493f35,0xbf713f62be79bf0e,0xbf623e483f22bf80,0x3f7fbf0ebe953f6d,0x3edb3ef1bf7d3f35,0xbf5c3dc93f3ebf7b
.quad 0x3e48bf6d3f55250d,0x3f0e3ec4bf7b3f35,0xbf3e3f75be79bf35,0xbe16bf463f71be48,0x3f7fbf0ebef13f80,0xbe953f7bbf22bec4,0xbf5cbdc93f71bf35,0x3f2cbf753e163f55
.quad 0x3ec43f35bf6d0000,0xbf6d3f353ec4bf80,0x3e79bf7f3edb3f35,0x3f80be95bf4e3f55,0xbf463f553e95bf80,0xbf62be483f7fbec4,0x3f80be95bf5c3f35,0x3f183f22bf67be48
.quad 0xbf55bec43f7b250d,0xbe48bf6d3f0e3f35,0x3eac3f62bf18bf35,0xbe793f7fbd49bf7b,0x3e95bf7bbdc93f80,0x3f22bf55bef13f6d,0xbf4e3f223f3ebf35,0xbf673ef13f5cbf0e
.quad 0xbf353f80bf350000,0x3f35bf803f35250d,0x3f5cbf753edb3ec4,0xbf3e3f7fbf18be48,0xbf753f55bdc9bf35,0x3f46bf7b3ef13ec4,0x3f80bf22be793f6d,0xbf4e3f75beacbf0e
.quad 0xbf7b3ec43f0ebf80,0x3f55bf6d3e483f35,0x3f67bdc9bf4e3f6d,0xbf5c3f62bd49bf55,0xbf46be483f75bf35,0x3f62bf55bdc93f6d,0x3f183ef1bf803ec4,0xbf673f463e79bf7b
.quad 0xbec4bf353f6d250d,0x3f6dbf35bec43f80,0x3e163f62bf3ebec4,0xbf713f223f04bf7b,0x3dc9bf7b3ef13f35,0x3f75bf0ebf223f6d,0xbeac3f7fbe16bf6d,0xbf783ef13f3ebf55
.quad 0x3f0ebf6dbe483f80,0x3f7bbec4bf553f35,0xbf3e3f463f04bf6d,0xbf7d3e953f67bf0e,0x3f62bf0ebf463f35,0x3f7fbe48bf753ec4,0xbf783e953f71bec4,0xbf803dc93f7dbe48
.quad 0x248dbf80a5543f80,0x248dbf80a5543f80,0xbe16bf7f3d493f80,0xbeacbf753e793f7b,0xbe95bf7b3dc93f80,0xbf22bf553ef13f6d,0xbedbbf753e163f80,0xbf5cbf223f2c3f55
.quad 0xbf0ebf6d3e483f80,0xbf7bbec43f553f35,0xbf2cbf623e793f80,0xbf7dbdc93f713f0e,0xbf46bf553e953f80,0xbf623e483f7f3ec4,0xbf5cbf463eac3f80,0xbf2c3ef13f7d3e48
.quad 0xbf6dbf353ec43f80,0xbec43f353f6d248d,0xbf78bf223edb3f80,0xbd493f623f4ebe48,0xbf7fbf0e3ef13f80,0x3e953f7b3f22bec4,0xbf80bef13f043f80,0x3f183f7f3edbbf0e
.quad 0xbf7bbec43f0e3f80,0x3f553f6d3e48bf35,0xbf71be953f183f80,0x3f783f46bd49bf55,0xbf62be483f223f80,0x3f7f3f0ebe95bf6d,0xbf4ebdc93f2c3f80,0x3f673e95bf04bf7b
.quad 0x248dbf80a5543f80,0x248dbf80a5543f80,0xbf04bf623edb3f6d,0xbf2cbf463f183f55,0xbf62bf0e3f463f35,0xbf7fbe483f753ec4,0xbf80bdc93f783ec4,0xbf4e3ef13f71be48
.quad 0xbf553ec43f7b248d,0xbe483f6d3f0ebf35,0xbedb3f463f4ebec4,0x3f043f75bd49bf7b,0x3dc93f7b3ef1bf35,0x3f753f0ebf22bf6d,0x3f183f753d49bf6d,0x3f67bdc9bf78bf0e
.quad 0x3f6d3f35bec4bf80,0x3ec4bf35bf6da554,0x3f7d3e95bf3ebf6d,0xbeacbf7fbf043f0e,0x3f46be48bf75bf35,0xbf62bf553dc93f6d,0x3eacbf22bf7dbec4,0xbf78be953f2c3f7b
.quad 0xbe48bf6dbf55a554,0xbf0e3ec43f7b3f35,0xbf2cbf7fbf043ec4,0x3e163f623f673e48,0xbf75bf55bdc93f35,0x3f463f7b3ef1bec4,0xbf78bef13eac3f6d,0x3f803f22be16bf55
.quad 0x248dbf80a5543f80,0x248dbf80a5543f80,0xbf4ebf223f3e3f35,0xbf67bef13f5c3f0e,0xbf753e483f7f248d,0xbf463f0e3f62bec4,0xbeac3f623f18bf35,0x3e793f7f3d49bf7b
.quad 0x3f0e3f6dbe48bf80,0x3f7b3ec4bf55bf35,0x3f803e95bf5cbf35,0x3f18bf22bf673e48,0x3f22bf0ebf75a554,0xbef1bf7bbdc93f6d,0xbe79bf7fbedb3f35,0xbf80be953f4e3f55
.quad 0xbf6dbf353ec43f80,0xbec43f353f6d248d,0xbf5c3dc93f713f35,0x3f2c3f753e16bf55,0xbdc93f553f62248d,0x3f753e48bf46bf6d,0x3f3e3f753e79bf35,0x3e16bf46bf71be48
.quad 0x3f7b3ec4bf0ebf80,0xbf55bf6dbe483f35,0x3edbbef1bf7dbf35,0xbf5cbdc93f3e3f7b,0xbef1bf7bbf46a554,0x3dc93f553f753ec4,0xbf7dbf46bd493f35,0x3f713f623e79bf0e
.quad 0x248dbf80a5543f80,0x248dbf80a5543f80,0xbf78be953f713ec4,0xbf80bdc93f7d3e48,0xbef13f553f22bf35,0xbdc93f7b3e95bf6d,0x3f3e3f46bf04bf6d,0x3f7d3e95bf67bf0e
.quad 0x3f55bec4bf7ba554,0x3e48bf6dbf0e3f35,0xbeacbf7fbe163f6d,0xbf78bef13f3e3f55,0xbf7fbe483f623f35,0xbe953f553f46bec4,0xbe163f623f3ebec4,0x3f713f22bf04bf7b
.quad 0x3f6d3f35bec4bf80,0x3ec4bf35bf6da554,0x3f18bef1bf80bec4,0xbf67bf463e793f7b,0xbf22bf7bbe953f35,0xbef13f0e3f7f3ec4,0xbf67bdc93f4e3f6d,0x3f5c3f623d49bf55
.quad 0x3e483f6d3f55248d,0x3f0ebec4bf7bbf35,0x3f803f22be79bf6d,0xbf4ebf75beac3f0e,0x3e95bf0ebf7fbf35,0xbf223e483f623f6d,0xbf5cbf75bedb3ec4,0x3f3e3f7f3f18be48
.quad 0x248dbf80a5543f80,0x248dbf80a5543f80,0xbf7d3dc93f80248d,0xbf713e953f78be48,0x3e953f7bbdc9bf80,0x3f223f55bef1bf6d,0x3f67be95bf7da554,0x3f04bf46bf3e3f0e
.quad 0xbf0ebf6d3e483f80,0xbf7bbec43f553f35,0xbf3e3ef13f78248d,0x3e163f7f3eacbf55,0x3f463f55be95bf80,0x3f62be48bf7fbec4,0x3f04bf22bf71a554,0xbf3ebf623e163f7b
.quad 0xbf6dbf353ec43f80,0xbec43f353f6d248d,0xbe793f463f67248d,0x3f803ef1bf18bf7b,0x3f7f3f0ebef1bf80,0xbe95bf7bbf223ec4,0xbd49bf62bf5ca554,0xbf4e3dc93f673f55
.quad 0xbf7bbec43f0e3f80,0x3f553f6d3e48bf35,0x3eac3f753f4e248d,0x3e79bf22bf80bf0e,0x3f623e48bf22bf80,0xbf7fbf0e3e953f6d,0xbf18bf7fbf3ea554,0x3edb3f753f5c3e48
.quad 0x248dbf80a5543f80,0x248dbf80a5543f80,0xbf5c3ef13f67bec4,0xbf3e3f223f4ebf0e,0x3f623f0ebf46bf35,0x3f7f3e48bf75bec4,0xbd49bf7fbe793f6d,0xbf18bf623eac3f7b
.quad 0xbf553ec43f7b248d,0xbe483f6d3f0ebf35,0x3f673f22bf18bf6d,0x3f5cbe95bf80be48,0xbdc9bf7bbef13f35,0xbf75bf0e3f223f6d,0xbf4e3e953f803ec4,0x3edb3f7f3e79bf55
.quad 0x3f6d3f35bec4bf80,0x3ec4bf35bf6da554,0xbe16bf75bf2c3ec4,0xbf71bdc93f5c3f55,0xbf463e483f753f35,0x3f623f55bdc9bf6d,0x3f713f46be16bf6d,0xbe79bf75bf3e3e48
.quad 0xbe48bf6dbf55a554,0xbf0e3ec43f7b3f35,0xbf3e3dc93f5c3f6d,0x3f7d3ef1bedbbf7b,0x3f753f553dc9bf35,0xbf46bf7bbef13ec4,0xbe79bf62bf71bec4,0x3d493f463f7d3f0e
.quad 0x248dbf80a5543f80,0x248dbf80a5543f80,0xbf183f463f2cbf35,0xbedb3f623f04bf55,0x3f75be48bf7fa554,0x3f46bf0ebf623ec4,0xbf71bef13f4e3f35,0xbf783dc93f803e48
.quad 0x3f0e3f6dbe48bf80,0x3f7b3ec4bf55bf35,0x3d49bf75bf043f35,0xbf4ebf463edb3f7b,0xbf223f0e3f75248d,0x3ef13f7b3dc9bf6d,0x3f783dc9bf67bf35,0xbd49bf75bf183f0e
.quad 0xbf6dbf353ec43f80,0xbec43f353f6d248d,0x3f043f7f3eacbf35,0x3f3ebe95bf7dbf0e,0x3dc9bf55bf62a554,0xbf75be483f463f6d,0xbf2c3e953f783f35,0x3f7d3f22beacbf7b
.quad 0x3f7b3ec4bf0ebf80,0xbf55bf6dbe483f35,0xbf67bf62be163f35,0x3f043f7f3f2cbe48,0x3ef13f7b3f46248d,0xbdc9bf55bf75bec4,0x3e16bf22bf80bf35,0xbeac3ef13f783f55
.quad 0x248dbf80a5543f80,0x248dbf80a5543f80,0xbe793f753eacbf6d,0xbd493f7f3e16bf7b,0x3ef1bf55bf223f35,0x3dc9bf7bbe953f6d,0xbf2c3f223f5cbec4,0xbe163f753edbbf55
.quad 0x3f55bec4bf7ba554,0x3e48bf6dbf0e3f35,0xbf713dc93f7d3ec4,0xbe793f623f2cbf0e,0x3f7f3e48bf62bf35,0x3e95bf55bf463ec4,0xbf7dbef13f2c3f6d,0xbeac3f463f5cbe48
.quad 0x3f6d3f35bec4bf80,0x3ec4bf35bf6da554,0xbf4ebf623d493f6d,0xbedb3f223f783e48,0x3f223f7b3e95bf35,0x3ef1bf0ebf7fbec4,0xbedbbf7fbf183ec4,0xbf043ef13f803f0e
.quad 0x3e483f6d3f55248d,0x3f0ebec4bf7bbf35,0x3d49bf46bf78bec4,0xbf183e953f713f55,0xbe953f0e3f7f3f35,0x3f22be48bf62bf6d,0x3f04be95bf67bf6d,0xbf2c3dc93f4e3f7b
.quad 0x3f80250dbf803f80,0x3f80250dbf800000,0x3f7dbdc9bf80bf80,0x3f71be95bf783e48,0x3f75be48bf7f3f80,0x3f46bf0ebf623ec4,0x3f67be95bf7dbf80,0x3f04bf46bf3e3f0e
.quad 0x3f55bec4bf7b3f80,0x3e48bf6dbf0e3f35,0x3f3ebef1bf78bf80,0xbe16bf7fbeac3f55,0x3f22bf0ebf753f80,0xbef1bf7bbdc93f6d,0x3f04bf22bf71bf80,0xbf3ebf623e163f7b
.quad 0x3ec4bf35bf6d3f80,0xbf6dbf353ec43f80,0x3e79bf46bf67bf80,0xbf80bef13f183f7b,0x3dc9bf55bf623f80,0xbf75be483f463f6d,0xbd49bf62bf5cbf80,0xbf4e3dc93f673f55
.quad 0xbe48bf6dbf553f80,0xbf0e3ec43f7b3f35,0xbeacbf75bf4ebf80,0xbe793f223f803f0e,0xbef1bf7bbf463f80,0x3dc93f553f753ec4,0xbf18bf7fbf3ebf80,0x3edb3f753f5c3e48
.quad 0x3f80250dbf800000,0x3f80250dbf800000,0x3f5cbef1bf673ec4,0x3f3ebf22bf4e3f0e,0x3ef1bf55bf223f35,0x3dc9bf7bbe953f6d,0xbd49bf7fbe793f6d,0xbf18bf623eac3f7b
.quad 0xbf0ebf6d3e483f80,0xbf7bbec43f553f35,0xbf67bf223f183f6d,0xbf5c3e953f803e48,0xbf7fbe483f623f35,0xbe953f553f46bec4,0xbf4e3e953f803ec4,0x3edb3f7f3e79bf55
.quad 0xbec43f353f6d250d,0x3f6d3f35bec4bf80,0x3e163f753f2cbec4,0x3f713dc9bf5cbf55,0x3f223f7b3e95bf35,0x3ef1bf0ebf7fbec4,0x3f713f46be16bf6d,0xbe79bf75bf3e3e48
.quad 0x3f7b3ec4bf0ebf80,0xbf55bf6dbe483f35,0x3f3ebdc9bf5cbf6d,0xbf7dbef13edb3f7b,0x3e95bf0ebf7fbf35,0xbf223e483f623f6d,0xbe79bf62bf71bec4,0x3d493f463f7d3f0e
.quad 0x3f80250dbf800000,0x3f80250dbf800000,0x3f18bf46bf2c3f35,0x3edbbf62bf043f55,0xbe95bf7b3dc93f80,0xbf22bf553ef13f6d,0xbf71bef13f4e3f35,0xbf783dc93f803e48
.quad 0xbf553ec43f7b250d,0xbe483f6d3f0ebf35,0xbd493f753f04bf35,0x3f4e3f46bedbbf7b,0x3f463f55be95bf80,0x3f62be48bf7fbec4,0x3f783dc9bf67bf35,0xbd49bf75bf183f0e
.quad 0x3ec4bf35bf6d0000,0xbf6dbf353ec43f80,0xbf04bf7fbeac3f35,0xbf3e3e953f7d3f0e,0xbf7fbf0e3ef13f80,0x3e953f7b3f22bec4,0xbf2c3e953f783f35,0x3f7d3f22beacbf7b
.quad 0x3e483f6d3f55250d,0x3f0ebec4bf7bbf35,0x3f673f623e16bf35,0xbf04bf7fbf2c3e48,0x3f623e48bf22bf80,0xbf7fbf0e3e953f6d,0x3e16bf22bf80bf35,0xbeac3ef13f783f55
.quad 0x3f80250dbf800000,0x3f80250dbf800000,0x3e79bf75beac3f6d,0x3d49bf7fbe163f7b,0xbf62bf0e3f463f35,0xbf7fbe483f753ec4,0xbf2c3f223f5cbec4,0xbe163f753edbbf55
.quad 0x3f0e3f6dbe48bf80,0x3f7b3ec4bf55bf35,0x3f71bdc9bf7dbec4,0x3e79bf62bf2c3f0e,0xbdc9bf7bbef13f35,0xbf75bf0e3f223f6d,0xbf7dbef13f2c3f6d,0xbeac3f463f5cbe48
.quad 0xbec43f353f6d250d,0x3f6d3f35bec4bf80,0x3f4e3f62bd49bf6d,0x3edbbf22bf78be48,0x3f46be48bf75bf35,0xbf62bf553dc93f6d,0xbedbbf7fbf183ec4,0xbf043ef13f803f0e
.quad 0xbf7bbec43f0e3f80,0x3f553f6d3e48bf35,0xbd493f463f783ec4,0x3f18be95bf71bf55,0x3f753f553dc9bf35,0xbf46bf7bbef13ec4,0x3f04be95bf67bf6d,0xbf2c3dc93f4e3f7b
.quad 0x3f80250dbf800000,0x3f80250dbf800000,0xbe16bf7f3d493f80,0xbeacbf753e793f7b,0xbf753e483f7f250d,0xbf463f0e3f62bec4,0x3edb3f75be16bf80,0x3f5c3f22bf2cbf55
.quad 0x3f55bec4bf7b0000,0x3e48bf6dbf0e3f35,0xbf2cbf623e793f80,0xbf7dbdc93f713f0e,0xbf223f0e3f75250d,0x3ef13f7b3dc9bf6d,0x3f5c3f46beacbf80,0x3f2cbef1bf7dbe48
.quad 0x3ec4bf35bf6d0000,0xbf6dbf353ec43f80,0xbf78bf223edb3f80,0xbd493f623f4ebe48,0xbdc93f553f62250d,0x3f753e48bf46bf6d,0x3f803ef1bf04bf80,0xbf18bf7fbedb3f0e
.quad 0xbe48bf6dbf550000,0xbf0e3ec43f7b3f35,0xbf71be953f183f80,0x3f783f46bd49bf55,0x3ef13f7b3f46250d,0xbdc9bf55bf75bec4,0x3f4e3dc9bf2cbf80,0xbf67be953f043f7b
.quad 0x3f80250dbf800000,0x3f80250dbf800000,0xbf04bf623edb3f6d,0xbf2cbf463f183f55,0xbef13f553f22bf35,0xbdc93f7b3e95bf6d,0x3f803dc9bf78bec4,0x3f4ebef1bf713e48
.quad 0xbf0ebf6d3e483f80,0xbf7bbec43f553f35,0xbedb3f463f4ebec4,0x3f043f75bd49bf7b,0x3f7f3e48bf62bf35,0x3e95bf55bf463ec4,0xbf18bf75bd493f6d,0xbf673dc93f783f0e
.quad 0xbec43f353f6d250d,0x3f6d3f35bec4bf80,0x3f7d3e95bf3ebf6d,0xbeacbf7fbf043f0e,0xbf22bf7bbe953f35,0xbef13f0e3f7f3ec4,0xbeac3f223f7d3ec4,0x3f783e95bf2cbf7b
.quad 0x3f7b3ec4bf0ebf80,0xbf55bf6dbe483f35,0xbf2cbf7fbf043ec4,0x3e163f623f673e48,0xbe953f0e3f7f3f35,0x3f22be48bf62bf6d,0x3f783ef1beacbf6d,0xbf80bf223e163f55
.quad 0x3f80250dbf800000,0x3f80250dbf800000,0xbf4ebf223f3e3f35,0xbf67bef13f5c3f0e,0x3e953f7bbdc9bf80,0x3f223f55bef1bf6d,0x3eacbf62bf183f35,0xbe79bf7fbd493f7b
.quad 0xbf553ec43f7b250d,0xbe483f6d3f0ebf35,0x3f803e95bf5cbf35,0x3f18bf22bf673e48,0xbf46bf553e953f80,0xbf623e483f7f3ec4,0x3e793f7f3edbbf35,0x3f803e95bf4ebf55
.quad 0x3ec4bf35bf6d0000,0xbf6dbf353ec43f80,0xbf5c3dc93f713f35,0x3f2c3f753e16bf55,0x3f7f3f0ebef1bf80,0xbe95bf7bbf223ec4,0xbf3ebf75be793f35,0xbe163f463f713e48
.quad 0x3e483f6d3f55250d,0x3f0ebec4bf7bbf35,0x3edbbef1bf7dbf35,0xbf5cbdc93f3e3f7b,0xbf62be483f223f80,0x3f7f3f0ebe95bf6d,0x3f7d3f463d49bf35,0xbf71bf62be793f0e
.quad 0x3f80250dbf800000,0x3f80250dbf800000,0xbf78be953f713ec4,0xbf80bdc93f7d3e48,0x3f623f0ebf46bf35,0x3f7f3e48bf75bec4,0xbf3ebf463f043f6d,0xbf7dbe953f673f0e
.quad 0x3f0e3f6dbe48bf80,0x3f7b3ec4bf55bf35,0xbeacbf7fbe163f6d,0xbf78bef13f3e3f55,0x3dc93f7b3ef1bf35,0x3f753f0ebf22bf6d,0x3e16bf62bf3e3ec4,0xbf71bf223f043f7b
.quad 0xbec43f353f6d250d,0x3f6d3f35bec4bf80,0x3f18bef1bf80bec4,0xbf67bf463e793f7b,0xbf463e483f753f35,0x3f623f55bdc9bf6d,0x3f673dc9bf4ebf6d,0xbf5cbf62bd493f55
.quad 0xbf7bbec43f0e3f80,0x3f553f6d3e48bf35,0x3f803f22be79bf6d,0xbf4ebf75beac3f0e,0xbf75bf55bdc93f35,0x3f463f7b3ef1bec4,0x3f5c3f753edbbec4,0xbf3ebf7fbf183e48
.quad 0xbf35a5543f353f80,0x3f35248dbf35bf80,0xbf183dc93f3e3f80,0x3edbbe95bf5cbf7b,0xbef13e483f463f80,0x3dc9bf0ebf75bf6d,0xbeac3e953f4e3f80,0xbe79bf46bf80bf55
.quad 0xbe483ec43f553f80,0xbf0ebf6dbf7bbf35,0xbd493ef13f5c3f80,0xbf4ebf7fbf67bf0e,0x3dc93f0e3f623f80,0xbf75bf7bbf46bec4,0x3e793f223f673f80,0xbf80bf62bf18be48
.quad 0x3ec43f353f6d3f80,0xbf6dbf35bec4a554,0x3f043f463f713f80,0xbf3ebef1be163e48,0x3f223f553f753f80,0xbef1be483dc93ec4,0x3f3e3f623f783f80,0xbe163dc93eac3f0e
.quad 0x3f553f6d3f7b3f80,0x3e483ec43f0e3f35,0x3f673f753f7d3f80,0x3f043f223f3e3f55,0x3f753f7b3f7f3f80,0x3f463f553f623f6d,0x3f7d3f7f3f803f80,0x3f713f753f783f7b
.quad 0xbf35a5543f353f80,0x3f35248dbf35bf80,0xbe793ef13f713f6d,0x3d49bf22bf7dbf55,0x3e953f553f7f3f35,0xbf22bf7bbf62bec4,0x3f3e3f7f3f5c3ec4,0xbf7dbf62bedb3e48
.quad 0x3f7b3f6d3f0e248d,0xbf55bec43e483f35,0x3f713f223e16bec4,0xbe793e953f3e3f7b,0x3f223e48be95bf35,0x3ef13f553f7f3f6d,0x3e16be95bf2cbf6d,0x3f713f7f3f5c3f0e
.quad 0xbec4bf35bf6dbf80,0x3f6d3f353ec4248d,0xbf4ebf75bf80bf6d,0x3edb3dc9be79bf0e,0xbf7fbf7bbf62bf35,0xbe95bf0ebf46bf6d,0xbf67bf46bf18bec4,0xbf5cbf75bf80bf7b
.quad 0xbf0ebec4be48a554,0xbf7bbf6dbf55bf35,0xbd493dc93e793ec4,0xbf18bef1beacbe48,0x3ef13f0e3f223f35,0x3dc93e483e953ec4,0x3f5c3f623f673f6d,0x3f3e3f463f4e3f55
.quad 0xbf35a5543f353f80,0x3f35248dbf35bf80,0x3e163f463f803f35,0xbeacbf62bf78bf0e,0x3f623f7b3f22248d,0xbf7fbf55be953ec4,0x3f673ef1be16bf35,0xbf043dc93f2c3f7b
.quad 0x3e48bec4bf55bf80,0x3f0e3f6d3f7b3f35,0xbf2cbf75bf78bf35,0x3f7d3f463eacbe48,0xbf7fbf55bef1a554,0x3e95be48bf22bf6d,0xbf04bdc93eac3f35,0xbf3ebf75bf7dbf55
.quad 0x3ec43f353f6d3f80,0xbf6dbf35bec4a554,0x3f783f7f3f673f35,0xbd493e953f183f55,0x3f463f0e3e95248d,0x3f623f7b3f7f3f6d,0xbd49be95bf04bf35,0x3f4e3f223edb3e48
.quad 0xbf55bf6dbf7bbf80,0xbe48bec4bf0ebf35,0xbf71bf62bf4ebf35,0xbf78bf7fbf80bf7b,0xbe95be48bdc9a554,0xbf22bf0ebef1bec4,0x3f183f223f2c3f35,0x3edb3ef13f043f0e
.quad 0xbf35a5543f353f80,0x3f35248dbf35bf80,0x3f043f753f673ec4,0xbf2cbf7fbf4ebe48,0x3f753f0ebdc9bf35,0xbf46be483ef13f6d,0xbd49bf22bf78bf6d,0x3f183f753f713f0e
.quad 0xbf7bbf6dbf0ea554,0x3f553ec4be48bf35,0xbedb3dc93f183f6d,0xbf04bf62bf80bf55,0x3f463f7b3f753f35,0xbf62bf0ebdc93ec4,0x3f4e3ef13d49bec4,0x3edb3f463f783f7b
.quad 0xbec4bf35bf6dbf80,0x3f6d3f353ec4248d,0xbf7dbf62bf2cbec4,0xbeacbf22bf5cbf7b,0xbdc93e483ef13f35,0xbf75bf55bf22bec4,0x3f713f7f3f7d3f6d,0x3e793ef13f2c3f55
.quad 0x3f0e3ec43e48248d,0x3f7b3f6d3f553f35,0xbf2cbf46bf5cbf6d,0xbe16be95bedbbf0e,0xbf62bf55bf46bf35,0xbf7fbf7bbf75bf6d,0x3e793e953eac3ec4,0x3d493dc93e163e48
.quad 0xbf35a5543f353f80,0x3f35248dbf35bf80,0x3f4e3f7f3f2c248d,0xbf67bf75bf043e48,0x3ef1be48bf46bf80,0xbdc93f0e3f753f6d,0xbf71bf75bf18a554,0x3f783f223d49bf0e
.quad 0xbe483ec43f553f80,0xbf0ebf6dbf7bbf35,0x3f803f623f04248d,0xbf18bdc93edb3f55,0xbdc9bf0ebf62bf80,0x3f753f7b3f463ec4,0xbf78bf46bedba554,0xbd49bef1bf4ebf7b
.quad 0x3ec43f353f6d3f80,0xbf6dbf35bec4a554,0x3f5c3f223eac248d,0x3f2c3f623f7d3f7b,0xbf22bf55bf75bf80,0x3ef13e48bdc9bec4,0xbf2cbef1be79a554,0xbf7dbf7fbf71bf55
.quad 0x3f553f6d3f7b3f80,0x3e483ec43f0e3f35,0x3edb3e953e16248d,0x3f5c3f463f2c3f0e,0xbf75bf7bbf7fbf80,0xbf46bf55bf62bf6d,0xbe16bdc9bd49a554,0xbeacbe95be79be48
.quad 0xbf35a5543f353f80,0x3f35248dbf35bf80,0x3f783f623eacbec4,0xbf80bf46be163f0e,0xbe95bf55bf7fbf35,0x3f223f7b3f623ec4,0xbf2cbdc93f043f6d,0x3e16bef1bf67bf7b
.quad 0x3f7b3f6d3f0e248d,0xbf55bec43e483f35,0xbeacbf46bf7dbf6d,0x3f783f753f2c3e48,0xbf22be483e953f35,0xbef1bf55bf7fbf6d,0x3f7d3f753f3e3ec4,0xbeac3dc93f043f55
.quad 0xbec4bf35bf6dbf80,0x3f6d3f353ec4248d,0xbf18be953d493ec4,0xbf67bf7fbf78bf55,0x3f7f3f7b3f623f35,0x3e953f0e3f463f6d,0xbedbbf22bf4ebf6d,0x3f043e953d49be48
.quad 0xbf0ebec4be48a554,0xbf7bbf6dbf55bf35,0x3f803f7f3f783f6d,0x3f4e3f623f713f7b,0xbef1bf0ebf22bf35,0xbdc9be48be95bec4,0xbf04bef1bedbbec4,0xbf2cbf22bf18bf0e
.quad 0xbf35a5543f353f80,0x3f35248dbf35bf80,0x3f7d3f22bd49bf35,0xbf71bef13e793f55,0xbf62bf7bbf22a554,0x3f7f3f553e95bec4,0x3edb3f623f7d3f35,0xbf5cbf7fbf3ebe48
.quad 0x3e48bec4bf55bf80,0x3f0e3f6d3f7b3f35,0xbf3ebe953e793f35,0xbe16bf22bf71bf7b,0x3f7f3f553ef1248d,0xbe953e483f223f6d,0xbf5cbf7fbf71bf35,0x3f2c3e95be16bf0e
.quad 0x3ec43f353f6d3f80,0xbf6dbf35bec4a554,0x3e79bdc9bedbbf35,0x3f803f753f4e3f0e,0xbf46bf0ebe95a554,0xbf62bf7bbf7fbf6d,0x3f803f753f5c3f35,0x3f183f463f673f7b
.quad 0xbf55bf6dbf7bbf80,0xbe48bec4bf0ebf35,0x3eac3ef13f183f35,0xbe79bdc93d493e48,0x3e953e483dc9248d,0x3f223f0e3ef13ec4,0xbf4ebf46bf3ebf35,0xbf67bf62bf5cbf55
.quad 0xbf35a5543f353f80,0x3f35248dbf35bf80,0x3f5c3e95bedbbf6d,0xbf3ebdc93f183f7b,0xbf75bf0e3dc93f35,0x3f463e48bef1bf6d,0x3f803f463e79bec4,0xbf4ebe953eac3f55
.quad 0xbf7bbf6dbf0ea554,0x3f553ec4be48bf35,0x3f673f7f3f4e3ec4,0xbf5cbef13d493f0e,0xbf46bf7bbf75bf35,0x3f623f0e3dc9bec4,0x3f183f623f803f6d,0xbf67bf22be793e48
.quad 0xbec4bf35bf6dbf80,0x3f6d3f353ec4248d,0x3e163ef13f3e3f6d,0xbf71bf46bf04be48,0x3dc9be48bef1bf35,0x3f753f553f223ec4,0xbeacbdc93e163ec4,0xbf78bf62bf3ebf0e
.quad 0x3f0e3ec43e48248d,0x3f7b3f6d3f553f35,0xbf3ebf22bf04bec4,0xbf7dbf75bf67bf55,0x3f623f553f463f35,0x3f7f3f7b3f753f6d,0xbf78bf75bf71bf6d,0xbf80bf7fbf7dbf7b
.quad 0xbf35bf80bf353f80,0x3f353f803f35250d,0xbf4ebf7fbf2cbf80,0x3f673f753f04be48,0xbf62bf7bbf223f80,0x3f7f3f553e95bec4,0xbf71bf75bf18bf80,0x3f783f223d49bf0e
.quad 0xbf7bbf6dbf0e3f80,0x3f553ec4be48bf35,0xbf80bf62bf04bf80,0x3f183dc9bedbbf55,0xbf7fbf55bef13f80,0x3e95be48bf22bf6d,0xbf78bf46bedbbf80,0xbd49bef1bf4ebf7b
.quad 0xbf6dbf35bec43f80,0xbec4bf35bf6dbf80,0xbf5cbf22beacbf80,0xbf2cbf62bf7dbf7b,0xbf46bf0ebe953f80,0xbf62bf7bbf7fbf6d,0xbf2cbef1be79bf80,0xbf7dbf7fbf71bf55
.quad 0xbf0ebec4be483f80,0xbf7bbf6dbf55bf35,0xbedbbe95be16bf80,0xbf5cbf46bf2cbf0e,0xbe95be48bdc93f80,0xbf22bf0ebef1bec4,0xbe16bdc9bd49bf80,0xbeacbe95be79be48
.quad 0xbf35bf80bf350000,0x3f353f803f35250d,0xbf78bf62beac3ec4,0x3f803f463e16bf0e,0xbf75bf0e3dc93f35,0x3f463e48bef1bf6d,0xbf2cbdc93f043f6d,0x3e16bef1bf67bf7b
.quad 0xbe483ec43f553f80,0xbf0ebf6dbf7bbf35,0x3eac3f463f7d3f6d,0xbf78bf75bf2cbe48,0x3f463f7b3f753f35,0xbf62bf0ebdc93ec4,0x3f7d3f753f3e3ec4,0xbeac3dc93f043f55
.quad 0x3f6d3f353ec4250d,0x3ec43f353f6d3f80,0x3f183e95bd49bec4,0x3f673f7f3f783f55,0x3dc9be48bef1bf35,0x3f753f553f223ec4,0xbedbbf22bf4ebf6d,0x3f043e953d49be48
.quad 0xbf55bf6dbf7bbf80,0xbe48bec4bf0ebf35,0xbf80bf7fbf78bf6d,0xbf4ebf62bf71bf7b,0xbf62bf55bf46bf35,0xbf7fbf7bbf75bf6d,0xbf04bef1bedbbec4,0xbf2cbf22bf18bf0e
.quad 0xbf35bf80bf350000,0x3f353f803f35250d,0xbf7dbf223d493f35,0x3f713ef1be79bf55,0xbef13e483f463f80,0x3dc9bf0ebf75bf6d,0x3edb3f623f7d3f35,0xbf5cbf7fbf3ebe48
.quad 0x3f7b3f6d3f0e250d,0xbf55bec43e483f35,0x3f3e3e95be79bf35,0x3e163f223f713f7b,0xbdc9bf0ebf62bf80,0x3f753f7b3f463ec4,0xbf5cbf7fbf71bf35,0x3f2c3e95be16bf0e
.quad 0xbf6dbf35bec40000,0xbec4bf35bf6dbf80,0xbe793dc93edb3f35,0xbf80bf75bf4ebf0e,0x3f223f553f753f80,0xbef1be483dc93ec4,0x3f803f753f5c3f35,0x3f183f463f673f7b
.quad 0x3f0e3ec43e48250d,0x3f7b3f6d3f553f35,0xbeacbef1bf18bf35,0x3e793dc9bd49be48,0xbf75bf7bbf7fbf80,0xbf46bf55bf62bf6d,0xbf4ebf46bf3ebf35,0xbf67bf62bf5cbf55
.quad 0xbf35bf80bf350000,0x3f353f803f35250d,0xbf5cbe953edb3f6d,0x3f3e3dc9bf18bf7b,0x3e953f553f7f3f35,0xbf22bf7bbf62bec4,0x3f803f463e79bec4,0xbf4ebe953eac3f55
.quad 0x3e48bec4bf55bf80,0x3f0e3f6d3f7b3f35,0xbf67bf7fbf4ebec4,0x3f5c3ef1bd49bf0e,0xbf22be483e953f35,0xbef1bf55bf7fbf6d,0x3f183f623f803f6d,0xbf67bf22be793e48
.quad 0x3f6d3f353ec4250d,0x3ec43f353f6d3f80,0xbe16bef1bf3ebf6d,0x3f713f463f043e48,0xbf7fbf7bbf62bf35,0xbe95bf0ebf46bf6d,0xbeacbdc93e163ec4,0xbf78bf62bf3ebf0e
.quad 0x3f553f6d3f7b3f80,0x3e483ec43f0e3f35,0x3f3e3f223f043ec4,0x3f7d3f753f673f55,0xbef1bf0ebf22bf35,0xbdc9be48be95bec4,0xbf78bf75bf71bf6d,0xbf80bf7fbf7dbf7b
.quad 0xbf35bf80bf350000,0x3f353f803f35250d,0xbf183dc93f3e3f80,0x3edbbe95bf5cbf7b,0x3f623f7b3f22250d,0xbf7fbf55be953ec4,0x3eacbe95bf4ebf80,0x3e793f463f803f55
.quad 0xbf7bbf6dbf0e0000,0x3f553ec4be48bf35,0xbd493ef13f5c3f80,0xbf4ebf7fbf67bf0e,0x3f7f3f553ef1250d,0xbe953e483f223f6d,0xbe79bf22bf67bf80,0x3f803f623f183e48
.quad 0xbf6dbf35bec40000,0xbec4bf35bf6dbf80,0x3f043f463f713f80,0xbf3ebef1be163e48,0x3f463f0e3e95250d,0x3f623f7b3f7f3f6d,0xbf3ebf62bf78bf80,0x3e16bdc9beacbf0e
.quad 0xbf0ebec4be480000,0xbf7bbf6dbf55bf35,0x3f673f753f7d3f80,0x3f043f223f3e3f55,0x3e953e483dc9250d,0x3f223f0e3ef13ec4,0xbf7dbf7fbf80bf80,0xbf71bf75bf78bf7b
.quad 0xbf35bf80bf350000,0x3f353f803f35250d,0xbe793ef13f713f6d,0x3d49bf22bf7dbf55,0x3f753f0ebdc9bf35,0xbf46be483ef13f6d,0xbf3ebf7fbf5cbec4,0x3f7d3f623edbbe48
.quad 0xbe483ec43f553f80,0xbf0ebf6dbf7bbf35,0x3f713f223e16bec4,0xbe793e953f3e3f7b,0xbf46bf7bbf75bf35,0x3f623f0e3dc9bec4,0xbe163e953f2c3f6d,0xbf71bf7fbf5cbf0e
.quad 0x3f6d3f353ec4250d,0x3ec43f353f6d3f80,0xbf4ebf75bf80bf6d,0x3edb3dc9be79bf0e,0xbdc93e483ef13f35,0xbf75bf55bf22bec4,0x3f673f463f183ec4,0x3f5c3f753f803f7b
.quad 0xbf55bf6dbf7bbf80,0xbe48bec4bf0ebf35,0xbd493dc93e793ec4,0xbf18bef1beacbe48,0x3f623f553f463f35,0x3f7f3f7b3f753f6d,0xbf5cbf62bf67bf6d,0xbf3ebf46bf4ebf55
.quad 0xbf35bf80bf350000,0x3f353f803f35250d,0x3e163f463f803f35,0xbeacbf62bf78bf0e,0x3ef1be48bf46bf80,0xbdc93f0e3f753f6d,0xbf67bef13e163f35,0x3f04bdc9bf2cbf7b
.quad 0x3f7b3f6d3f0e250d,0xbf55bec43e483f35,0xbf2cbf75bf78bf35,0x3f7d3f463eacbe48,0x3dc93f0e3f623f80,0xbf75bf7bbf46bec4,0x3f043dc9beacbf35,0x3f3e3f753f7d3f55
.quad 0xbf6dbf35bec40000,0xbec4bf35bf6dbf80,0x3f783f7f3f673f35,0xbd493e953f183f55,0xbf22bf55bf75bf80,0x3ef13e48bdc9bec4,0x3d493e953f043f35,0xbf4ebf22bedbbe48
.quad 0x3f0e3ec43e48250d,0x3f7b3f6d3f553f35,0xbf71bf62bf4ebf35,0xbf78bf7fbf80bf7b,0x3f753f7b3f7f3f80,0x3f463f553f623f6d,0xbf18bf22bf2cbf35,0xbedbbef1bf04bf0e
.quad 0xbf35bf80bf350000,0x3f353f803f35250d,0x3f043f753f673ec4,0xbf2cbf7fbf4ebe48,0xbe95bf55bf7fbf35,0x3f223f7b3f623ec4,0x3d493f223f783f6d,0xbf18bf75bf71bf0e
.quad 0x3e48bec4bf55bf80,0x3f0e3f6d3f7b3f35,0xbedb3dc93f183f6d,0xbf04bf62bf80bf55,0x3f223e48be95bf35,0x3ef13f553f7f3f6d,0xbf4ebef1bd493ec4,0xbedbbf46bf78bf7b
.quad 0x3f6d3f353ec4250d,0x3ec43f353f6d3f80,0xbf7dbf62bf2cbec4,0xbeacbf22bf5cbf7b,0x3f7f3f7b3f623f35,0x3e953f0e3f463f6d,0xbf71bf7fbf7dbf6d,0xbe79bef1bf2cbf55
.quad 0x3f553f6d3f7b3f80,0x3e483ec43f0e3f35,0xbf2cbf46bf5cbf6d,0xbe16be95bedbbf0e,0x3ef13f0e3f223f35,0x3dc93e483e953ec4,0xbe79be95beacbec4,0xbd49bdc9be16be48

.size TBL2, .-TBL2
.p2align 8
.type TBL1,@object
TBL1:
.quad 0x3f803f803f803f80,0x3f803f803f803f80,0xa554bf80248d3f80,0xa554bf80248d3f80,0xbf803f80bf803f80,0xbf803f80bf803f80,0x248dbf80a5543f80,0x248dbf80a5543f80
.quad 0x3ec43f353f6d3f80,0xbf6dbf35bec4248d,0x3f6dbf35bec43f80,0x3ec43f35bf6d248d,0xbec43f35bf6d3f80,0x3f6dbf353ec4248d,0xbf6dbf353ec43f80,0xbec43f353f6d248d
.quad 0xbf35248d3f353f80,0x3f35a554bf35bf80,0x3f35a554bf353f80,0xbf35248d3f35bf80,0x3f35248dbf353f80,0xbf35a5543f35bf80,0xbf35a5543f353f80,0x3f35248dbf35bf80
.quad 0xbf6dbf353ec43f80,0xbec43f353f6da554,0xbec43f35bf6d3f80,0x3f6dbf353ec4a554,0x3f6dbf35bec43f80,0x3ec43f35bf6da554,0x3ec43f353f6d3f80,0xbf6dbf35bec4a554
.quad 0x3f803f803f803f80,0x3f803f803f803f80,0xa554bf80248d3f80,0xa554bf80248d3f80,0xbf803f80bf803f80,0xbf803f80bf803f80,0x248dbf80a5543f80,0x248dbf80a5543f80
.quad 0xbec4bf35bf6dbf80,0x3f6d3f353ec4a554,0xbf6d3f353ec4bf80,0xbec4bf353f6da554,0x3ec4bf353f6dbf80,0xbf6d3f35bec4a554,0x3f6d3f35bec4bf80,0x3ec4bf35bf6da554
.quad 0xbf35248d3f353f80,0x3f35a554bf35bf80,0x3f35a554bf353f80,0xbf35248d3f35bf80,0x3f35248dbf353f80,0xbf35a5543f35bf80,0xbf35a5543f353f80,0x3f35248dbf35bf80
.quad 0x3f6d3f35bec4bf80,0x3ec4bf35bf6d248d,0x3ec4bf353f6dbf80,0xbf6d3f35bec4248d,0xbf6d3f353ec4bf80,0xbec4bf353f6d248d,0xbec4bf35bf6dbf80,0x3f6d3f353ec4248d
.quad 0x0,0x0,0xbf80250d3f800000,0xbf80250d3f800000,0x250d0000250d0000,0x250d0000250d0000,0x3f80250dbf800000,0x3f80250dbf800000
.quad 0x3f6d3f353ec40000,0x3ec43f353f6d3f80,0xbec4bf353f6d0000,0x3f6dbf35bec43f80,0xbf6d3f35bec40000,0xbec43f35bf6d3f80,0x3ec4bf35bf6d0000,0xbf6dbf353ec43f80
.quad 0x3f353f803f350000,0xbf35bf80bf35250d,0x3f35bf803f350000,0xbf353f80bf35250d,0xbf353f80bf350000,0x3f35bf803f35250d,0xbf35bf80bf350000,0x3f353f803f35250d
.quad 0xbec43f353f6d0000,0x3f6d3f35bec4bf80,0x3f6dbf353ec40000,0x3ec4bf353f6dbf80,0x3ec43f35bf6d0000,0xbf6d3f353ec4bf80,0xbf6dbf35bec40000,0xbec4bf35bf6dbf80
.quad 0x0,0x0,0xbf80250d3f800000,0xbf80250d3f800000,0x250d0000250d0000,0x250d0000250d0000,0x3f80250dbf800000,0x3f80250dbf800000
.quad 0xbf6dbf35bec4250d,0xbec4bf35bf6dbf80,0x3ec43f35bf6d250d,0xbf6d3f353ec4bf80,0x3f6dbf353ec4250d,0x3ec4bf353f6dbf80,0xbec43f353f6d250d,0x3f6d3f35bec4bf80
.quad 0x3f353f803f350000,0xbf35bf80bf35250d,0x3f35bf803f350000,0xbf353f80bf35250d,0xbf353f80bf350000,0x3f35bf803f35250d,0xbf35bf80bf350000,0x3f353f803f35250d
.quad 0x3ec4bf35bf6d250d,0xbf6dbf353ec43f80,0xbf6d3f35bec4250d,0xbec43f35bf6d3f80,0xbec4bf353f6d250d,0x3f6dbf35bec43f80,0x3f6d3f353ec4250d,0x3ec43f353f6d3f80
.quad 0x8000800080008000,0x8000800080008000,0x3f80a50dbf808000,0x3f80a50dbf808000,0xa50d8000a50d8000,0xa50d8000a50d8000,0xbf80a50d3f808000,0xbf80a50d3f808000
.quad 0xbf6dbf35bec48000,0xbec4bf35bf6dbf80,0x3ec43f35bf6d8000,0xbf6d3f353ec4bf80,0x3f6dbf353ec48000,0x3ec4bf353f6dbf80,0xbec43f353f6d8000,0x3f6d3f35bec4bf80
.quad 0xbf35bf80bf358000,0x3f353f803f35a50d,0xbf353f80bf358000,0x3f35bf803f35a50d,0x3f35bf803f358000,0xbf353f80bf35a50d,0x3f353f803f358000,0xbf35bf80bf35a50d
.quad 0x3ec4bf35bf6d8000,0xbf6dbf353ec43f80,0xbf6d3f35bec48000,0xbec43f35bf6d3f80,0xbec4bf353f6d8000,0x3f6dbf35bec43f80,0x3f6d3f353ec48000,0x3ec43f353f6d3f80
.quad 0x8000800080008000,0x8000800080008000,0x3f80a50dbf808000,0x3f80a50dbf808000,0xa50d8000a50d8000,0xa50d8000a50d8000,0xbf80a50d3f808000,0xbf80a50d3f808000
.quad 0x3f6d3f353ec4a50d,0x3ec43f353f6d3f80,0xbec4bf353f6da50d,0x3f6dbf35bec43f80,0xbf6d3f35bec4a50d,0xbec43f35bf6d3f80,0x3ec4bf35bf6da50d,0xbf6dbf353ec43f80
.quad 0xbf35bf80bf358000,0x3f353f803f35a50d,0xbf353f80bf358000,0x3f35bf803f35a50d,0x3f35bf803f358000,0xbf353f80bf35a50d,0x3f353f803f358000,0xbf35bf80bf35a50d
.quad 0xbec43f353f6da50d,0x3f6d3f35bec4bf80,0x3f6dbf353ec4a50d,0x3ec4bf353f6dbf80,0x3ec43f35bf6da50d,0xbf6d3f353ec4bf80,0xbf6dbf35bec4a50d,0xbec4bf35bf6dbf80
.quad 0x3f803f803f803f80,0x3f803f803f803f80,0xa554bf80248d3f80,0xa554bf80248d3f80,0xbf803f80bf803f80,0xbf803f80bf803f80,0x248dbf80a5543f80,0x248dbf80a5543f80
.quad 0x3ec43f353f6d3f80,0xbf6dbf35bec4248d,0x3f6dbf35bec43f80,0x3ec43f35bf6d248d,0xbec43f35bf6d3f80,0x3f6dbf353ec4248d,0xbf6dbf353ec43f80,0xbec43f353f6d248d
.quad 0xbf35248d3f353f80,0x3f35a554bf35bf80,0x3f35a554bf353f80,0xbf35248d3f35bf80,0x3f35248dbf353f80,0xbf35a5543f35bf80,0xbf35a5543f353f80,0x3f35248dbf35bf80
.quad 0xbf6dbf353ec43f80,0xbec43f353f6da554,0xbec43f35bf6d3f80,0x3f6dbf353ec4a554,0x3f6dbf35bec43f80,0x3ec43f35bf6da554,0x3ec43f353f6d3f80,0xbf6dbf35bec4a554
.quad 0x3f803f803f803f80,0x3f803f803f803f80,0xa554bf80248d3f80,0xa554bf80248d3f80,0xbf803f80bf803f80,0xbf803f80bf803f80,0x248dbf80a5543f80,0x248dbf80a5543f80
.quad 0xbec4bf35bf6dbf80,0x3f6d3f353ec4a554,0xbf6d3f353ec4bf80,0xbec4bf353f6da554,0x3ec4bf353f6dbf80,0xbf6d3f35bec4a554,0x3f6d3f35bec4bf80,0x3ec4bf35bf6da554
.quad 0xbf35248d3f353f80,0x3f35a554bf35bf80,0x3f35a554bf353f80,0xbf35248d3f35bf80,0x3f35248dbf353f80,0xbf35a5543f35bf80,0xbf35a5543f353f80,0x3f35248dbf35bf80
.quad 0x3f6d3f35bec4bf80,0x3ec4bf35bf6d248d,0x3ec4bf353f6dbf80,0xbf6d3f35bec4248d,0xbf6d3f353ec4bf80,0xbec4bf353f6d248d,0xbec4bf35bf6dbf80,0x3f6d3f353ec4248d
.quad 0x3f8000003f800000,0x3f8000003f800000,0x3f7fcd793f800000,0x3f7e39bc3f7f35f9,0x3f7f35f93f800000,0x3f78ed3c3f7cd925,0x3f7e39bc3f800000,0x3f702d4f3f78ed3c
.quad 0x3f7ffcd73f800000,0x3f7fe3943f7ff35e,0x3f7fb10f3f800000,0x3f7d3aac3f7ec46d,0x3f7f00593f800000,0x3f770f113f7c0361,0x3f7deafa3f800000,0x3f6d76aa3f77b493
.quad 0x3f7ff35e3f800000,0x3f7f8e563f7fcd79,0x3f7f8e563f800000,0x3f7c03613f7e39bc,0x3f7ec46d3f800000,0x3f74fa0b3f7b14be,0x3f7d95f43f800000,0x3f6a8b4b3f766377
.quad 0x3f7fe3943f800000,0x3f7f00593f7f8e56,0x3f7f654e3f800000,0x3f7a94213f7d95f4,0x3f7e82383f800000,0x3f72ae9e3f7a0d54,0x3f7d3aac3f800000,0x3f676bd83f74fa0b
.quad 0x3f8000003f800000,0x3f8000003f800000,0x3f7b14be3f7cd925,0x3f7663773f78ed3c,0x3f6c835e3f737871,0x3f5a46a03f641901,0x3f54db313f641901,0x3f2dc5e33f42a9f7
.quad 0x3f7fb10f3f7fcd79,0x3f7f654e3f7f8e56,0x3f7853f83f7b14be,0x3f7109083f74fa0b,0x3f676bd83f702d4f,0x3f50935b3f5cdc29,0x3f4d9f023f5f5be6,0x3f2074403f3889dc
.quad 0x3f7ec46d3f7f35f9,0x3f7d95f43f7e39bc,0x3f74fa0b3f78ed3c,0x3f6a8b4b3f702d4f,0x3f61c5983f6c835e,0x3f45e4033f54db31,0x3f45e4033f5a46a0,0x3f1260b23f2dc5e3
.quad 0x3f7d3aac3f7e39bc,0x3f7a94213f7c0361,0x3f7109083f766377,0x3f62f2193f6a8b4b,0x3f5b941a3f687c12,0x3f3a45823f4c1d35,0x3f3daef93f54db31,0x3f039c3d3f226799
.quad 0x3f8000003f800000,0x3f8000003f800000,0x3f702d4f3f737871,0x3f687c123f6c835e,0x3f42a9f73f4f1bbd,0x3f26423a3f3504f3,0x3efa2c903f167918,0x3e8afa3e3ec3ef15
.quad 0x3f7f00593f7f35f9,0x3f7e82383f7ec46d,0x3f676bd83f6c835e,0x3f5b941a3f61c598,0x3f333bc63f42a9f7,0x3f104f0e3f226799,0x3ed1c7593f05c277,0x3e2a1c3f3e94a031
.quad 0x3f7c03613f7cd925,0x3f7a0d543f7b14be,0x3f5cdc293f641901,0x3f4c1d353f54db31,0x3f2267993f3504f3,0x3ef15aea3f0e39da,0x3ea7bf253ee87171,0x3d7122833e47c5c2
.quad 0x3f770f113f78ed3c,0x3f72ae9e3f74fa0b,0x3f50935b3f5a46a0,0x3f3a45823f45e403,0x3f104f0e3f26423a,0x3ebf47d73ef15aea,0x3e78cfcc3ec3ef15,0xbd48fb303dc8bd36
.quad 0x3f8000003f800000,0x3f8000003f800000,0x3f5f5be63f641901,0x3f54db313f5a46a0,0x3f05c2773f167918,0x3ec3ef153ee87171,0x3d20cee73e20305b,0xbe47c5c2bda0af2a
.quad 0x3f7deafa3f7e39bc,0x3f7d3aac3f7d95f4,0x3f4d9f023f54db31,0x3f3daef93f45e403,0x3ed1c7593efa2c90,0x3e78cfcc3ea7bf25,0xbdb4b86a3d20cee7,0xbeac7cd4be5b73dc
.quad 0x3f77b4933f78ed3c,0x3f74fa0b3f766377,0x3f3889dc3f42a9f7,0x3f2267993f2dc5e3,0x3e94a0313ec3ef15,0x3dc8bd363e47c5c2,0xbe5b73dcbda0af2a,0xbef15aeabeb13641
.quad 0x3f6d76aa3f702d4f,0x3f676bd83f6a8b4b,0x3f2074403f2dc5e3,0x3f039c3d3f1260b2,0x3e2a1c3f3e8afa3e,0xbd48fb303d712283,0xbeac7cd4be47c5c2,0xbf187fc0bef15aea
.quad 0x0,0x0,0x3d20cee700000000,0x3df0b7723da0af2a,0x3da0af2a00000000,0x3e6f0c4d3e20305b,0x3df0b77200000000,0x3eb136413e6f0c4d
.quad 0x3c20d8d200000000,0x3cf13d4c3ca0d6d6,0x3d48fb3000000000,0x3e1640833dc8bd36,0x3db4b86a00000000,0x3e8622103e3403f1,0x3e0255f400000000,0x3ebf47d73e814693
.quad 0x3ca0d6d600000000,0x3d7122833d20cee7,0x3d71228300000000,0x3e3403f13df0b772,0x3dc8bd3600000000,0x3e94a0313e47c5c2,0x3e0c4cf700000000,0x3ecd2ef33e8afa3e
.quad 0x3cf13d4c00000000,0x3db4b86a3d712283,0x3d8ca1f200000000,0x3e519f653e0c4cf7,0x3ddcbd0d00000000,0x3ea2fd523e5b73dc,0x3e16408300000000,0x3edae8803e94a031
.quad 0x0,0x0,0x3e47c5c23e20305b,0x3e8afa3e3e6f0c4d,0x3ec3ef153e9e377a,0x3f05c2773ee87171,0x3f0e39da3ee87171,0x3f3bfc8f3f26423a
.quad 0x3d48fb303d20cee7,0x3d8ca1f23d712283,0x3e78cfcc3e47c5c2,0x3eac7cd43e94a031,0x3edae8803eb13641,0x3f146eba3f0172c3,0x3f187fc03efa2c90,0x3f4779bc3f316e2c
.quad 0x3dc8bd363da0af2a,0x3e0c4cf73df0b772,0x3e94a0313e6f0c4d,0x3ecd2ef33eb13641,0x3ef15aea3ec3ef15,0x3f2267993f0e39da,0x3f2267993f05c277,0x3f5205d43f3bfc8f
.quad 0x3e1640833df0b772,0x3e519f653e3403f1,0x3eac7cd43e8afa3e,0x3eece91a3ecd2ef3,0x3f039c3d3ed65a92,0x3f2f9c323f1a82a4,0x3f2beb4a3f0e39da,0x3f5b941a3f45e403
.quad 0x0,0x0,0x3eb136413e9e377a,0x3ed65a923ec3ef15,0x3f26423a3f167918,0x3f42a9f73f3504f3,0x3f5f5be63f4f1bbd,0x3f7663773f6c835e
.quad 0x3db4b86a3da0af2a,0x3ddcbd0d3dc8bd36,0x3edae8803ec3ef15,0x3f039c3d3ef15aea,0x3f36c9a93f26423a,0x3f53731f3f45e403,0x3f6986903f5a46a0,0x3f7c71603f74fa0b
.quad 0x3e3403f13e20305b,0x3e5b73dc3e47c5c2,0x3f0172c33ee87171,0x3f1a82a43f0e39da,0x3f45e4033f3504f3,0x3f61c5983f54db31,0x3f71decf3f641901,0x3f7f8e563f7b14be
.quad 0x3e8622103e6f0c4d,0x3ea2fd523e94a031,0x3f146eba3f05c277,0x3f2f9c323f226799,0x3f53731f3f42a9f7,0x3f6d76aa3f61c598,0x3f7853f83f6c835e,0x3f7fb10f3f7ec46d
.quad 0x0,0x0,0x3efa2c903ee87171,0x3f0e39da3f05c277,0x3f5a46a03f4f1bbd,0x3f6c835e3f641901,0x3f7fcd793f7cd925,0x3f7b14be3f7f35f9
.quad 0x3e0255f43df0b772,0x3e1640833e0c4cf7,0x3f187fc03f0e39da,0x3f2beb4a3f226799,0x3f6986903f5f5be6,0x3f7853f83f71decf,0x3f7f00593f7fcd79,0x3f7109083f7a0d54
.quad 0x3e8146933e6f0c4d,0x3e94a0313e8afa3e,0x3f316e2c3f26423a,0x3f45e4033f3bfc8f,0x3f74fa0b3f6c835e,0x3f7ec46d3f7b14be,0x3f7a0d543f7f35f9,0x3f61c5983f702d4f
.quad 0x3ebf47d73eb13641,0x3edae8803ecd2ef3,0x3f4779bc3f3bfc8f,0x3f5b941a3f5205d4,0x3f7c71603f766377,0x3f7fb10f3f7f8e56,0x3f7109083f7b14be,0x3f4d9f023f61c598
.quad 0x3f8000003f800000,0x3f8000003f800000,0x3f490a883f4f1bbd,0x3f3bfc8f3f42a9f7,0x3e6f0c4d3e9e377a,0x3da0af2a3e20305b,0xbed65a92be9e377a,0xbf1e7cf1bf05c277
.quad 0x3f7c71603f7cd925,0x3f7b8f2a3f7c0361,0x3f2beb4a3f3504f3,0x3f187fc03f226799,0x3d8ca1f23e20305b,0xbddcbd0dbca0d6d6,0xbf104f0ebee87171,0xbf4105b8bf2a0c73
.quad 0x3f71decf3f737871,0x3f6e641a3f702d4f,0x3f0a04f83f167918,0x3edf71083efa2c90,0xbdc8bd36248d3132,0xbe94a031be47c5c2,0xbf316e2cbf167918,0xbf5cdc29bf490a88
.quad 0x3f6093843f641901,0x3f58f3c43f5cdc29,0x3ec8917e3ee87171,0x3e8622103ea7bf25,0xbe862210be20305b,0xbeece91abeba9be1,0xbf4d9f02bf3504f3,0xbf710908bf61c598
.quad 0x3f8000003f800000,0x3f8000003f800000,0x3f2dc5e33f3504f3,0x3f1e7cf13f26423a,0xbda0af2a248d3132,0xbe6f0c4dbe20305b,0xbf490a88bf3504f3,0xbf687c12bf5a46a0
.quad 0x3f7a94213f7b14be,0x3f79805c3f7a0d54,0x3f039c3d3f0e39da,0x3edae8803ef15aea,0xbe8fcefebe47c5c2,0xbee3f40dbeba9be1,0xbf653a48bf54db31,0xbf7a9421bf71decf
.quad 0x3f6a8b4b3f6c835e,0x3f6655e73f687c12,0x3ea7bf253ec3ef15,0x3e5b73dc3e8afa3e,0xbef15aeabec3ef15,0xbf226799bf0e39da,0xbf77b493bf6c835e,0xbf7ff35ebf7e39bc
.quad 0x3f50935b3f54db31,0x3f4779bc3f4c1d35,0x3e0255f43e47c5c2,0xbc20d8d23d712283,0xbf2456f1bf0e39da,0xbf4a965ebf3889dc,0xbf7fb10fbf7b14be,0xbf7853f8bf7ec46d
.quad 0x3f8000003f800000,0x3f8000003f800000,0x3f0e39da3f167918,0x3efa2c903f05c277,0xbec3ef15be9e377a,0xbf05c277bee87171,0xbf7b14bebf737871,0xbf7fcd79bf7f35f9
.quad 0x3f7853f83f78ed3c,0x3f770f113f77b493,0x3eac7cd43ec3ef15,0x3e78cfcc3e94a031,0xbf187fc0bf05c277,0xbf3a4582bf2a0c73,0xbf7fb10fbf7f35f9,0xbf743c41bf7c0361
.quad 0x3f61c5983f641901,0x3f5cdc293f5f5be6,0x3dc8bd363e20305b,0xbca0d6d63d20cee7,0xbf45e403bf3504f3,0xbf61c598bf54db31,0xbf74fa0bbf7cd925,0xbf579b8cbf687c12
.quad 0x3f3daef93f42a9f7,0x3f333bc63f3889dc,0xbe164083bda0af2a,0xbe8fcefebe5b73dc,0xbf676bd8bf5a46a0,0xbf79805cbf71decf,0xbf5b941abf6c835e,0xbf2beb4abf45e403
.quad 0x3f8000003f800000,0x3f8000003f800000,0x3ed65a923ee87171,0x3eb136413ec3ef15,0xbf26423abf167918,0xbf42a9f7bf3504f3,0xbf766377bf7cd925,0xbf5f5be6bf6c835e
.quad 0x3f75b1c93f766377,0x3f743c413f74fa0b,0x3e1640833e47c5c2,0x3d48fb303dc8bd36,0xbf563e03bf490a88,0xbf6b8a3dbf61c598,0xbf58f3c4bf687c12,0xbf2f9c32bf45e403
.quad 0x3f579b8c3f5a46a0,0x3f5205d43f54db31,0xbe0c4cf7bda0af2a,0xbe814693be47c5c2,0xbf74fa0bbf6c835e,0xbf7ec46dbf7b14be,0xbf2a0c73bf42a9f7,0xbedf7108bf0e39da
.quad 0x3f28296a3f2dc5e3,0x3f1c81b93f226799,0xbed1c759beb13641,0xbf07e565bef15aea,0xbf7ffcd7bf7e39bc,0xbf7a9421bf7ec46d,0xbedae880bf0e39da,0xbe164083be94a031
.quad 0x0,0x0,0x3f1e7cf13f167918,0x3f2dc5e33f26423a,0x3f78ed3c3f737871,0x3f7f35f93f7cd925,0x3f687c123f737871,0x3f490a883f5a46a0
.quad 0x3e2a1c3f3e20305b,0x3e3de7313e3403f1,0x3f3daef93f3504f3,0x3f4d9f023f45e403,0x3f7f654e3f7cd925,0x3f7e82383f7ff35e,0x3f53731f3f641901,0x3f28296a3f3f5cb5
.quad 0x3ea7bf253e9e377a,0x3eba9be13eb13641,0x3f579b8c3f4f1bbd,0x3f6655e73f5f5be6,0x3f7ec46d3f800000,0x3f74fa0b3f7b14be,0x3f3889dc3f4f1bbd,0x3f0172c33f1e7cf1
.quad 0x3ef5c6c53ee87171,0x3f07e5653f0172c3,0x3f6b8a3d3f641901,0x3f770f113f71decf,0x3f770f113f7cd925,0x3f62f2193f6e641a,0x3f187fc03f3504f3,0x3eac7cd43ef15aea
.quad 0x0,0x0,0x3f3bfc8f3f3504f3,0x3f490a883f42a9f7,0x3f7f35f93f800000,0x3f78ed3c3f7cd925,0x3f1e7cf13f3504f3,0x3ed65a923f05c277
.quad 0x3e519f653e47c5c2,0x3e6542e93e5b73dc,0x3f5b941a3f54db31,0x3f676bd83f61c598,0x3f75b1c93f7b14be,0x3f653a483f6e641a,0x3ee3f40d3f0e39da,0x3e519f653ea7bf25
.quad 0x3ecd2ef33ec3ef15,0x3edf71083ed65a92,0x3f71decf3f6c835e,0x3f7a0d543f766377,0x3f61c5983f6c835e,0x3f45e4033f54db31,0x3e8146933ec3ef15,0xbca0d6d63df0b772
.quad 0x3f146eba3f0e39da,0x3f2074403f1a82a4,0x3f7deafa3f7b14be,0x3f7ffcd73f7f8e56,0x3f4449693f54db31,0x3f1c81b93f316e2c,0x3d48fb303e47c5c2,0xbe78cfccbdc8bd36
.quad 0x0,0x0,0x3f54db313f4f1bbd,0x3f5f5be63f5a46a0,0x3f6c835e3f737871,0x3f5a46a03f641901,0x3e47c5c23e9e377a,0xbd20cee73da0af2a
.quad 0x3e78cfcc3e6f0c4d,0x3e8622103e814693,0x3f7109083f6c835e,0x3f7853f83f74fa0b,0x3f4d9f023f5a46a0,0x3f2f9c323f3f5cb5,0xbd48fb303da0af2a,0xbe996dbabe3403f1
.quad 0x3ef15aea3ee87171,0x3f0172c33efa2c90,0x3f7ec46d3f7cd925,0x3f7ff35e3f7fcd79,0x3f2267993f3504f3,0x3ef15aea3f0e39da,0xbe94a031be20305b,0xbf0a04f8bed65a92
.quad 0x3f2beb4a3f26423a,0x3f36c9a93f316e2c,0x3f7d3aac3f7f35f9,0x3f75b1c93f7a0d54,0x3edae8803f05c277,0x3e6542e93ea7bf25,0xbf039c3dbec3ef15,0xbf3daef9bf226799
.quad 0x0,0x0,0x3f687c123f641901,0x3f702d4f3f6c835e,0x3f42a9f73f4f1bbd,0x3f26423a3f3504f3,0xbe8afa3ebe20305b,0xbefa2c90bec3ef15
.quad 0x3e8fcefe3e8afa3e,0x3e996dba3e94a031,0x3f7d3aac3f7b14be,0x3f7fb10f3f7ec46d,0x3f0c21243f1e7cf1,0x3ec8917e3ef15aea,0xbf07e565bed65a92,0xbf3a4582bf226799
.quad 0x3f0a04f83f05c277,0x3f1260b23f0e39da,0x3f7d95f43f7f35f9,0x3f77b4933f7b14be,0x3e94a0313ec3ef15,0x3dc8bd363e47c5c2,0xbf3f5cb5bf26423a,0xbf6655e7bf54db31
.quad 0x3f4105b83f3bfc8f,0x3f4a965e3f45e403,0x3f6986903f702d4f,0x3f58f3c43f61c598,0x3c20d8d23df0b772,0xbe519f65bdc8bd36,0xbf676bd8bf54db31,0xbf7d3aacbf74fa0b
.quad 0x3f8000003f800000,0x3f8000003f800000,0x3e8afa3e3e9e377a,0x3e47c5c23e6f0c4d,0xbf5a46a0bf4f1bbd,0xbf6c835ebf641901,0xbf3bfc8fbf4f1bbd,0xbf0e39dabf26423a
.quad 0x3f72ae9e3f737871,0x3f7109083f71decf,0xbd48fb30248d3132,0xbe164083bdc8bd36,0xbf79805cbf737871,0xbf7fb10fbf7d95f4,0xbef5c6c5bf167918,0xbe78cfccbeba9be1
.quad 0x3f4c1d353f4f1bbd,0x3f45e4033f490a88,0xbeba9be1be9e377a,0xbef15aeabed65a92,0xbf7ec46dbf800000,0xbf74fa0bbf7b14be,0xbe3403f1be9e377a,0x3dc8bd36bd20cee7
.quad 0x3f104f0e3f167918,0x3f039c3d3f0a04f8,0xbf2456f1bf167918,0xbf3daef9bf316e2c,0xbf698690bf737871,0xbf4d9f02bf5cdc29,0x3e164083a553c9ca,0x3edae8803e94a031
.quad 0x3f8000003f800000,0x3f8000003f800000,0x3df0b7723e20305b,0x3d20cee73da0af2a,0xbf78ed3cbf737871,0xbf7f35f9bf7cd925,0xbeb13641bee87171,0xbdf0b772be6f0c4d
.quad 0x3f6f4ba83f702d4f,0x3f6d76aa3f6e641a,0xbe78cfccbe47c5c2,0xbeac7cd4be94a031,0xbf7deafabf7fcd79,0xbf743c41bf7a0d54,0x3c20d8d2bdf0b772,0x3e8622103e0c4cf7
.quad 0x3f3f5cb53f42a9f7,0x3f3889dc3f3bfc8f,0xbf1260b2bf05c277,0xbf2a0c73bf1e7cf1,0xbf61c598bf6c835e,0xbf45e403bf54db31,0x3eba9be13e6f0c4d,0x3f1a82a43efa2c90
.quad 0x3eece91a3efa2c90,0x3ed1c7593edf7108,0xbf53731fbf490a88,0xbf653a48bf5cdc29,0xbf28296abf3bfc8f,0xbef5c6c5bf1260b2,0x3f2beb4a3f0e39da,0x3f5b941a3f45e403
.quad 0x3f8000003f800000,0x3f8000003f800000,0xbd20cee7248d3132,0xbdf0b772bda0af2a,0xbf7f35f9bf800000,0xbf78ed3cbf7cd925,0x3df0b772a553c9ca,0x3eb136413e6f0c4d
.quad 0x3f6b8a3d3f6c835e,0x3f6986903f6a8b4b,0xbedae880bec3ef15,0xbf039c3dbef15aea,0xbf62f219bf6c835e,0xbf4a965ebf579b8c,0x3efe8c2f3ec3ef15,0x3f333bc63f1a82a4
.quad 0x3f316e2c3f3504f3,0x3f2a0c733f2dc5e3,0xbf3f5cb5bf3504f3,0xbf5205d4bf490a88,0xbf226799bf3504f3,0xbef15aeabf0e39da,0x3f4c1d353f3504f3,0x3f6e641a3f5f5be6
.quad 0x3eb5eb4f3ec3ef15,0x3e996dba3ea7bf25,0xbf72ae9ebf6c835e,0xbf7b8f2abf77b493,0xbe8fcefebec3ef15,0xbd8ca1f2be3403f1,0x3f7853f83f6c835e,0x3f7fb10f3f7ec46d
.quad 0x3f8000003f800000,0x3f8000003f800000,0xbe47c5c2be20305b,0xbe8afa3ebe6f0c4d,0xbf6c835ebf737871,0xbf5a46a0bf641901,0x3f0e39da3ee87171,0x3f3bfc8f3f26423a
.quad 0x3f676bd83f687c12,0x3f653a483f6655e7,0xbf187fc0bf0e39da,0xbf2beb4abf226799,0xbf2beb4abf3bfc8f,0xbf07e565bf1a82a4,0x3f5b941a3f490a88,0x3f75b1c93f6a8b4b
.quad 0x3f2267993f26423a,0x3f1a82a43f1e7cf1,0xbf61c598bf5a46a0,0xbf6e641abf687c12,0xbe94a031bec3ef15,0xbdc8bd36be47c5c2,0x3f7ec46d3f78ed3c,0x3f7c03613f7fcd79
.quad 0x3e78cfcc3e8afa3e,0x3e3de7313e5b73dc,0xbf7fb10fbf7e39bc,0xbf7f0059bf7ff35e,0x3e1640833d20cee7,0x3eb5eb4f3e814693,0x3f7109083f7b14be,0x3f4d9f023f61c598
.quad 0x0,0x0,0x3f7663773f737871,0x3f7b14be3f78ed3c,0x3f05c2773f167918,0x3ec3ef153ee87171,0xbf2dc5e3bf167918,0xbf54db31bf42a9f7
.quad 0x3ea2fd523e9e377a,0x3eac7cd43ea7bf25,0x3f7fb10f3f800000,0x3f7d3aac3f7ec46d,0x3e6542e93e9e377a,0x3d48fb303e0c4cf7,0xbf609384bf4f1bbd,0xbf7853f8bf6e641a
.quad 0x3f1a82a43f167918,0x3f2267993f1e7cf1,0x3f6e641a3f737871,0x3f61c5983f687c12,0xbdc8bd36250d3132,0xbe94a031be47c5c2,0xbf7c0361bf737871,0xbf7ec46dbf7fcd79
.quad 0x3f53731f3f4f1bbd,0x3f5b941a3f579b8c,0x3f4449693f4f1bbd,0x3f2beb4a3f3889dc,0xbed1c759be9e377a,0xbf187fc0bf0172c3,0xbf7d3aacbf800000,0xbf676bd8bf74fa0b
.quad 0x0,0x0,0x3f7e39bc3f7cd925,0x3f7fcd793f7f35f9,0x3e6f0c4d3e9e377a,0x3da0af2a3e20305b,0xbf702d4fbf641901,0xbf7e39bcbf78ed3c
.quad 0x3eb5eb4f3eb13641,0x3ebf47d73eba9be1,0x3f7853f83f7b14be,0x3f7109083f74fa0b,0xbe0255f4bd20cee7,0xbe996dbabe5b73dc,0xbf7ffcd7bf7e39bc,0xbf770f11bf7d95f4
.quad 0x3f2a0c733f26423a,0x3f316e2c3f2dc5e3,0x3f5205d43f5a46a0,0x3f3f5cb53f490a88,0xbef15aeabec3ef15,0xbf226799bf0e39da,0xbf6e641abf78ed3c,0xbf4c1d35bf5f5be6
.quad 0x3f62f2193f5f5be6,0x3f6986903f6655e7,0x3f104f0e3f1e7cf1,0x3ee3f40d3f0172c3,0xbf4105b8bf2dc5e3,0xbf609384bf5205d4,0xbf3daef9bf54db31,0xbf039c3dbf226799
.quad 0x0,0x0,0x3f7fcd793f800000,0x3f7e39bc3f7f35f9,0xbda0af2a250d3132,0xbe6f0c4dbe20305b,0xbf7e39bcbf800000,0xbf702d4fbf78ed3c
.quad 0x3ec8917e3ec3ef15,0x3ed1c7593ecd2ef3,0x3f676bd83f6c835e,0x3f5b941a3f61c598,0xbeece91abec3ef15,0xbf1c81b9bf0a04f8,0xbf5e1ec5bf6c835e,0xbf36c9a9bf4c1d35
.quad 0x3f3889dc3f3504f3,0x3f3f5cb53f3bfc8f,0x3f2a0c733f3504f3,0x3f1260b23f1e7cf1,0xbf45e403bf3504f3,0xbf61c598bf54db31,0xbf1a82a4bf3504f3,0xbeba9be1befa2c90
.quad 0x3f6f4ba83f6c835e,0x3f743c413f71decf,0x3ea2fd523ec3ef15,0x3e3de7313e814693,0xbf75b1c9bf6c835e,0xbf7f654ebf7c0361,0xbe78cfccbec3ef15,0x3d48fb30bdc8bd36
.quad 0x0,0x0,0x3f7b14be3f7cd925,0x3f7663773f78ed3c,0xbec3ef15be9e377a,0xbf05c277bee87171,0xbf54db31bf641901,0xbf2dc5e3bf42a9f7
.quad 0x3edae8803ed65a92,0x3ee3f40d3edf7108,0x3f4d9f023f54db31,0x3f3daef93f45e403,0xbf3daef9bf2dc5e3,0xbf58f3c4bf4c1d35,0xbf039c3dbf1e7cf1,0xbe8fcefebecd2ef3
.quad 0x3f45e4033f42a9f7,0x3f4c1d353f490a88,0x3ef15aea3f05c277,0x3eba9be13ed65a92,0xbf74fa0bbf6c835e,0xbf7ec46dbf7b14be,0xbdc8bd36be6f0c4d,0x3e3403f13d20cee7
.quad 0x3f7853f83f766377,0x3f7b8f2a3f7a0d54,0x3d48fb303df0b772,0xbdb4b86abca0d6d6,0xbf7d3aacbf7fcd79,0xbf6f4ba8bf77b493,0x3eac7cd43e47c5c2,0x3f187fc03ef15aea
.quad 0x3f803f803f803f80,0x0,0x3f643f733f7d3f80,0x3ee83e9e3e200000,0x3f163f4f3f733f80,0x3f4f3f163e9e0000,0x3e203f163f643f80,0x3f7d3f4f3ee80000
.quad 0xbe9e3e9e3f4f3f80,0x3f733f733f160000,0xbf35248d3f353f80,0x3f353f803f350000,0xbf73be9e3f163f80,0x3e9e3f733f4f0000,0xbf7dbf163ee83f80,0xbe203f4f3f640000
.quad 0xbf4fbf4f3e9e3f80,0xbf163f163f730000,0xbee8bf733e203f80,0xbf643e9e3f7d0000,0xa554bf80248d3f80,0xbf80250d3f800000,0x3ee8bf73be203f80,0xbf64be9e3f7d0000
.quad 0x3f4fbf4fbe9e3f80,0xbf16bf163f730000,0x3f7dbf16bee83f80,0xbe20bf4f3f640000,0x3f73be9ebf163f80,0x3e9ebf733f4f0000,0x3f35a554bf353f80,0x3f35bf803f350000
.quad 0x3f803f803f803f80,0x0,0x3ee83f163f353f4f,0x3f643f4f3f353f16,0xbf16be9e248d3e9e,0x3f4f3f733f803f73,0xbf7dbf73bf35be9e,0xbe203e9e3f353f73
.quad 0xbe9ebf4fbf80bf4f,0xbf73bf16250d3f16,0x3f35a554bf35bf80,0xbf35bf80bf35250d,0x3f733f4fa554bf4f,0x3e9ebf16bf80bf16,0x3e203f733f35be9e,0x3f7d3e9ebf35bf73
.quad 0xbf4f3e9e3f803e9e,0x3f163f730000bf73,0xbf64bf163f353f4f,0xbee83f4f3f35bf16,0xa554bf80248d3f80,0xbf80250d3f800000,0x3f64bf16bf353f4f,0xbee8bf4f3f353f16
.quad 0x3f4f3e9ebf803e9e,0x3f16bf73250d3f73,0xbe203f73bf35be9e,0x3f7dbe9ebf353f73,0xbf733f4fa554bf4f,0x3e9e3f16bf803f16,0xbf35248d3f35bf80,0xbf353f80bf35250d
.quad 0x3f803f803f803f80,0x0,0xbe20248d3e203e9e,0x3f7d3f803f7d3f73,0xbf73bf80bf73bf4f,0xbe9e250d3e9e3f16,0x3ee8a554bee8bf4f,0xbf64bf80bf64bf16
.quad 0x3f4f3f803f4f3e9e,0x3f160000bf16bf73,0xbf35248d3f353f80,0x3f353f803f350000,0xbf16bf80bf163e9e,0xbf4f250d3f4f3f73,0x3f64a554bf64bf4f,0xbee8bf80bee83f16
.quad 0x3e9e3f803e9ebf4f,0x3f730000bf73bf16,0xbf7d248d3f7d3e9e,0x3e203f803e20bf73,0xa554bf80248d3f80,0xbf80250d3f800000,0x3f7da554bf7d3e9e,0x3e20bf803e203f73
.quad 0xbe9e3f80be9ebf4f,0x3f730000bf733f16,0xbf64248d3f64bf4f,0xbee83f80bee8bf16,0x3f16bf803f163e9e,0xbf4f250d3f4fbf73,0x3f35a554bf353f80,0x3f35bf803f350000
.quad 0x3f803f803f803f80,0x0,0xbf35bf16bee8be9e,0x3f353f4f3f643f73,0xa554be9ebf16bf4f,0xbf80bf73bf4fbf16,0x3f353f733f7d3f4f,0x3f353e9ebe20bf16
.quad 0xbf80bf4fbe9e3e9e,0x250d3f163f733f73,0x3f35a554bf35bf80,0xbf35bf80bf35250d,0x248d3f4f3f733e9e,0x3f803f16be9ebf73,0xbf35bf73be203f4f,0xbf353e9e3f7d3f16
.quad 0x3f803e9ebf4fbf4f,0xbf73bf163f16,0xbf353f163f64be9e,0x3f353f4fbee8bf73,0xa554bf80248d3f80,0xbf80250d3f800000,0x3f353f16bf64be9e,0x3f35bf4fbee83f73
.quad 0xbf803e9e3f4fbf4f,0x250d3f73bf16bf16,0x3f35bf733e203f4f,0xbf35be9e3f7dbf16,0x248d3f4fbf733e9e,0x3f80bf16be9e3f73,0xbf35248d3f35bf80,0xbf353f80bf35250d
.quad 0x3e9e3e9ebf4f3f80,0x3f73bf733f160000,0xbe203f16bf643f80,0x3f7dbf4f3ee80000,0xbf163f4fbf733f80,0x3f4fbf163e9e0000,0xbf643f73bf7d3f80,0x3ee8be9e3e200000
.quad 0xbf803f80bf803f80,0x250d0000250d0000,0xbf643f73bf7d3f80,0xbee83e9ebe200000,0xbf163f4fbf733f80,0xbf4f3f16be9e0000,0xbe203f16bf643f80,0xbf7d3f4fbee80000
.quad 0x3e9e3e9ebf4f3f80,0xbf733f73bf160000,0x3f35248dbf353f80,0xbf353f80bf350000,0x3f73be9ebf163f80,0xbe9e3f73bf4f0000,0x3f7dbf16bee83f80,0x3e203f4fbf640000
.quad 0x3f4fbf4fbe9e3f80,0x3f163f16bf730000,0x3ee8bf73be203f80,0x3f643e9ebf7d0000,0x248dbf80a5543f80,0x3f80250dbf800000,0xbee8bf733e203f80,0x3f64be9ebf7d0000
.quad 0x3e9ebf4f3f80bf4f,0xbf733f160000bf16,0x3f7dbf733f35be9e,0xbe20be9e3f35bf73,0x3f16be9e248d3e9e,0x3f4fbf733f80bf73,0xbee83f16bf353f4f,0x3f64bf4f3f35bf16
.quad 0xbf803f80bf803f80,0x250d0000250d0000,0xbee83f16bf353f4f,0xbf643f4fbf353f16,0x3f16be9ea5543e9e,0xbf4f3f73bf803f73,0x3f7dbf733f35be9e,0x3e203e9ebf353f73
.quad 0x3e9ebf4f3f80bf4f,0x3f73bf1600003f16,0xbf35a5543f35bf80,0x3f35bf803f35250d,0xbf733f4f248dbf4f,0xbe9ebf163f80bf16,0xbe203f73bf35be9e,0xbf7d3e9e3f35bf73
.quad 0x3f4f3e9ebf803e9e,0xbf163f73250dbf73,0x3f64bf16bf353f4f,0x3ee83f4fbf35bf16,0x248dbf80a5543f80,0x3f80250dbf800000,0xbf64bf163f353f4f,0x3ee8bf4fbf353f16
.quad 0xbf4f3f80bf4f3e9e,0x3f160000bf163f73,0xbee8248d3ee8bf4f,0xbf643f80bf643f16,0x3f73bf803f73bf4f,0xbe9e250d3e9ebf16,0x3e20a554be203e9e,0x3f7dbf803f7dbf73
.quad 0xbf803f80bf803f80,0x250d0000250d0000,0x3e20248dbe203e9e,0xbf7d3f80bf7d3f73,0x3f73bf803f73bf4f,0x3e9e250dbe9e3f16,0xbee8a5543ee8bf4f,0x3f64bf803f64bf16
.quad 0xbf4f3f80bf4f3e9e,0xbf1600003f16bf73,0x3f35248dbf353f80,0xbf353f80bf350000,0x3f16bf803f163e9e,0x3f4f250dbf4f3f73,0xbf64a5543f64bf4f,0x3ee8bf803ee83f16
.quad 0xbe9e3f80be9ebf4f,0xbf7300003f73bf16,0x3f7d248dbf7d3e9e,0xbe203f80be20bf73,0x248dbf80a5543f80,0x3f80250dbf800000,0xbf7da5543f7d3e9e,0xbe20bf80be203f73
.quad 0x3f80bf4f3e9e3e9e,0xbf163f73bf73,0xbf353f73bf7d3f4f,0x3f35be9ebe203f16,0xa554be9e3f16bf4f,0xbf803f73bf4f3f16,0x3f35bf163ee8be9e,0x3f35bf4f3f64bf73
.quad 0xbf803f80bf803f80,0x250d0000250d0000,0x3f35bf163ee8be9e,0xbf353f4fbf643f73,0x248dbe9e3f16bf4f,0x3f80bf733f4fbf16,0xbf353f73bf7d3f4f,0xbf353e9e3e20bf16
.quad 0x3f80bf4f3e9e3e9e,0x3f16bf733f73,0xbf35a5543f35bf80,0x3f35bf803f35250d,0xa5543f4fbf733e9e,0xbf803f163e9ebf73,0x3f35bf733e203f4f,0x3f353e9ebf7d3f16
.quad 0xbf803e9e3f4fbf4f,0x250dbf733f163f16,0x3f353f16bf64be9e,0xbf353f4f3ee8bf73,0x248dbf80a5543f80,0x3f80250dbf800000,0xbf353f163f64be9e,0xbf35bf4f3ee83f73
.quad 0xbf4fbf4f3e9e3f80,0x3f16bf16bf730000,0xbf7dbf163ee83f80,0x3e20bf4fbf640000,0xbf73be9e3f163f80,0xbe9ebf73bf4f0000,0xbf35a5543f353f80,0xbf35bf80bf350000
.quad 0xbe9e3e9e3f4f3f80,0xbf73bf73bf160000,0x3e203f163f643f80,0xbf7dbf4fbee80000,0x3f163f4f3f733f80,0xbf4fbf16be9e0000,0x3f643f733f7d3f80,0xbee8be9ebe200000
.quad 0x0,0x0,0x0,0x0,0x0,0x0,0x0,0x0
.quad 0x0,0x0,0x0,0x0,0x0,0x0,0x0,0x0
.quad 0xbf4f3e9e3f803e9e,0xbf16bf7300003f73,0x3e203f733f35be9e,0xbf7dbe9e3f353f73,0x3f733f4f248dbf4f,0xbe9e3f163f803f16,0x3f35248dbf35bf80,0x3f353f803f35250d
.quad 0xbe9ebf4fbf80bf4f,0x3f733f16250dbf16,0xbf7dbf73bf35be9e,0x3e20be9ebf35bf73,0xbf16be9ea5543e9e,0xbf4fbf73bf80bf73,0x3ee83f163f353f4f,0xbf64bf4fbf35bf16
.quad 0x0,0x0,0x0,0x0,0x0,0x0,0x0,0x0
.quad 0x0,0x0,0x0,0x0,0x0,0x0,0x0,0x0
.quad 0x3e9e3f803e9ebf4f,0xbf7300003f733f16,0x3f64248dbf64bf4f,0x3ee83f803ee8bf16,0xbf16bf80bf163e9e,0x3f4f250dbf4fbf73,0xbf35a5543f353f80,0xbf35bf80bf350000
.quad 0x3f4f3f803f4f3e9e,0xbf1600003f163f73,0x3ee8248dbee8bf4f,0x3f643f803f643f16,0xbf73bf80bf73bf4f,0x3e9e250dbe9ebf16,0xbe20a5543e203e9e,0xbf7dbf80bf7dbf73
.quad 0x0,0x0,0x0,0x0,0x0,0x0,0x0,0x0
.quad 0x0,0x0,0x0,0x0,0x0,0x0,0x0,0x0
.quad 0x3f803e9ebf4fbf4f,0x3f733f16bf16,0xbf35bf73be203f4f,0x3f35be9ebf7dbf16,0xa5543f4f3f733e9e,0xbf80bf163e9e3f73,0x3f35248dbf35bf80,0x3f353f803f35250d
.quad 0xbf80bf4fbe9e3e9e,0x250dbf16bf73bf73,0x3f353f733f7d3f4f,0xbf35be9e3e203f16,0x248dbe9ebf16bf4f,0x3f803f733f4f3f16,0xbf35bf16bee8be9e,0xbf35bf4fbf64bf73
.quad 0x0,0x0,0x0,0x0,0x0,0x0,0x0,0x0
.quad 0x0,0x0,0x0,0x0,0x0,0x0,0x0,0x0
.quad 0x3f803f803f803f80,0x0,0xbf7dbf73bf64bf4f,0x3e203e9e3ee83f16,0x3f733f4f3f163e9e,0xbe9ebf16bf4fbf73,0xbf64bf16be203e9e,0x3ee83f4f3f7d3f73
.quad 0x3f4f3e9ebe9ebf4f,0xbf16bf73bf73bf16,0xbf35248d3f353f80,0x3f353f803f350000,0x3f16be9ebf73bf4f,0xbf4fbf73be9e3f16,0xbee83f163f7d3e9e,0x3f643f4fbe20bf73
.quad 0x3e9ebf4fbf4f3e9e,0xbf73bf163f163f73,0xbe203f733ee8bf4f,0x3f7d3e9ebf64bf16,0xa554bf80248d3f80,0xbf80250d3f800000,0x3e203f73bee8bf4f,0x3f7dbe9ebf643f16
.quad 0xbe9ebf4f3f4f3e9e,0xbf733f163f16bf73,0x3ee83f16bf7d3e9e,0x3f64bf4fbe203f73,0xbf16be9e3f73bf4f,0xbf4f3f73be9ebf16,0x3f35a554bf353f80,0x3f35bf803f350000
.quad 0x3f803f803f803f80,0x0,0xbf64bf73bf7dbf80,0xbee8be9ebe20250d,0x3f163f4f3f733f80,0x3f4f3f163e9e0000,0xbe20bf16bf64bf80,0xbf7dbf4fbee8250d
.quad 0xbe9e3e9e3f4f3f80,0x3f733f733f160000,0x3f35a554bf35bf80,0xbf35bf80bf35250d,0xbf73be9e3f163f80,0x3e9e3f733f4f0000,0x3f7d3f16bee8bf80,0x3e20bf4fbf64250d
.quad 0xbf4fbf4f3e9e3f80,0xbf163f163f730000,0x3ee83f73be20bf80,0x3f64be9ebf7d250d,0xa554bf80248d3f80,0xbf80250d3f800000,0xbee83f733e20bf80,0x3f643e9ebf7d250d
.quad 0x3f4fbf4fbe9e3f80,0xbf16bf163f730000,0xbf7d3f163ee8bf80,0x3e203f4fbf64250d,0x3f73be9ebf163f80,0x3e9ebf733f4f0000,0xbf35248d3f35bf80,0xbf353f80bf35250d
.quad 0x3f803f803f803f80,0x0,0xbee8bf16bf35bf4f,0xbf64bf4fbf35bf16,0xbf16be9e248d3e9e,0x3f4f3f733f803f73,0x3f7d3f733f353e9e,0x3e20be9ebf35bf73
.quad 0xbe9ebf4fbf80bf4f,0xbf73bf16250d3f16,0xbf35248d3f353f80,0x3f353f803f350000,0x3f733f4fa554bf4f,0x3e9ebf16bf80bf16,0xbe20bf73bf353e9e,0xbf7dbe9e3f353f73
.quad 0xbf4f3e9e3f803e9e,0x3f163f730000bf73,0x3f643f16bf35bf4f,0x3ee8bf4fbf353f16,0xa554bf80248d3f80,0xbf80250d3f800000,0xbf643f163f35bf4f,0x3ee83f4fbf35bf16
.quad 0x3f4f3e9ebf803e9e,0x3f16bf73250d3f73,0x3e20bf733f353e9e,0xbf7d3e9e3f35bf73,0xbf733f4fa554bf4f,0x3e9e3f16bf803f16,0x3f35a554bf353f80,0x3f35bf803f350000
.quad 0x3f803f803f803f80,0x0,0x3e20a554be20be9e,0xbf7dbf80bf7dbf73,0xbf73bf80bf73bf4f,0xbe9e250d3e9e3f16,0xbee8248d3ee83f4f,0x3f643f803f643f16
.quad 0x3f4f3f803f4f3e9e,0x3f160000bf16bf73,0x3f35a554bf35bf80,0xbf35bf80bf35250d,0xbf16bf80bf163e9e,0xbf4f250d3f4f3f73,0xbf64248d3f643f4f,0x3ee83f803ee8bf16
.quad 0x3e9e3f803e9ebf4f,0x3f730000bf73bf16,0x3f7da554bf7dbe9e,0xbe20bf80be203f73,0xa554bf80248d3f80,0xbf80250d3f800000,0xbf7d248d3f7dbe9e,0xbe203f80be20bf73
.quad 0xbe9e3f80be9ebf4f,0x3f730000bf733f16,0x3f64a554bf643f4f,0x3ee8bf803ee83f16,0x3f16bf803f163e9e,0xbf4f250d3f4fbf73,0xbf35248d3f35bf80,0xbf353f80bf35250d
.quad 0xbf4f3e9e3e9ebf4f,0xbf163f73bf733f16,0x3f64bf163e203e9e,0x3ee8bf4f3f7dbf73,0xbf733f4fbf163e9e,0xbe9e3f16bf4f3f73,0x3f7dbf733f64bf4f,0x3e20be9e3ee8bf16
.quad 0xbf803f80bf803f80,0x250d0000250d0000,0x3f7dbf733f64bf4f,0xbe203e9ebee83f16,0xbf733f4fbf163e9e,0x3e9ebf163f4fbf73,0x3f64bf163e203e9e,0xbee83f4fbf7d3f73
.quad 0xbf4f3e9e3e9ebf4f,0x3f16bf733f73bf16,0x3f35248dbf353f80,0xbf353f80bf350000,0xbf16be9e3f73bf4f,0x3f4fbf733e9e3f16,0x3ee83f16bf7d3e9e,0xbf643f4f3e20bf73
.quad 0xbe9ebf4f3f4f3e9e,0x3f73bf16bf163f73,0x3e203f73bee8bf4f,0xbf7d3e9e3f64bf16,0x248dbf80a5543f80,0x3f80250dbf800000,0xbe203f733ee8bf4f,0xbf7dbe9e3f643f16
.quad 0x3e9e3e9ebf4f3f80,0x3f73bf733f160000,0x3e20bf163f64bf80,0xbf7d3f4fbee8250d,0xbf163f4fbf733f80,0x3f4fbf163e9e0000,0x3f64bf733f7dbf80,0xbee83e9ebe20250d
.quad 0xbf803f80bf803f80,0x250d0000250d0000,0x3f64bf733f7dbf80,0x3ee8be9e3e20250d,0xbf163f4fbf733f80,0xbf4f3f16be9e0000,0x3e20bf163f64bf80,0x3f7dbf4f3ee8250d
.quad 0x3e9e3e9ebf4f3f80,0xbf733f73bf160000,0xbf35a5543f35bf80,0x3f35bf803f35250d,0x3f73be9ebf163f80,0xbe9e3f73bf4f0000,0xbf7d3f163ee8bf80,0xbe20bf4f3f64250d
.quad 0x3f4fbf4fbe9e3f80,0x3f163f16bf730000,0xbee83f733e20bf80,0xbf64be9e3f7d250d,0x248dbf80a5543f80,0x3f80250dbf800000,0x3ee83f73be20bf80,0xbf643e9e3f7d250d
.quad 0x3e9ebf4f3f80bf4f,0xbf733f160000bf16,0xbf7d3f73bf353e9e,0x3e203e9ebf353f73,0x3f16be9e248d3e9e,0x3f4fbf733f80bf73,0x3ee8bf163f35bf4f,0xbf643f4fbf353f16
.quad 0xbf803f80bf803f80,0x250d0000250d0000,0x3ee8bf163f35bf4f,0x3f64bf4f3f35bf16,0x3f16be9ea5543e9e,0xbf4f3f73bf803f73,0xbf7d3f73bf353e9e,0xbe20be9e3f35bf73
.quad 0x3e9ebf4f3f80bf4f,0x3f73bf1600003f16,0x3f35248dbf353f80,0xbf353f80bf350000,0xbf733f4f248dbf4f,0xbe9ebf163f80bf16,0x3e20bf733f353e9e,0x3f7dbe9ebf353f73
.quad 0x3f4f3e9ebf803e9e,0xbf163f73250dbf73,0xbf643f163f35bf4f,0xbee8bf4f3f353f16,0x248dbf80a5543f80,0x3f80250dbf800000,0x3f643f16bf35bf4f,0xbee83f4f3f35bf16
.quad 0xbf4f3f80bf4f3e9e,0x3f160000bf163f73,0x3ee8a554bee83f4f,0x3f64bf803f64bf16,0x3f73bf803f73bf4f,0xbe9e250d3e9ebf16,0xbe20248d3e20be9e,0xbf7d3f80bf7d3f73
.quad 0xbf803f80bf803f80,0x250d0000250d0000,0xbe20a5543e20be9e,0x3f7dbf803f7dbf73,0x3f73bf803f73bf4f,0x3e9e250dbe9e3f16,0x3ee8248dbee83f4f,0xbf643f80bf643f16
.quad 0xbf4f3f80bf4f3e9e,0xbf1600003f16bf73,0xbf35a5543f35bf80,0x3f35bf803f35250d,0x3f16bf803f163e9e,0x3f4f250dbf4f3f73,0x3f64248dbf643f4f,0xbee83f80bee8bf16
.quad 0xbe9e3f80be9ebf4f,0xbf7300003f73bf16,0xbf7da5543f7dbe9e,0x3e20bf803e203f73,0x248dbf80a5543f80,0x3f80250dbf800000,0x3f7d248dbf7dbe9e,0x3e203f803e20bf73
.quad 0x3e9ebf4fbf4f3e9e,0x3f733f16bf16bf73,0xbee83f163f7d3e9e,0xbf64bf4f3e203f73,0x3f16be9ebf73bf4f,0x3f4f3f733e9ebf16,0xbf35a5543f353f80,0xbf35bf80bf350000
.quad 0x3f4f3e9ebe9ebf4f,0x3f163f733f733f16,0xbf64bf16be203e9e,0xbee8bf4fbf7dbf73,0x3f733f4f3f163e9e,0x3e9e3f163f4f3f73,0xbf7dbf73bf64bf4f,0xbe20be9ebee8bf16
.quad 0x0,0x0,0x0,0x0,0x0,0x0,0x0,0x0
.quad 0x0,0x0,0x0,0x0,0x0,0x0,0x0,0x0
.quad 0xbf4fbf4f3e9e3f80,0x3f16bf16bf730000,0x3f7d3f16bee8bf80,0xbe203f4f3f64250d,0xbf73be9e3f163f80,0xbe9ebf73bf4f0000,0x3f35248dbf35bf80,0x3f353f803f35250d
.quad 0xbe9e3e9e3f4f3f80,0xbf73bf73bf160000,0xbe20bf16bf64bf80,0x3f7d3f4f3ee8250d,0x3f163f4f3f733f80,0xbf4fbf16be9e0000,0xbf64bf73bf7dbf80,0x3ee83e9e3e20250d
.quad 0x0,0x0,0x0,0x0,0x0,0x0,0x0,0x0
.quad 0x0,0x0,0x0,0x0,0x0,0x0,0x0,0x0
.quad 0xbf4f3e9e3f803e9e,0xbf16bf7300003f73,0xbe20bf73bf353e9e,0x3f7d3e9ebf35bf73,0x3f733f4f248dbf4f,0xbe9e3f163f803f16,0xbf35a5543f353f80,0xbf35bf80bf350000
.quad 0xbe9ebf4fbf80bf4f,0x3f733f16250dbf16,0x3f7d3f733f353e9e,0xbe203e9e3f353f73,0xbf16be9ea5543e9e,0xbf4fbf73bf80bf73,0xbee8bf16bf35bf4f,0x3f643f4f3f353f16
.quad 0x0,0x0,0x0,0x0,0x0,0x0,0x0,0x0
.quad 0x0,0x0,0x0,0x0,0x0,0x0,0x0,0x0
.quad 0x3e9e3f803e9ebf4f,0xbf7300003f733f16,0xbf64a5543f643f4f,0xbee8bf80bee83f16,0xbf16bf80bf163e9e,0x3f4f250dbf4fbf73,0x3f35248dbf35bf80,0x3f353f803f35250d
.quad 0x3f4f3f803f4f3e9e,0xbf1600003f163f73,0xbee8a5543ee83f4f,0xbf64bf80bf64bf16,0xbf73bf80bf73bf4f,0x3e9e250dbe9ebf16,0x3e20248dbe20be9e,0x3f7d3f803f7d3f73
.quad 0x0,0x0,0x0,0x0,0x0,0x0,0x0,0x0
.quad 0x0,0x0,0x0,0x0,0x0,0x0,0x0,0x0
.quad 0x3f803f803f803f80,0x0,0x3f353f163ee83e9e,0xbf35bf4fbf64bf73,0xa554be9ebf16bf4f,0xbf80bf73bf4fbf16,0xbf35bf73bf7dbf4f,0xbf35be9e3e203f16
.quad 0xbf80bf4fbe9e3e9e,0x250d3f163f733f73,0xbf35248d3f353f80,0x3f353f803f350000,0x248d3f4f3f733e9e,0x3f803f16be9ebf73,0x3f353f733e20bf4f,0x3f35be9ebf7dbf16
.quad 0x3f803e9ebf4fbf4f,0xbf73bf163f16,0x3f35bf16bf643e9e,0xbf35bf4f3ee83f73,0xa554bf80248d3f80,0xbf80250d3f800000,0xbf35bf163f643e9e,0xbf353f4f3ee8bf73
.quad 0xbf803e9e3f4fbf4f,0x250d3f73bf16bf16,0xbf353f73be20bf4f,0x3f353e9ebf7d3f16,0x248d3f4fbf733e9e,0x3f80bf16be9e3f73,0x3f35a554bf353f80,0x3f35bf803f350000
.quad 0x3f803f803f803f80,0x0,0x3f7d3f733f643f4f,0xbe20be9ebee8bf16,0x3f733f4f3f163e9e,0xbe9ebf16bf4fbf73,0x3f643f163e20be9e,0xbee8bf4fbf7dbf73
.quad 0x3f4f3e9ebe9ebf4f,0xbf16bf73bf73bf16,0x3f35a554bf35bf80,0xbf35bf80bf35250d,0x3f16be9ebf73bf4f,0xbf4fbf73be9e3f16,0x3ee8bf16bf7dbe9e,0xbf64bf4f3e203f73
.quad 0x3e9ebf4fbf4f3e9e,0xbf73bf163f163f73,0x3e20bf73bee83f4f,0xbf7dbe9e3f643f16,0xa554bf80248d3f80,0xbf80250d3f800000,0xbe20bf733ee83f4f,0xbf7d3e9e3f64bf16
.quad 0xbe9ebf4f3f4f3e9e,0xbf733f163f16bf73,0xbee8bf163f7dbe9e,0xbf643f4f3e20bf73,0xbf16be9e3f73bf4f,0xbf4f3f73be9ebf16,0xbf35248d3f35bf80,0xbf353f80bf35250d
.quad 0x0,0x0,0x0,0x0,0x0,0x0,0x0,0x0
.quad 0x0,0x0,0x0,0x0,0x0,0x0,0x0,0x0
.quad 0x0,0x0,0x0,0x0,0x0,0x0,0x0,0x0
.quad 0x0,0x0,0x0,0x0,0x0,0x0,0x0,0x0
.quad 0x0,0x0,0x0,0x0,0x0,0x0,0x0,0x0
.quad 0x0,0x0,0x0,0x0,0x0,0x0,0x0,0x0
.quad 0x0,0x0,0x0,0x0,0x0,0x0,0x0,0x0
.quad 0x0,0x0,0x0,0x0,0x0,0x0,0x0,0x0
.quad 0x3f80bf4f3e9e3e9e,0xbf163f73bf73,0x3f35bf733f7dbf4f,0xbf353e9e3e20bf16,0xa554be9e3f16bf4f,0xbf803f73bf4f3f16,0xbf353f16bee83e9e,0xbf353f4fbf643f73
.quad 0xbf803f80bf803f80,0x250d0000250d0000,0xbf353f16bee83e9e,0x3f35bf4f3f64bf73,0x248dbe9e3f16bf4f,0x3f80bf733f4fbf16,0x3f35bf733f7dbf4f,0x3f35be9ebe203f16
.quad 0x3f80bf4f3e9e3e9e,0x3f16bf733f73,0x3f35248dbf353f80,0xbf353f80bf350000,0xa5543f4fbf733e9e,0xbf803f163e9ebf73,0xbf353f73be20bf4f,0xbf35be9e3f7dbf16
.quad 0xbf803e9e3f4fbf4f,0x250dbf733f163f16,0xbf35bf163f643e9e,0x3f35bf4fbee83f73,0x248dbf80a5543f80,0x3f80250dbf800000,0x3f35bf16bf643e9e,0x3f353f4fbee8bf73
.quad 0xbf4f3e9e3e9ebf4f,0xbf163f73bf733f16,0xbf643f16be20be9e,0xbee83f4fbf7d3f73,0xbf733f4fbf163e9e,0xbe9e3f16bf4f3f73,0xbf7d3f73bf643f4f,0xbe203e9ebee83f16
.quad 0xbf803f80bf803f80,0x250d0000250d0000,0xbf7d3f73bf643f4f,0x3e20be9e3ee8bf16,0xbf733f4fbf163e9e,0x3e9ebf163f4fbf73,0xbf643f16be20be9e,0x3ee8bf4f3f7dbf73
.quad 0xbf4f3e9e3e9ebf4f,0x3f16bf733f73bf16,0xbf35a5543f35bf80,0x3f35bf803f35250d,0xbf16be9e3f73bf4f,0x3f4fbf733e9e3f16,0xbee8bf163f7dbe9e,0x3f64bf4fbe203f73
.quad 0xbe9ebf4f3f4f3e9e,0x3f73bf16bf163f73,0xbe20bf733ee83f4f,0x3f7dbe9ebf643f16,0x248dbf80a5543f80,0x3f80250dbf800000,0x3e20bf73bee83f4f,0x3f7d3e9ebf64bf16
.quad 0x0,0x0,0x0,0x0,0x0,0x0,0x0,0x0
.quad 0x0,0x0,0x0,0x0,0x0,0x0,0x0,0x0
.quad 0x0,0x0,0x0,0x0,0x0,0x0,0x0,0x0
.quad 0x0,0x0,0x0,0x0,0x0,0x0,0x0,0x0
.quad 0x0,0x0,0x0,0x0,0x0,0x0,0x0,0x0
.quad 0x0,0x0,0x0,0x0,0x0,0x0,0x0,0x0
.quad 0x0,0x0,0x0,0x0,0x0,0x0,0x0,0x0
.quad 0x0,0x0,0x0,0x0,0x0,0x0,0x0,0x0
.quad 0x3f803e9ebf4fbf4f,0x3f733f16bf16,0x3f353f733e20bf4f,0xbf353e9e3f7d3f16,0xa5543f4f3f733e9e,0xbf80bf163e9e3f73,0xbf35a5543f353f80,0xbf35bf80bf350000
.quad 0xbf80bf4fbe9e3e9e,0x250dbf16bf73bf73,0xbf35bf73bf7dbf4f,0x3f353e9ebe20bf16,0x248dbe9ebf16bf4f,0x3f803f733f4f3f16,0x3f353f163ee83e9e,0x3f353f4f3f643f73
.quad 0x0,0x0,0x0,0x0,0x0,0x0,0x0,0x0
.quad 0x0,0x0,0x0,0x0,0x0,0x0,0x0,0x0
.quad 0x3e9ebf4fbf4f3e9e,0x3f733f16bf16bf73,0x3ee8bf16bf7dbe9e,0x3f643f4fbe20bf73,0x3f16be9ebf73bf4f,0x3f4f3f733e9ebf16,0x3f35248dbf35bf80,0x3f353f803f35250d
.quad 0x3f4f3e9ebe9ebf4f,0x3f163f733f733f16,0x3f643f163e20be9e,0x3ee83f4f3f7d3f73,0x3f733f4f3f163e9e,0x3e9e3f163f4f3f73,0x3f7d3f733f643f4f,0x3e203e9e3ee83f16
.quad 0x0,0x0,0x0,0x0,0x0,0x0,0x0,0x0
.quad 0x0,0x0,0x0,0x0,0x0,0x0,0x0,0x0
.quad 0x0,0x0,0x0,0x0,0x0,0x0,0x0,0x0
.quad 0x0,0x0,0x0,0x0,0x0,0x0,0x0,0x0
.quad 0x0,0x0,0x0,0x0,0x0,0x0,0x0,0x0
.quad 0x0,0x0,0x0,0x0,0x0,0x0,0x0,0x0
.quad 0x0,0x0,0x0,0x0,0x0,0x0,0x0,0x0
.quad 0x0,0x0,0x0,0x0,0x0,0x0,0x0,0x0
.quad 0x0,0x0,0x0,0x0,0x0,0x0,0x0,0x0
.quad 0x0,0x0,0x0,0x0,0x0,0x0,0x0,0x0

.size TBL1, .-TBL1
PF_END:
.section .rodata,"a"
.p2align 6
.amdhsa_kernel concat_heads__spectral_fnet__ssm_conv_h3__prompt_kernel
  .amdhsa_next_free_vgpr 256
  .amdhsa_next_free_sgpr 102
  .amdhsa_accum_offset 256
  .amdhsa_group_segment_fixed_size 0
  .amdhsa_kernarg_size 112
  .amdhsa_user_sgpr_count 2
  .amdhsa_user_sgpr_kernarg_segment_ptr 1
  .amdhsa_system_sgpr_workgroup_id_x 1
.end_amdhsa_kernel
```
